```python
import torch

def _softmax(x, axis=-1):
    return torch.softmax(x, dim=axis)
def _gelu(x):
    return torch.nn.functional.gelu(x, approximate="tanh")
def _silu(x):
    return torch.nn.functional.silu(x)
def _sigmoid(x):
    return torch.sigmoid(x)
def _layernorm(x, axis=-1, eps=1e-5):
    m = x.mean(dim=axis, keepdim=True)
    v = x.var(dim=axis, keepdim=True, unbiased=False)
    return (x - m) / torch.sqrt(v + eps)
def _scatter_add(tgt, idx, src, axis=0):
    return tgt.clone().index_add_(axis, idx, src)
def _segment_sum(src, seg, n):
    out = torch.zeros((n,) + src.shape[1:], dtype=src.dtype)
    return out.index_add_(0, seg, src)
def _pad(x, pw):
    flat = tuple(v for pair in reversed(pw) for v in pair)
    return torch.nn.functional.pad(x, flat)

kernel_name = 'concat_heads__compressed_kv_cla__linear_kernel_hedgehog__prompt'

def setup_inputs():

    _w = (lambda a: (lambda t: t.to(torch.bfloat16) if t.is_floating_point() else t)(torch.as_tensor(a)))
    def _A_setup():
        B, H, Sq, Sk, D, M = 1, 32, 2048, 2048, 128, 640
        Dc = 4 * D
        return {
            "x": _w((lambda *s: torch.randn(*s, dtype=torch.bfloat16) * 0.8)(B, Sq, M)),
            "c_kv": _w((lambda *s: torch.randn(*s, dtype=torch.bfloat16) * 0.4)(B, Sk, Dc)),
            "w_q": _w((lambda *s: torch.randn(*s, dtype=torch.bfloat16) * 6.4)(M, H, D) * (M ** -0.5)),
            "w_uk": _w((lambda *s: torch.randn(*s, dtype=torch.bfloat16) * 6.4)(Dc, H, D) * (Dc ** -0.5)),
            "w_uv": _w((lambda *s: torch.randn(*s, dtype=torch.bfloat16) * 0.4)(Dc, H, D) * (Dc ** -0.5)),
            "w_o": _w((lambda *s: torch.randn(*s, dtype=torch.bfloat16) * 0.4)(H, D, M) * ((H * D) ** -0.5)),
        }
    _A_in = _A_setup()

    def _B_setup():
        B, S, D, H = 1, 2048, 640, 32
        Dh = D // H
        return {
            "x": _w((lambda *s: torch.randn(*s, dtype=torch.bfloat16) * 0.4)(B, S, D)),
            "wqkv": _w((lambda *s: torch.randn(*s, dtype=torch.bfloat16) * 0.4)(D, 3 * D)),
            "w_phi": _w((lambda *s: torch.randn(*s, dtype=torch.bfloat16) * 0.4)(H, Dh, Dh) * (Dh ** -0.5)),
            "wo": _w((lambda *s: torch.randn(*s, dtype=torch.bfloat16) * 0.05)(D, D)),
        }
    _B_in = _B_setup()

    return {
        "A_x": _A_in["x"],
        "A_c_kv": _A_in["c_kv"],
        "A_w_q": _A_in["w_q"],
        "A_w_uk": _A_in["w_uk"],
        "A_w_uv": _A_in["w_uv"],
        "A_w_o": _A_in["w_o"],
        "B_x": _B_in["x"],
        "B_wqkv": _B_in["wqkv"],
        "B_w_phi": _B_in["w_phi"],
        "B_wo": _B_in["wo"],
    }

def reference(A_x, A_c_kv, A_w_q, A_w_uk, A_w_uv, A_w_o, B_x, B_wqkv, B_w_phi, B_wo):
    def _A_ref(x, c_kv, w_q, w_uk, w_uv, w_o):
        B, Sq, M = x.shape[0], x.shape[1], x.shape[2]
        Sk = c_kv.shape[1]
        H, D = w_q.shape[1], w_q.shape[2]
        q = torch.einsum("bqm,mhd->bhqd", x, w_q)
        k = torch.einsum("bkc,chd->bhkd", c_kv, w_uk)
        v = torch.einsum("bkc,chd->bhkd", c_kv, w_uv)
        scores = torch.einsum("bhqd,bhkd->bhqk", q, k) * (D ** -0.5)
        off = Sk - Sq
        qi = torch.arange(Sq)[:, None]
        kj = torch.arange(Sk)[None, :]
        cmask = kj <= (qi + off)
        scores = torch.where(cmask[None, None], scores, -1e9)
        p = _softmax(scores, axis=-1)
        ctx = torch.einsum("bhqk,bhkd->bhqd", p, v)
        return torch.einsum("bhqd,hdm->bqm", ctx, w_o)

    def _B_ref(x, wqkv, w_phi, wo):
        B, S, D = x.shape
        H = 32; Dh = D // H
        qkv = (lambda x, *d: x.permute(*d))((x @ wqkv).reshape(B, S, 3, H, Dh), 2, 0, 3, 1, 4)
        q, k, v = qkv[0], qkv[1], qkv[2]
        pq = torch.einsum("bhsd,hdf->bhsf", q, w_phi)
        pk = torch.einsum("bhsd,hdf->bhsf", k, w_phi)
        phi_q = torch.concatenate([_softmax(pq, axis=-1), _softmax(-pq, axis=-1)], axis=-1)
        phi_k = torch.concatenate([_softmax(pk, axis=-1), _softmax(-pk, axis=-1)], axis=-1)
        kv = torch.einsum("bhsf,bhsd->bhfd", phi_k, v)
        z  = torch.einsum("bhsf->bhf", phi_k)
        num = torch.einsum("bhqf,bhfd->bhqd", phi_q, kv)
        den = torch.einsum("bhqf,bhf->bhq", phi_q, z)[..., None] + 1e-6
        o = num / den
        return (lambda x, *d: x.permute(*d))(o, 0, 2, 1, 3).reshape(B, S, D) @ wo

    a = _A_ref(A_x, A_c_kv, A_w_q, A_w_uk, A_w_uv, A_w_o)
    b = _B_ref(B_x, B_wqkv, B_w_phi, B_wo)
    return torch.concatenate([a, b], axis=-1)
```

```asm
; @launch kernel=main_kernel grid=(256,1,1) block=(256,1,1) lds=163840
.amdgcn_target "amdgcn-amd-amdhsa--gfx950"
.text
.globl main_kernel
.p2align 8
.type main_kernel,@function
main_kernel:
  s_cmp_ge_u32 s2, 256
  s_cbranch_scc1 M_exit
  s_getpc_b64 s[96:97]
M_pc0:
  s_load_dwordx16 s[56:71], s[0:1], 0
  s_load_dwordx8 s[72:79], s[0:1], 64
  s_load_dwordx2 s[80:81], s[0:1], 96
  v_and_b32 v1, 63, v0
  v_lshrrev_b32 v23, 6, v0
  s_nop 0
  v_readfirstlane_b32 s30, v23
  s_and_b32 s35, s2, 7
  s_lshr_b32 s36, s2, 3
  s_lshl_b32 s31, s30, 12
  s_lshl_b32 s28, s35, 2
  s_lshr_b32 s32, s36, 3
  s_add_u32 s28, s28, s32
  s_and_b32 s29, s36, 7
  s_lshl_b32 s32, s36, 2
  s_add_u32 s32, s32, s30
  s_lshl_b32 s32, s32, 9
  v_and_b32 v23, 3, v1
  v_lshl_add_u32 v23, v23, 7, s32
  v_min_u32 v23, M_codeend-M_pc0-4, v23
  global_load_dword v26, v23, s[96:97]
  v_lshrrev_b32 v23, 3, v1
  s_lshl_b32 s32, s30, 9
  v_add_u32 v23, s32, v23
  v_mul_u32_u24 v23, 1024, v23
  v_lshrrev_b32 v24, 4, v1
  v_and_b32 v25, 7, v1
  v_xor_b32 v25, v25, v24
  v_lshl_add_u32 v2, v25, 4, v23
  v_xor_b32 v25, 4, v25
  v_lshl_add_u32 v3, v25, 4, v23
  v_add_u32 v3, 7168, v3
  v_add_u32 v4, 14336, v2
  v_add_u32 v5, 14336, v3
  v_lshrrev_b32 v23, 4, v1
  v_lshlrev_b32 v24, 2, v23
  s_lshl_b32 s32, s30, 4
  v_add_u32 v23, s32, v23
  v_mul_u32_u24 v23, 8192, v23
  v_and_b32 v25, 15, v1
  v_xor_b32 v25, v25, v24
  v_lshl_add_u32 v6, v25, 4, v23
  v_add_u32 v7, 31744, v6
  v_add_u32 v8, 63488, v6
  v_add_u32 v9, 95232, v6
  v_xor_b32 v8, 32, v8
  v_xor_b32 v9, 32, v9
  s_waitcnt lgkmcnt(0)
  s_add_u32 s20, s80, 0x4800000
  s_addc_u32 s21, s81, 0
  s_mov_b32 s22, 0x8000
  s_mov_b32 s23, 0x20000
  s_cmp_lg_u32 s2, 255
  s_cbranch_scc1 M_nolead
  v_lshlrev_b32 v23, 7, v0
  v_mov_b32 v24, 0
  buffer_store_dword v24, v23, s[20:23], 0 offen sc1
M_nolead:
  s_lshl_b32 s32, s29, 15
  s_add_u32 s4, s58, s32
  s_addc_u32 s5, s59, 0
  s_mov_b32 s7, 0x20000
  s_sub_u32 s6, 0x200000, s32
  s_lshl_b32 s32, s28, 8
  s_add_u32 s8, s62, s32
  s_addc_u32 s9, s63, 0
  s_mov_b32 s11, 0x20000
  s_sub_u32 s10, 4194304, s32
  s_lshl_b32 s32, s28, 8
  s_add_u32 s12, s64, s32
  s_addc_u32 s13, s65, 0
  s_mov_b32 s15, 0x20000
  s_sub_u32 s14, 4194304, s32
  s_add_u32 s41, s31, 0x0
  s_mov_b32 s44, 0
  s_mov_b32 m0, s41
  s_nop 0
  buffer_load_dwordx4 v2, s[4:7], s44 offen offset:0  lds
  buffer_load_dwordx4 v3, s[4:7], s44 offen offset:1024  lds
  buffer_load_dwordx4 v4, s[4:7], s44 offen offset:2048  lds
  buffer_load_dwordx4 v5, s[4:7], s44 offen offset:3072  lds
  s_add_u32 s41, s31, 0x4000
  s_mov_b32 s44, 262144
  s_mov_b32 m0, s41
  s_nop 0
  buffer_load_dwordx4 v2, s[4:7], s44 offen offset:0  lds
  buffer_load_dwordx4 v3, s[4:7], s44 offen offset:1024  lds
  buffer_load_dwordx4 v4, s[4:7], s44 offen offset:2048  lds
  buffer_load_dwordx4 v5, s[4:7], s44 offen offset:3072  lds
  s_add_u32 s41, s31, 0x8000
  s_mov_b32 s44, 0
  s_mov_b32 m0, s41
  s_nop 0
  buffer_load_dwordx4 v6, s[8:11], s44 offen offset:0 nt lds
  buffer_load_dwordx4 v7, s[8:11], s44 offen offset:1024 nt lds
  buffer_load_dwordx4 v8, s[8:11], s44 offen offset:2048 nt lds
  buffer_load_dwordx4 v9, s[8:11], s44 offen offset:3072 nt lds
  s_add_u32 s41, s31, 0xc000
  s_mov_b32 s44, 0
  s_mov_b32 m0, s41
  s_nop 0
  buffer_load_dwordx4 v6, s[12:15], s44 offen offset:0 nt lds
  buffer_load_dwordx4 v7, s[12:15], s44 offen offset:1024 nt lds
  buffer_load_dwordx4 v8, s[12:15], s44 offen offset:2048 nt lds
  buffer_load_dwordx4 v9, s[12:15], s44 offen offset:3072 nt lds
  s_add_u32 s41, s31, 0x10000
  s_mov_b32 s44, 128
  s_mov_b32 m0, s41
  s_nop 0
  buffer_load_dwordx4 v2, s[4:7], s44 offen offset:0  lds
  buffer_load_dwordx4 v3, s[4:7], s44 offen offset:1024  lds
  buffer_load_dwordx4 v4, s[4:7], s44 offen offset:2048  lds
  buffer_load_dwordx4 v5, s[4:7], s44 offen offset:3072  lds
  s_add_u32 s41, s31, 0x14000
  s_mov_b32 s44, 262272
  s_mov_b32 m0, s41
  s_nop 0
  buffer_load_dwordx4 v2, s[4:7], s44 offen offset:0  lds
  buffer_load_dwordx4 v3, s[4:7], s44 offen offset:1024  lds
  buffer_load_dwordx4 v4, s[4:7], s44 offen offset:2048  lds
  buffer_load_dwordx4 v5, s[4:7], s44 offen offset:3072  lds
  s_add_u32 s41, s31, 0x18000
  s_mov_b32 s44, 524288
  s_mov_b32 m0, s41
  s_nop 0
  buffer_load_dwordx4 v6, s[8:11], s44 offen offset:0 nt lds
  buffer_load_dwordx4 v7, s[8:11], s44 offen offset:1024 nt lds
  buffer_load_dwordx4 v8, s[8:11], s44 offen offset:2048 nt lds
  buffer_load_dwordx4 v9, s[8:11], s44 offen offset:3072 nt lds
  s_add_u32 s41, s31, 0x1c000
  s_mov_b32 s44, 524288
  s_mov_b32 m0, s41
  s_nop 0
  buffer_load_dwordx4 v6, s[12:15], s44 offen offset:0 nt lds
  buffer_load_dwordx4 v7, s[12:15], s44 offen offset:1024 nt lds
  buffer_load_dwordx4 v8, s[12:15], s44 offen offset:2048 nt lds
  buffer_load_dwordx4 v9, s[12:15], s44 offen offset:3072 nt lds
  v_and_b32 v23, 15, v1
  v_bfe_u32 v24, v1, 1, 3
  v_lshrrev_b32 v10, 4, v1
  v_xor_b32 v10, v10, v24
  v_lshlrev_b32 v10, 4, v10
  v_lshl_add_u32 v10, v23, 7, v10
  s_lshr_b32 s32, s30, 1
  s_lshl_b32 s32, s32, 14
  v_add_u32 v10, s32, v10
  v_xor_b32 v11, 64, v10
  s_lshl_b32 s47, s32, 3
  v_bfe_u32 v23, v1, 2, 2
  v_lshrrev_b32 v24, 4, v1
  v_lshlrev_b32 v14, 11, v24
  v_lshl_add_u32 v14, v23, 8, v14
  v_lshl_add_u32 v14, v23, 6, v14
  v_and_b32 v24, 1, v24
  v_lshl_add_u32 v14, v24, 5, v14
  v_and_b32 v23, 3, v1
  v_lshl_add_u32 v14, v23, 3, v14
  s_and_b32 s32, s30, 1
  s_lshl_b32 s32, s32, 7
  s_add_u32 s32, s32, 0x8000
  v_xor_b32 v14, s32, v14
  v_xor_b32 v15, 32, v14
  v_xor_b32 v16, 64, v14
  v_xor_b32 v17, 96, v14
  v_lshlrev_b32 v22, 4, v1
  s_lshl_b32 s37, s35, 1
  s_cmp_ge_u32 s36, 15
  s_cselect_b32 s32, 15, 0
  s_addc_u32 s37, s37, 0
  s_sub_u32 s38, s36, s32
  s_mul_i32 s40, s29, 163840
  s_sub_u32 s39, 2457600, s40
  s_waitcnt vmcnt(16) lgkmcnt(0)
  s_barrier
  ds_read_b128 a[128:131], v10 offset:0
  ds_read_b128 a[132:135], v10 offset:2048
  ds_read_b64_tr_b16 a[160:161], v14 offset:0
  ds_read_b64_tr_b16 a[162:163], v14 offset:1024
  ds_read_b64_tr_b16 a[164:165], v15 offset:0
  ds_read_b64_tr_b16 a[166:167], v15 offset:1024
  ds_read_b64_tr_b16 a[168:169], v16 offset:0
  ds_read_b64_tr_b16 a[170:171], v16 offset:1024
  ds_read_b64_tr_b16 a[172:173], v17 offset:0
  ds_read_b64_tr_b16 a[174:175], v17 offset:1024
  ds_read_b128 a[136:139], v10 offset:4096
  ds_read_b128 a[140:143], v10 offset:6144
  ds_read_b128 a[144:147], v10 offset:8192
  ds_read_b128 a[148:151], v10 offset:10240
  ds_read_b128 a[152:155], v10 offset:12288
  ds_read_b128 a[156:159], v10 offset:14336
  ds_read_b64_tr_b16 a[176:177], v14 offset:16384
  ds_read_b64_tr_b16 a[178:179], v14 offset:17408
  ds_read_b64_tr_b16 a[180:181], v15 offset:16384
  ds_read_b64_tr_b16 a[182:183], v15 offset:17408
  ds_read_b64_tr_b16 a[184:185], v16 offset:16384
  ds_read_b64_tr_b16 a[186:187], v16 offset:17408
  ds_read_b64_tr_b16 a[188:189], v17 offset:16384
  ds_read_b64_tr_b16 a[190:191], v17 offset:17408
  s_cmp_lg_u32 s2, 255
  s_cbranch_scc1 M_nolead2
  s_cmp_lg_u32 s30, 0
  s_cbranch_scc1 M_nolead2
  v_mov_b32 v23, 0
  v_mov_b32 v24, 1
  s_mov_b64 exec, 1
  global_store_dword v23, v24, s[78:79] sc1
  s_mov_b64 exec, -1
M_nolead2:
  s_waitcnt lgkmcnt(0)
  v_mfma_f32_16x16x32_bf16 v[96:99], a[160:163], a[128:131], 0
  ds_read_b128 a[192:195], v11 offset:0
  s_add_u32 s41, s31, 0x20000
  s_mov_b32 s44, 256
  v_mfma_f32_16x16x32_bf16 v[100:103], a[164:167], a[128:131], 0
  s_mov_b32 m0, s41
  v_mfma_f32_16x16x32_bf16 v[104:107], a[160:163], a[132:135], 0
  ds_read_b128 a[196:199], v11 offset:2048
  buffer_load_dwordx4 v2, s[4:7], s44 offen offset:0  lds
  v_mfma_f32_16x16x32_bf16 v[108:111], a[164:167], a[132:135], 0
  v_mfma_f32_16x16x32_bf16 v[112:115], a[168:171], a[128:131], 0
  ds_read_b64_tr_b16 a[224:225], v14 offset:8192
  v_mfma_f32_16x16x32_bf16 v[116:119], a[172:175], a[128:131], 0
  buffer_load_dwordx4 v3, s[4:7], s44 offen offset:1024  lds
  v_mfma_f32_16x16x32_bf16 v[120:123], a[168:171], a[132:135], 0
  ds_read_b64_tr_b16 a[226:227], v14 offset:9216
  v_mfma_f32_16x16x32_bf16 v[124:127], a[172:175], a[132:135], 0
  v_mfma_f32_16x16x32_bf16 v[128:131], a[160:163], a[136:139], 0
  ds_read_b64_tr_b16 a[228:229], v15 offset:8192
  buffer_load_dwordx4 v4, s[4:7], s44 offen offset:2048  lds
  v_mfma_f32_16x16x32_bf16 v[132:135], a[164:167], a[136:139], 0
  v_mfma_f32_16x16x32_bf16 v[136:139], a[160:163], a[140:143], 0
  ds_read_b64_tr_b16 a[230:231], v15 offset:9216
  v_mfma_f32_16x16x32_bf16 v[140:143], a[164:167], a[140:143], 0
  buffer_load_dwordx4 v5, s[4:7], s44 offen offset:3072  lds
  v_mfma_f32_16x16x32_bf16 v[144:147], a[168:171], a[136:139], 0
  ds_read_b64_tr_b16 a[232:233], v16 offset:8192
  v_mfma_f32_16x16x32_bf16 v[148:151], a[172:175], a[136:139], 0
  v_mfma_f32_16x16x32_bf16 v[152:155], a[168:171], a[140:143], 0
  ds_read_b64_tr_b16 a[234:235], v16 offset:9216
  v_mfma_f32_16x16x32_bf16 v[156:159], a[172:175], a[140:143], 0
  v_mfma_f32_16x16x32_bf16 v[32:35], a[160:163], a[144:147], 0
  ds_read_b64_tr_b16 a[236:237], v17 offset:8192
  v_mfma_f32_16x16x32_bf16 v[36:39], a[164:167], a[144:147], 0
  v_mfma_f32_16x16x32_bf16 v[40:43], a[160:163], a[148:151], 0
  ds_read_b64_tr_b16 a[238:239], v17 offset:9216
  v_mfma_f32_16x16x32_bf16 v[44:47], a[164:167], a[148:151], 0
  v_mfma_f32_16x16x32_bf16 v[48:51], a[168:171], a[144:147], 0
  ds_read_b128 a[200:203], v11 offset:4096
  v_mfma_f32_16x16x32_bf16 v[52:55], a[172:175], a[144:147], 0
  v_mfma_f32_16x16x32_bf16 v[56:59], a[168:171], a[148:151], 0
  ds_read_b128 a[204:207], v11 offset:6144
  v_mfma_f32_16x16x32_bf16 v[60:63], a[172:175], a[148:151], 0
  v_mfma_f32_16x16x32_bf16 v[64:67], a[160:163], a[152:155], 0
  ds_read_b128 a[208:211], v11 offset:8192
  v_mfma_f32_16x16x32_bf16 v[68:71], a[164:167], a[152:155], 0
  v_mfma_f32_16x16x32_bf16 v[72:75], a[160:163], a[156:159], 0
  ds_read_b128 a[212:215], v11 offset:10240
  v_mfma_f32_16x16x32_bf16 v[76:79], a[164:167], a[156:159], 0
  v_mfma_f32_16x16x32_bf16 v[80:83], a[168:171], a[152:155], 0
  ds_read_b128 a[216:219], v11 offset:12288
  v_mfma_f32_16x16x32_bf16 v[84:87], a[172:175], a[152:155], 0
  s_add_u32 s42, s31, 0x24000
  s_mov_b32 s45, 262400
  v_mfma_f32_16x16x32_bf16 v[88:91], a[168:171], a[156:159], 0
  ds_read_b128 a[220:223], v11 offset:14336
  s_mov_b32 m0, s42
  v_mfma_f32_16x16x32_bf16 v[92:95], a[172:175], a[156:159], 0
  buffer_load_dwordx4 v2, s[4:7], s45 offen offset:0  lds
  v_mfma_f32_16x16x32_bf16 v[160:163], a[128:131], a[176:179], 0
  ds_read_b64_tr_b16 a[240:241], v14 offset:24576
  v_mfma_f32_16x16x32_bf16 v[164:167], a[132:135], a[176:179], 0
  v_mfma_f32_16x16x32_bf16 v[168:171], a[128:131], a[180:183], 0
  ds_read_b64_tr_b16 a[242:243], v14 offset:25600
  buffer_load_dwordx4 v3, s[4:7], s45 offen offset:1024  lds
  v_mfma_f32_16x16x32_bf16 v[172:175], a[132:135], a[180:183], 0
  v_mfma_f32_16x16x32_bf16 v[176:179], a[128:131], a[184:187], 0
  ds_read_b64_tr_b16 a[244:245], v15 offset:24576
  v_mfma_f32_16x16x32_bf16 v[180:183], a[132:135], a[184:187], 0
  buffer_load_dwordx4 v4, s[4:7], s45 offen offset:2048  lds
  v_mfma_f32_16x16x32_bf16 v[184:187], a[128:131], a[188:191], 0
  ds_read_b64_tr_b16 a[246:247], v15 offset:25600
  v_mfma_f32_16x16x32_bf16 v[188:191], a[132:135], a[188:191], 0
  v_mfma_f32_16x16x32_bf16 v[192:195], a[136:139], a[176:179], 0
  ds_read_b64_tr_b16 a[248:249], v16 offset:24576
  buffer_load_dwordx4 v5, s[4:7], s45 offen offset:3072  lds
  v_mfma_f32_16x16x32_bf16 v[196:199], a[140:143], a[176:179], 0
  v_mfma_f32_16x16x32_bf16 v[200:203], a[136:139], a[180:183], 0
  ds_read_b64_tr_b16 a[250:251], v16 offset:25600
  v_mfma_f32_16x16x32_bf16 v[204:207], a[140:143], a[180:183], 0
  v_mfma_f32_16x16x32_bf16 v[208:211], a[136:139], a[184:187], 0
  ds_read_b64_tr_b16 a[252:253], v17 offset:24576
  v_mfma_f32_16x16x32_bf16 v[212:215], a[140:143], a[184:187], 0
  v_mfma_f32_16x16x32_bf16 v[216:219], a[136:139], a[188:191], 0
  ds_read_b64_tr_b16 a[254:255], v17 offset:25600
  v_mfma_f32_16x16x32_bf16 v[220:223], a[140:143], a[188:191], 0
  v_mfma_f32_16x16x32_bf16 v[224:227], a[144:147], a[176:179], 0
  v_mfma_f32_16x16x32_bf16 v[228:231], a[148:151], a[176:179], 0
  v_mfma_f32_16x16x32_bf16 v[232:235], a[144:147], a[180:183], 0
  s_mov_b32 s86, 0x10000
  s_mov_b32 s87, 0x10000
  v_mfma_f32_16x16x32_bf16 v[236:239], a[148:151], a[180:183], 0
  v_mfma_f32_16x16x32_bf16 v[240:243], a[144:147], a[184:187], 0
  v_mfma_f32_16x16x32_bf16 v[244:247], a[148:151], a[184:187], 0
  v_mfma_f32_16x16x32_bf16 v[248:251], a[144:147], a[188:191], 0
  v_mfma_f32_16x16x32_bf16 v[252:255], a[148:151], a[188:191], 0
  v_mfma_f32_16x16x32_bf16 a[0:3], a[152:155], a[176:179], 0
  v_mfma_f32_16x16x32_bf16 a[4:7], a[156:159], a[176:179], 0
  v_mfma_f32_16x16x32_bf16 a[8:11], a[152:155], a[180:183], 0
  v_mfma_f32_16x16x32_bf16 a[12:15], a[156:159], a[180:183], 0
  v_mfma_f32_16x16x32_bf16 a[16:19], a[152:155], a[184:187], 0
  v_add_u32 v10, s86, v10
  v_add_u32 v11, s86, v11
  v_mfma_f32_16x16x32_bf16 a[20:23], a[156:159], a[184:187], 0
  v_add_u32 v14, s87, v14
  v_add_u32 v15, s87, v15
  v_mfma_f32_16x16x32_bf16 a[24:27], a[152:155], a[188:191], 0
  v_add_u32 v16, s87, v16
  v_add_u32 v17, s87, v17
  v_mfma_f32_16x16x32_bf16 a[28:31], a[156:159], a[188:191], 0
  s_waitcnt vmcnt(8) lgkmcnt(0)
  s_barrier
  v_mfma_f32_16x16x32_bf16 v[96:99], a[224:227], a[192:195], v[96:99]
  v_mfma_f32_16x16x32_bf16 v[100:103], a[228:231], a[192:195], v[100:103]
  s_add_u32 s41, s31, 0x0
  v_mfma_f32_16x16x32_bf16 v[104:107], a[224:227], a[196:199], v[104:107]
  s_mov_b32 s44, 1048576
  v_mfma_f32_16x16x32_bf16 v[108:111], a[228:231], a[196:199], v[108:111]
  v_mfma_f32_16x16x32_bf16 v[112:115], a[232:235], a[192:195], v[112:115]
  s_add_u32 s42, s31, 0x4000
  v_mfma_f32_16x16x32_bf16 v[116:119], a[236:239], a[192:195], v[116:119]
  s_mov_b32 s45, 1048576
  s_call_b64 s[48:49], M_kvA
  v_mfma_f32_16x16x32_bf16 a[28:31], a[220:223], a[252:255], a[28:31]
  s_waitcnt lgkmcnt(0)
  v_mfma_f32_16x16x32_bf16 v[96:99], a[160:163], a[128:131], v[96:99]
  s_lshl_b32 s32, s2, 2
  s_add_u32 s32, s32, s30
  v_mfma_f32_16x16x32_bf16 v[100:103], a[164:167], a[128:131], v[100:103]
  s_mul_i32 s32, s32, 10
  s_add_u32 s32, s32, 0
  v_min_u32 v23, 9, v1
  v_mfma_f32_16x16x32_bf16 v[104:107], a[160:163], a[132:135], v[104:107]
  v_add_u32 v23, s32, v23
  v_min_u32 v23, 19199, v23
  v_mfma_f32_16x16x32_bf16 v[108:111], a[164:167], a[132:135], v[108:111]
  v_lshlrev_b32 v23, 7, v23
  global_load_dword v26, v23, s[70:71]
  s_add_u32 s41, s31, 0x8000
  v_mfma_f32_16x16x32_bf16 v[112:115], a[168:171], a[128:131], v[112:115]
  s_mov_b32 s44, 384
  s_add_u32 s42, s31, 0xc000
  v_mfma_f32_16x16x32_bf16 v[116:119], a[172:175], a[128:131], v[116:119]
  s_mov_b32 s45, 262528
  s_mov_b32 s86, 0x10000
  s_mov_b32 s87, 0xfffe8000
  s_call_b64 s[48:49], M_kvB
  v_mfma_f32_16x16x32_bf16 a[28:31], a[156:159], a[188:191], a[28:31]
  s_waitcnt vmcnt(9) lgkmcnt(0)
  s_barrier
  v_mfma_f32_16x16x32_bf16 v[96:99], a[224:227], a[192:195], v[96:99]
  s_lshl_b32 s32, s2, 2
  s_add_u32 s32, s32, s30
  v_mfma_f32_16x16x32_bf16 v[100:103], a[228:231], a[192:195], v[100:103]
  s_mul_i32 s32, s32, 10
  s_add_u32 s32, s32, 10240
  v_mfma_f32_16x16x32_bf16 v[104:107], a[224:227], a[196:199], v[104:107]
  v_min_u32 v23, 9, v1
  v_add_u32 v23, s32, v23
  v_mfma_f32_16x16x32_bf16 v[108:111], a[228:231], a[196:199], v[108:111]
  v_min_u32 v23, 19199, v23
  v_lshlrev_b32 v23, 7, v23
  v_mfma_f32_16x16x32_bf16 v[112:115], a[232:235], a[192:195], v[112:115]
  global_load_dword v26, v23, s[70:71]
  s_add_u32 s41, s31, 0x10000
  v_mfma_f32_16x16x32_bf16 v[116:119], a[236:239], a[192:195], v[116:119]
  s_mov_b32 s44, 1572864
  s_add_u32 s42, s31, 0x14000
  s_mov_b32 s45, 1572864
  s_call_b64 s[48:49], M_kvA
  v_mfma_f32_16x16x32_bf16 a[28:31], a[220:223], a[252:255], a[28:31]
  s_waitcnt lgkmcnt(0)
  v_mfma_f32_16x16x32_bf16 v[96:99], a[160:163], a[128:131], v[96:99]
  s_lshl_b32 s32, s2, 2
  s_add_u32 s32, s32, s30
  v_mfma_f32_16x16x32_bf16 v[100:103], a[164:167], a[128:131], v[100:103]
  s_mul_i32 s32, s32, 10
  s_add_u32 s32, s32, 0
  v_min_u32 v23, 9, v1
  v_mfma_f32_16x16x32_bf16 v[104:107], a[160:163], a[132:135], v[104:107]
  v_add_u32 v23, s32, v23
  v_min_u32 v23, 20479, v23
  v_mfma_f32_16x16x32_bf16 v[108:111], a[164:167], a[132:135], v[108:111]
  v_lshlrev_b32 v23, 7, v23
  global_load_dword v26, v23, s[68:69]
  s_add_u32 s41, s31, 0x18000
  v_mfma_f32_16x16x32_bf16 v[112:115], a[168:171], a[128:131], v[112:115]
  s_mov_b32 s44, 512
  s_add_u32 s42, s31, 0x1c000
  v_mfma_f32_16x16x32_bf16 v[116:119], a[172:175], a[128:131], v[116:119]
  s_mov_b32 s45, 262656
  s_mov_b32 s86, 0xfffe8000
  s_mov_b32 s87, 0x10000
  s_call_b64 s[48:49], M_kvB
  v_mfma_f32_16x16x32_bf16 a[28:31], a[156:159], a[188:191], a[28:31]
  s_waitcnt vmcnt(9) lgkmcnt(0)
  s_barrier
  v_mfma_f32_16x16x32_bf16 v[96:99], a[224:227], a[192:195], v[96:99]
  s_lshl_b32 s32, s2, 2
  s_add_u32 s32, s32, s30
  v_mfma_f32_16x16x32_bf16 v[100:103], a[228:231], a[192:195], v[100:103]
  s_mul_i32 s32, s32, 10
  s_add_u32 s32, s32, 10240
  v_mfma_f32_16x16x32_bf16 v[104:107], a[224:227], a[196:199], v[104:107]
  v_min_u32 v23, 9, v1
  v_add_u32 v23, s32, v23
  v_mfma_f32_16x16x32_bf16 v[108:111], a[228:231], a[196:199], v[108:111]
  v_min_u32 v23, 20479, v23
  v_lshlrev_b32 v23, 7, v23
  v_mfma_f32_16x16x32_bf16 v[112:115], a[232:235], a[192:195], v[112:115]
  global_load_dword v26, v23, s[68:69]
  s_add_u32 s41, s31, 0x20000
  v_mfma_f32_16x16x32_bf16 v[116:119], a[236:239], a[192:195], v[116:119]
  s_mov_b32 s44, 2097152
  s_add_u32 s42, s31, 0x24000
  s_mov_b32 s45, 2097152
  s_call_b64 s[48:49], M_kvA
  v_mfma_f32_16x16x32_bf16 a[28:31], a[220:223], a[252:255], a[28:31]
  s_waitcnt lgkmcnt(0)
  v_mfma_f32_16x16x32_bf16 v[96:99], a[160:163], a[128:131], v[96:99]
  s_lshl_b32 s32, s2, 2
  s_add_u32 s32, s32, s30
  v_mfma_f32_16x16x32_bf16 v[100:103], a[164:167], a[128:131], v[100:103]
  s_mul_i32 s32, s32, 10
  s_add_u32 s32, s32, 0
  v_min_u32 v23, 9, v1
  v_mfma_f32_16x16x32_bf16 v[104:107], a[160:163], a[132:135], v[104:107]
  v_add_u32 v23, s32, v23
  v_min_u32 v23, 20479, v23
  v_mfma_f32_16x16x32_bf16 v[108:111], a[164:167], a[132:135], v[108:111]
  v_lshlrev_b32 v23, 7, v23
  global_load_dword v26, v23, s[56:57]
  s_add_u32 s41, s31, 0x0
  v_mfma_f32_16x16x32_bf16 v[112:115], a[168:171], a[128:131], v[112:115]
  s_mov_b32 s44, 640
  s_add_u32 s42, s31, 0x4000
  v_mfma_f32_16x16x32_bf16 v[116:119], a[172:175], a[128:131], v[116:119]
  s_mov_b32 s45, 262784
  s_mov_b32 s86, 0x10000
  s_mov_b32 s87, 0x10000
  s_call_b64 s[48:49], M_kvB
  v_mfma_f32_16x16x32_bf16 a[28:31], a[156:159], a[188:191], a[28:31]
  s_waitcnt vmcnt(9) lgkmcnt(0)
  s_barrier
  v_mfma_f32_16x16x32_bf16 v[96:99], a[224:227], a[192:195], v[96:99]
  s_lshl_b32 s32, s2, 2
  s_add_u32 s32, s32, s30
  v_mfma_f32_16x16x32_bf16 v[100:103], a[228:231], a[192:195], v[100:103]
  s_mul_i32 s32, s32, 10
  s_add_u32 s32, s32, 10240
  v_mfma_f32_16x16x32_bf16 v[104:107], a[224:227], a[196:199], v[104:107]
  v_min_u32 v23, 9, v1
  v_add_u32 v23, s32, v23
  v_mfma_f32_16x16x32_bf16 v[108:111], a[228:231], a[196:199], v[108:111]
  v_min_u32 v23, 20479, v23
  v_lshlrev_b32 v23, 7, v23
  v_mfma_f32_16x16x32_bf16 v[112:115], a[232:235], a[192:195], v[112:115]
  global_load_dword v26, v23, s[56:57]
  s_add_u32 s41, s31, 0x8000
  v_mfma_f32_16x16x32_bf16 v[116:119], a[236:239], a[192:195], v[116:119]
  s_mov_b32 s44, 2621440
  s_add_u32 s42, s31, 0xc000
  s_mov_b32 s45, 2621440
  s_call_b64 s[48:49], M_kvA
  v_mfma_f32_16x16x32_bf16 a[28:31], a[220:223], a[252:255], a[28:31]
  s_waitcnt lgkmcnt(0)
  v_mfma_f32_16x16x32_bf16 v[96:99], a[160:163], a[128:131], v[96:99]
  s_lshl_b32 s32, s2, 2
  s_add_u32 s32, s32, s30
  v_mfma_f32_16x16x32_bf16 v[100:103], a[164:167], a[128:131], v[100:103]
  s_mul_i32 s32, s32, 10
  s_add_u32 s32, s32, 0
  v_min_u32 v23, 9, v1
  v_mfma_f32_16x16x32_bf16 v[104:107], a[160:163], a[132:135], v[104:107]
  v_add_u32 v23, s32, v23
  v_min_u32 v23, 40959, v23
  v_mfma_f32_16x16x32_bf16 v[108:111], a[164:167], a[132:135], v[108:111]
  v_lshlrev_b32 v23, 7, v23
  global_load_dword v26, v23, s[60:61]
  s_add_u32 s41, s31, 0x10000
  v_mfma_f32_16x16x32_bf16 v[112:115], a[168:171], a[128:131], v[112:115]
  s_mov_b32 s44, 768
  s_add_u32 s42, s31, 0x14000
  v_mfma_f32_16x16x32_bf16 v[116:119], a[172:175], a[128:131], v[116:119]
  s_mov_b32 s45, 262912
  s_mov_b32 s86, 0xfffe8000
  s_mov_b32 s87, 0xfffe8000
  s_call_b64 s[48:49], M_kvB
  v_mfma_f32_16x16x32_bf16 a[28:31], a[156:159], a[188:191], a[28:31]
  s_waitcnt vmcnt(9) lgkmcnt(0)
  s_barrier
  v_mfma_f32_16x16x32_bf16 v[96:99], a[224:227], a[192:195], v[96:99]
  s_lshl_b32 s32, s2, 2
  s_add_u32 s32, s32, s30
  v_mfma_f32_16x16x32_bf16 v[100:103], a[228:231], a[192:195], v[100:103]
  s_mul_i32 s32, s32, 10
  s_add_u32 s32, s32, 10240
  v_mfma_f32_16x16x32_bf16 v[104:107], a[224:227], a[196:199], v[104:107]
  v_min_u32 v23, 9, v1
  v_add_u32 v23, s32, v23
  v_mfma_f32_16x16x32_bf16 v[108:111], a[228:231], a[196:199], v[108:111]
  v_min_u32 v23, 40959, v23
  v_lshlrev_b32 v23, 7, v23
  v_mfma_f32_16x16x32_bf16 v[112:115], a[232:235], a[192:195], v[112:115]
  global_load_dword v26, v23, s[60:61]
  s_add_u32 s41, s31, 0x18000
  v_mfma_f32_16x16x32_bf16 v[116:119], a[236:239], a[192:195], v[116:119]
  s_mov_b32 s44, 3145728
  s_add_u32 s42, s31, 0x1c000
  s_mov_b32 s45, 3145728
  s_call_b64 s[48:49], M_kvA
  v_mfma_f32_16x16x32_bf16 a[28:31], a[220:223], a[252:255], a[28:31]
  s_waitcnt lgkmcnt(0)
  v_mfma_f32_16x16x32_bf16 v[96:99], a[160:163], a[128:131], v[96:99]
  s_lshl_b32 s32, s2, 2
  s_add_u32 s32, s32, s30
  v_mfma_f32_16x16x32_bf16 v[100:103], a[164:167], a[128:131], v[100:103]
  s_mul_i32 s32, s32, 10
  s_add_u32 s32, s32, 20480
  v_min_u32 v23, 9, v1
  v_mfma_f32_16x16x32_bf16 v[104:107], a[160:163], a[132:135], v[104:107]
  v_add_u32 v23, s32, v23
  v_min_u32 v23, 40959, v23
  v_mfma_f32_16x16x32_bf16 v[108:111], a[164:167], a[132:135], v[108:111]
  v_lshlrev_b32 v23, 7, v23
  global_load_dword v26, v23, s[60:61]
  s_add_u32 s41, s31, 0x20000
  v_mfma_f32_16x16x32_bf16 v[112:115], a[168:171], a[128:131], v[112:115]
  s_mov_b32 s44, 896
  s_add_u32 s42, s31, 0x24000
  v_mfma_f32_16x16x32_bf16 v[116:119], a[172:175], a[128:131], v[116:119]
  s_mov_b32 s45, 263040
  s_mov_b32 s86, 0x10000
  s_mov_b32 s87, 0x10000
  s_call_b64 s[48:49], M_kvB
  v_mfma_f32_16x16x32_bf16 a[28:31], a[156:159], a[188:191], a[28:31]
  s_waitcnt vmcnt(9) lgkmcnt(0)
  s_barrier
  v_mfma_f32_16x16x32_bf16 v[96:99], a[224:227], a[192:195], v[96:99]
  s_lshl_b32 s32, s2, 2
  s_add_u32 s32, s32, s30
  v_mfma_f32_16x16x32_bf16 v[100:103], a[228:231], a[192:195], v[100:103]
  s_mul_i32 s32, s32, 10
  s_add_u32 s32, s32, 30720
  v_mfma_f32_16x16x32_bf16 v[104:107], a[224:227], a[196:199], v[104:107]
  v_min_u32 v23, 9, v1
  v_add_u32 v23, s32, v23
  v_mfma_f32_16x16x32_bf16 v[108:111], a[228:231], a[196:199], v[108:111]
  v_min_u32 v23, 40959, v23
  v_lshlrev_b32 v23, 7, v23
  v_mfma_f32_16x16x32_bf16 v[112:115], a[232:235], a[192:195], v[112:115]
  global_load_dword v26, v23, s[60:61]
  s_add_u32 s41, s31, 0x0
  v_mfma_f32_16x16x32_bf16 v[116:119], a[236:239], a[192:195], v[116:119]
  s_mov_b32 s44, 3670016
  s_add_u32 s42, s31, 0x4000
  s_mov_b32 s45, 3670016
  s_call_b64 s[48:49], M_kvA
  v_mfma_f32_16x16x32_bf16 a[28:31], a[220:223], a[252:255], a[28:31]
  s_waitcnt lgkmcnt(0)
  v_mfma_f32_16x16x32_bf16 v[96:99], a[160:163], a[128:131], v[96:99]
  v_mov_b32 v23, 0
  global_load_dword v29, v23, s[78:79] sc1
  s_mul_i32 s32, s37, 163840
  s_add_u32 s4, s68, s32
  v_mfma_f32_16x16x32_bf16 v[100:103], a[164:167], a[128:131], v[100:103]
  s_addc_u32 s5, s69, 0
  s_mov_b32 s7, 0x20000
  s_cmp_lt_u32 s2, 240
  s_cselect_b32 s6, 163840, 0
  v_lshrrev_b32 v23, 3, v1
  v_mfma_f32_16x16x32_bf16 v[104:107], a[160:163], a[132:135], v[104:107]
  s_lshl_b32 s32, s30, 5
  v_add_u32 v23, s32, v23
  v_mul_u32_u24 v23, 1280, v23
  v_lshrrev_b32 v24, 4, v1
  v_mfma_f32_16x16x32_bf16 v[108:111], a[164:167], a[132:135], v[108:111]
  v_and_b32 v25, 7, v1
  v_xor_b32 v25, v25, v24
  v_lshl_add_u32 v2, v25, 4, v23
  v_xor_b32 v25, 4, v25
  v_lshl_add_u32 v3, v25, 4, v23
  v_mfma_f32_16x16x32_bf16 v[112:115], a[168:171], a[128:131], v[112:115]
  v_add_u32 v3, 9216, v3
  v_add_u32 v4, 18432, v2
  v_add_u32 v5, 18432, v3
  s_add_u32 s41, s31, 0x8000
  v_mfma_f32_16x16x32_bf16 v[116:119], a[172:175], a[128:131], v[116:119]
  s_mov_b32 s44, 0
  s_mov_b32 s42, 0x30000
  s_brev_b32 s45, 1
  s_mov_b32 s86, 0x10000
  s_mov_b32 s87, 0xfffe8000
  s_call_b64 s[48:49], M_kvB
  v_mfma_f32_16x16x32_bf16 a[28:31], a[156:159], a[188:191], a[28:31]
  s_waitcnt vmcnt(9) lgkmcnt(0)
  s_barrier
  v_mfma_f32_16x16x32_bf16 v[96:99], a[224:227], a[192:195], v[96:99]
  s_lshl_b32 s32, s38, 8
  s_add_u32 s8, s70, s32
  s_addc_u32 s9, s71, 0
  s_mov_b32 s11, 0x20000
  v_mfma_f32_16x16x32_bf16 v[100:103], a[228:231], a[192:195], v[100:103]
  s_sub_u32 s10, 2457600, s32
  s_cmp_lt_u32 s2, 240
  s_cselect_b32 s10, s10, 0
  s_mov_b64 s[12:13], s[8:9]
  v_mfma_f32_16x16x32_bf16 v[104:107], a[224:227], a[196:199], v[104:107]
  s_mov_b32 s14, s10
  v_lshrrev_b32 v23, 4, v1
  v_lshlrev_b32 v24, 2, v23
  s_lshl_b32 s32, s30, 4
  v_mfma_f32_16x16x32_bf16 v[108:111], a[228:231], a[196:199], v[108:111]
  v_add_u32 v23, s32, v23
  v_mul_u32_u24 v23, 3840, v23
  v_and_b32 v25, 15, v1
  v_xor_b32 v25, v25, v24
  v_mfma_f32_16x16x32_bf16 v[112:115], a[232:235], a[192:195], v[112:115]
  v_lshl_add_u32 v6, v25, 4, v23
  v_add_u32 v7, 14336, v6
  v_add_u32 v8, 28672, v6
  v_add_u32 v9, 43008, v6
  v_mfma_f32_16x16x32_bf16 v[116:119], a[236:239], a[192:195], v[116:119]
  s_add_u32 s41, s31, 0xc000
  s_mov_b32 s44, 0
  s_add_u32 s42, s31, 0x10000
  s_mov_b32 s45, 245760
  s_call_b64 s[48:49], M_kvA
  v_mfma_f32_16x16x32_bf16 a[28:31], a[220:223], a[252:255], a[28:31]
  s_waitcnt lgkmcnt(0)
  v_mfma_f32_16x16x32_bf16 v[96:99], a[160:163], a[128:131], v[96:99]
  s_mul_i32 s32, s36, 800
  s_add_u32 s16, s72, s32
  v_mfma_f32_16x16x32_bf16 v[100:103], a[164:167], a[128:131], v[100:103]
  s_addc_u32 s17, s73, 0
  s_mov_b32 s18, 0x320
  v_mfma_f32_16x16x32_bf16 v[104:107], a[160:163], a[132:135], v[104:107]
  s_mov_b32 s19, 0x20000
  v_subrev_u32 v23, 480, v22
  buffer_load_dwordx4 a[96:99], v23, s[16:19], 0 offen
  v_mfma_f32_16x16x32_bf16 v[108:111], a[164:167], a[132:135], v[108:111]
  buffer_load_dwordx4 a[100:103], v22, s[16:19], 0 offen offset:544
  s_add_u32 s41, s31, 0x14000
  v_mfma_f32_16x16x32_bf16 v[112:115], a[168:171], a[128:131], v[112:115]
  s_mov_b32 s44, 128
  s_add_u32 s42, s31, 0x18000
  v_mfma_f32_16x16x32_bf16 v[116:119], a[172:175], a[128:131], v[116:119]
  s_mov_b32 s45, 256
  s_mov_b32 s86, 0xfffe8000
  s_mov_b32 s87, 0x10000
  s_call_b64 s[48:49], M_kvB
  v_mfma_f32_16x16x32_bf16 a[28:31], a[156:159], a[188:191], a[28:31]
  s_waitcnt vmcnt(14) lgkmcnt(0)
  s_barrier
  v_mfma_f32_16x16x32_bf16 v[96:99], a[224:227], a[192:195], v[96:99]
  s_add_u32 s41, s31, 0x1c000
  s_mov_b32 s44, 491520
  s_add_u32 s42, s31, 0x20000
  s_mov_b32 s45, 737280
  s_add_u32 s43, s31, 0x24000
  s_mov_b32 s46, 384
  v_and_b32 v23, 31, v1
  v_bfe_u32 v24, v1, 1, 3
  v_mfma_f32_16x16x32_bf16 v[100:103], a[228:231], a[192:195], v[100:103]
  s_mov_b32 m0, s41
  v_lshrrev_b32 v10, 5, v1
  v_xor_b32 v10, v10, v24
  v_mfma_f32_16x16x32_bf16 v[104:107], a[224:227], a[196:199], v[104:107]
  buffer_load_dwordx4 v6, s[8:11], s44 offen offset:0  lds
  v_lshlrev_b32 v10, 4, v10
  v_lshl_add_u32 v10, v23, 7, v10
  v_xor_b32 v11, 32, v10
  v_mfma_f32_16x16x32_bf16 v[108:111], a[228:231], a[196:199], v[108:111]
  v_xor_b32 v12, 64, v10
  v_xor_b32 v13, 96, v10
  v_mfma_f32_16x16x32_bf16 v[112:115], a[232:235], a[192:195], v[112:115]
  s_lshr_b32 s32, s30, 1
  s_lshl_b32 s32, s32, 13
  v_mfma_f32_16x16x32_bf16 v[116:119], a[236:239], a[192:195], v[116:119]
  s_add_u32 s32, s32, 0x8000
  v_add_u32 v10, s32, v10
  v_add_u32 v11, s32, v11
  v_mfma_f32_16x16x32_bf16 v[120:123], a[232:235], a[196:199], v[120:123]
  buffer_load_dwordx4 v7, s[8:11], s44 offen offset:1024  lds
  v_add_u32 v12, s32, v12
  v_add_u32 v13, s32, v13
  v_mfma_f32_16x16x32_bf16 v[124:127], a[236:239], a[196:199], v[124:127]
  s_and_b32 s32, s30, 1
  s_lshl_b32 s32, s32, 1
  v_mov_b32 v25, s32
  v_mfma_f32_16x16x32_bf16 v[128:131], a[224:227], a[200:203], v[128:131]
  v_bfe_u32 v23, v1, 2, 2
  v_xor_b32 v24, v25, v23
  v_mfma_f32_16x16x32_bf16 v[132:135], a[228:231], a[200:203], v[132:135]
  v_lshlrev_b32 v24, 6, v24
  v_lshl_add_u32 v24, v23, 8, v24
  v_mfma_f32_16x16x32_bf16 v[136:139], a[224:227], a[204:207], v[136:139]
  v_lshrrev_b32 v23, 5, v1
  v_lshl_add_u32 v24, v23, 11, v24
  v_bfe_u32 v23, v1, 4, 1
  v_mfma_f32_16x16x32_bf16 v[140:143], a[228:231], a[204:207], v[140:143]
  buffer_load_dwordx4 v8, s[8:11], s44 offen offset:2048  lds
  v_lshl_add_u32 v24, v23, 5, v24
  v_and_b32 v23, 3, v1
  v_mfma_f32_16x16x32_bf16 v[144:147], a[232:235], a[200:203], v[144:147]
  v_lshl_add_u32 v14, v23, 3, v24
  v_add_u32 v14, 0xc000, v14
  v_mfma_f32_16x16x32_bf16 v[148:151], a[236:239], a[200:203], v[148:151]
  v_xor_b32 v15, 64, v14
  s_lshl_b32 s32, s28, 20
  s_lshl_b32 s33, s29, 14
  v_mfma_f32_16x16x32_bf16 v[152:155], a[232:235], a[204:207], v[152:155]
  s_add_u32 s32, s32, s33
  s_add_u32 s16, s80, s32
  v_mfma_f32_16x16x32_bf16 v[156:159], a[236:239], a[204:207], v[156:159]
  s_addc_u32 s17, s81, 0
  s_mov_b32 s19, 0x20000
  s_sub_u32 s18, 0x100000, s33
  v_mfma_f32_16x16x32_bf16 v[32:35], a[224:227], a[208:211], v[32:35]
  buffer_load_dwordx4 v9, s[8:11], s44 offen offset:3072  lds
  v_mfma_f32_16x16x32_bf16 v[36:39], a[228:231], a[208:211], v[36:39]
  v_cvt_pk_bf16_f32 v96, v96, v97
  v_cvt_pk_bf16_f32 v97, v98, v99
  v_mfma_f32_16x16x32_bf16 v[40:43], a[224:227], a[212:215], v[40:43]
  v_cvt_pk_bf16_f32 v98, v100, v101
  v_cvt_pk_bf16_f32 v99, v102, v103
  v_mfma_f32_16x16x32_bf16 v[44:47], a[228:231], a[212:215], v[44:47]
  v_cvt_pk_bf16_f32 v100, v104, v105
  v_cvt_pk_bf16_f32 v101, v106, v107
  v_mfma_f32_16x16x32_bf16 v[48:51], a[232:235], a[208:211], v[48:51]
  ds_read_b128 a[128:131], v10 offset:0
  v_cvt_pk_bf16_f32 v102, v108, v109
  v_mfma_f32_16x16x32_bf16 v[52:55], a[236:239], a[208:211], v[52:55]
  s_mov_b32 m0, s42
  v_cvt_pk_bf16_f32 v103, v110, v111
  v_cvt_pk_bf16_f32 v104, v112, v113
  v_mfma_f32_16x16x32_bf16 v[56:59], a[232:235], a[212:215], v[56:59]
  buffer_load_dwordx4 v6, s[8:11], s45 offen offset:0  lds
  v_mfma_f32_16x16x32_bf16 v[60:63], a[236:239], a[212:215], v[60:63]
  ds_read_b64_tr_b16 a[136:137], v14 offset:0
  v_cvt_pk_bf16_f32 v105, v114, v115
  v_mfma_f32_16x16x32_bf16 v[64:67], a[224:227], a[216:219], v[64:67]
  v_cvt_pk_bf16_f32 v106, v116, v117
  v_cvt_pk_bf16_f32 v107, v118, v119
  v_mfma_f32_16x16x32_bf16 v[68:71], a[228:231], a[216:219], v[68:71]
  v_cvt_pk_bf16_f32 v108, v120, v121
  v_cvt_pk_bf16_f32 v109, v122, v123
  v_mfma_f32_16x16x32_bf16 v[72:75], a[224:227], a[220:223], v[72:75]
  buffer_load_dwordx4 v7, s[8:11], s45 offen offset:1024  lds
  ds_read_b64_tr_b16 a[138:139], v14 offset:1024
  v_mfma_f32_16x16x32_bf16 v[76:79], a[228:231], a[220:223], v[76:79]
  v_cvt_pk_bf16_f32 v110, v124, v125
  v_cvt_pk_bf16_f32 v111, v126, v127
  v_mfma_f32_16x16x32_bf16 v[80:83], a[232:235], a[216:219], v[80:83]
  v_cvt_pk_bf16_f32 v112, v128, v129
  v_cvt_pk_bf16_f32 v113, v130, v131
  v_mfma_f32_16x16x32_bf16 v[84:87], a[236:239], a[216:219], v[84:87]
  ds_read_b128 a[132:135], v10 offset:4096
  v_cvt_pk_bf16_f32 v114, v132, v133
  v_mfma_f32_16x16x32_bf16 v[88:91], a[232:235], a[220:223], v[88:91]
  v_cvt_pk_bf16_f32 v115, v134, v135
  v_cvt_pk_bf16_f32 v116, v136, v137
  v_mfma_f32_16x16x32_bf16 v[92:95], a[236:239], a[220:223], v[92:95]
  buffer_load_dwordx4 v8, s[8:11], s45 offen offset:2048  lds
  v_cvt_pk_bf16_f32 v117, v138, v139
  v_mfma_f32_16x16x32_bf16 v[160:163], a[192:195], a[240:243], v[160:163]
  ds_read_b64_tr_b16 a[140:141], v15 offset:0
  v_cvt_pk_bf16_f32 v118, v140, v141
  v_cvt_pk_bf16_f32 v119, v142, v143
  v_mfma_f32_16x16x32_bf16 v[164:167], a[196:199], a[240:243], v[164:167]
  v_cvt_pk_bf16_f32 v120, v144, v145
  v_cvt_pk_bf16_f32 v121, v146, v147
  v_cvt_pk_bf16_f32 v122, v148, v149
  v_mfma_f32_16x16x32_bf16 v[168:171], a[192:195], a[244:247], v[168:171]
  v_cvt_pk_bf16_f32 v123, v150, v151
  v_cvt_pk_bf16_f32 v124, v152, v153
  v_cvt_pk_bf16_f32 v125, v154, v155
  v_mfma_f32_16x16x32_bf16 v[172:175], a[196:199], a[244:247], v[172:175]
  ds_read_b64_tr_b16 a[142:143], v15 offset:1024
  v_cvt_pk_bf16_f32 v126, v156, v157
  v_cvt_pk_bf16_f32 v127, v158, v159
  v_mfma_f32_16x16x32_bf16 v[176:179], a[192:195], a[248:251], v[176:179]
  buffer_load_dwordx4 v9, s[8:11], s45 offen offset:3072  lds
  v_cvt_pk_bf16_f32 v128, v32, v33
  v_mfma_f32_16x16x32_bf16 v[180:183], a[196:199], a[248:251], v[180:183]
  v_cvt_pk_bf16_f32 v129, v34, v35
  v_cvt_pk_bf16_f32 v130, v36, v37
  v_cvt_pk_bf16_f32 v131, v38, v39
  v_mfma_f32_16x16x32_bf16 v[184:187], a[192:195], a[252:255], v[184:187]
  ds_read_b128 a[144:147], v11 offset:0
  v_cvt_pk_bf16_f32 v132, v40, v41
  v_cvt_pk_bf16_f32 v133, v42, v43
  v_mfma_f32_16x16x32_bf16 v[188:191], a[196:199], a[252:255], v[188:191]
  v_cvt_pk_bf16_f32 v134, v44, v45
  v_cvt_pk_bf16_f32 v135, v46, v47
  v_cvt_pk_bf16_f32 v136, v48, v49
  v_mfma_f32_16x16x32_bf16 v[192:195], a[200:203], a[240:243], v[192:195]
  v_cvt_pk_bf16_f32 v137, v50, v51
  v_cvt_pk_bf16_f32 v138, v52, v53
  v_cvt_pk_bf16_f32 v139, v54, v55
  v_mfma_f32_16x16x32_bf16 v[196:199], a[204:207], a[240:243], v[196:199]
  s_mov_b32 m0, s43
  ds_read_b64_tr_b16 a[152:153], v14 offset:4096
  v_cvt_pk_bf16_f32 v140, v56, v57
  v_cvt_pk_bf16_f32 v141, v58, v59
  v_mfma_f32_16x16x32_bf16 v[200:203], a[200:203], a[244:247], v[200:203]
  buffer_load_dwordx4 v2, s[4:7], s46 offen offset:0  lds
  v_cvt_pk_bf16_f32 v142, v60, v61
  v_mfma_f32_16x16x32_bf16 v[204:207], a[204:207], a[244:247], v[204:207]
  v_cvt_pk_bf16_f32 v143, v62, v63
  v_cvt_pk_bf16_f32 v144, v64, v65
  v_cvt_pk_bf16_f32 v145, v66, v67
  v_mfma_f32_16x16x32_bf16 v[208:211], a[200:203], a[248:251], v[208:211]
  ds_read_b64_tr_b16 a[154:155], v14 offset:5120
  v_cvt_pk_bf16_f32 v146, v68, v69
  v_cvt_pk_bf16_f32 v147, v70, v71
  v_mfma_f32_16x16x32_bf16 v[212:215], a[204:207], a[248:251], v[212:215]
  v_cvt_pk_bf16_f32 v148, v72, v73
  v_cvt_pk_bf16_f32 v149, v74, v75
  v_cvt_pk_bf16_f32 v150, v76, v77
  v_mfma_f32_16x16x32_bf16 v[216:219], a[200:203], a[252:255], v[216:219]
  buffer_load_dwordx4 v3, s[4:7], s46 offen offset:1024  lds
  v_cvt_pk_bf16_f32 v151, v78, v79
  v_mfma_f32_16x16x32_bf16 v[220:223], a[204:207], a[252:255], v[220:223]
  ds_read_b128 a[148:151], v11 offset:4096
  v_cvt_pk_bf16_f32 v152, v80, v81
  v_cvt_pk_bf16_f32 v153, v82, v83
  v_mfma_f32_16x16x32_bf16 v[224:227], a[208:211], a[240:243], v[224:227]
  v_cvt_pk_bf16_f32 v154, v84, v85
  v_cvt_pk_bf16_f32 v155, v86, v87
  v_cvt_pk_bf16_f32 v156, v88, v89
  v_mfma_f32_16x16x32_bf16 v[228:231], a[212:215], a[240:243], v[228:231]
  v_cvt_pk_bf16_f32 v157, v90, v91
  v_cvt_pk_bf16_f32 v158, v92, v93
  v_cvt_pk_bf16_f32 v159, v94, v95
  v_mfma_f32_16x16x32_bf16 v[232:235], a[208:211], a[244:247], v[232:235]
  ds_read_b64_tr_b16 a[156:157], v15 offset:4096
  v_cvt_pk_bf16_f32 v160, v160, v161
  v_mfma_f32_16x16x32_bf16 v[236:239], a[212:215], a[244:247], v[236:239]
  buffer_load_dwordx4 v4, s[4:7], s46 offen offset:2048  lds
  v_mfma_f32_16x16x32_bf16 v[240:243], a[208:211], a[248:251], v[240:243]
  v_cvt_pk_bf16_f32 v161, v162, v163
  v_cvt_pk_bf16_f32 v162, v164, v165
  v_mfma_f32_16x16x32_bf16 v[244:247], a[212:215], a[248:251], v[244:247]
  ds_read_b64_tr_b16 a[158:159], v15 offset:5120
  v_cvt_pk_bf16_f32 v163, v166, v167
  v_mfma_f32_16x16x32_bf16 v[248:251], a[208:211], a[252:255], v[248:251]
  v_cvt_pk_bf16_f32 v164, v168, v169
  v_cvt_pk_bf16_f32 v165, v170, v171
  v_mfma_f32_16x16x32_bf16 v[252:255], a[212:215], a[252:255], v[252:255]
  v_cvt_pk_bf16_f32 v166, v172, v173
  v_cvt_pk_bf16_f32 v167, v174, v175
  v_mfma_f32_16x16x32_bf16 a[0:3], a[216:219], a[240:243], a[0:3]
  buffer_load_dwordx4 v5, s[4:7], s46 offen offset:3072  lds
  v_mfma_f32_16x16x32_bf16 a[4:7], a[220:223], a[240:243], a[4:7]
  v_cvt_pk_bf16_f32 v168, v176, v177
  v_cvt_pk_bf16_f32 v169, v178, v179
  v_mfma_f32_16x16x32_bf16 a[8:11], a[216:219], a[244:247], a[8:11]
  v_cvt_pk_bf16_f32 v170, v180, v181
  v_cvt_pk_bf16_f32 v171, v182, v183
  v_mfma_f32_16x16x32_bf16 a[12:15], a[220:223], a[244:247], a[12:15]
  v_cvt_pk_bf16_f32 v172, v184, v185
  v_cvt_pk_bf16_f32 v173, v186, v187
  v_mfma_f32_16x16x32_bf16 a[16:19], a[216:219], a[248:251], a[16:19]
  v_cvt_pk_bf16_f32 v174, v188, v189
  v_cvt_pk_bf16_f32 v175, v190, v191
  v_mfma_f32_16x16x32_bf16 a[20:23], a[220:223], a[248:251], a[20:23]
  v_cvt_pk_bf16_f32 v176, v192, v193
  v_cvt_pk_bf16_f32 v177, v194, v195
  v_mfma_f32_16x16x32_bf16 a[24:27], a[216:219], a[252:255], a[24:27]
  v_cvt_pk_bf16_f32 v178, v196, v197
  v_cvt_pk_bf16_f32 v179, v198, v199
  v_cvt_pk_bf16_f32 v180, v200, v201
  v_mfma_f32_16x16x32_bf16 a[28:31], a[220:223], a[252:255], a[28:31]
  v_cvt_pk_bf16_f32 v181, v202, v203
  v_cvt_pk_bf16_f32 v182, v204, v205
  v_cvt_pk_bf16_f32 v183, v206, v207
  s_waitcnt lgkmcnt(0)
  s_cmp_ge_u32 s38, 10
  s_cbranch_scc1 M_bv
  v_mfma_f32_32x32x16_bf16 v[32:47], a[136:139], a[128:131], 0
  s_add_u32 s42, s31, 0x0
  s_mov_b32 s45, 512
  ds_read_b128 a[160:163], v12 offset:0
  ds_read_b64_tr_b16 a[168:169], v14 offset:8192
  s_mov_b32 s86, 0xc000
  s_mov_b32 s87, 0x4000
  v_cvt_pk_bf16_f32 v184, v208, v209
  v_cvt_pk_bf16_f32 v185, v210, v211
  v_cvt_pk_bf16_f32 v186, v212, v213
  v_cvt_pk_bf16_f32 v187, v214, v215
  v_cvt_pk_bf16_f32 v188, v216, v217
  v_cvt_pk_bf16_f32 v189, v218, v219
  v_cvt_pk_bf16_f32 v190, v220, v221
  v_cvt_pk_bf16_f32 v191, v222, v223
  v_cvt_pk_bf16_f32 v192, v224, v225
  v_cvt_pk_bf16_f32 v193, v226, v227
  v_mfma_f32_32x32x16_bf16 v[48:63], a[140:143], a[128:131], 0
  s_mov_b32 m0, s42
  ds_read_b64_tr_b16 a[170:171], v14 offset:9216
  ds_read_b128 a[164:167], v12 offset:4096
  v_cvt_pk_bf16_f32 v194, v228, v229
  v_cvt_pk_bf16_f32 v195, v230, v231
  v_cvt_pk_bf16_f32 v196, v232, v233
  v_cvt_pk_bf16_f32 v197, v234, v235
  v_cvt_pk_bf16_f32 v198, v236, v237
  v_cvt_pk_bf16_f32 v199, v238, v239
  v_cvt_pk_bf16_f32 v200, v240, v241
  v_cvt_pk_bf16_f32 v201, v242, v243
  v_cvt_pk_bf16_f32 v202, v244, v245
  v_cvt_pk_bf16_f32 v203, v246, v247
  v_cvt_pk_bf16_f32 v204, v248, v249
  v_mfma_f32_32x32x16_bf16 v[64:79], a[136:139], a[132:135], 0
  buffer_load_dwordx4 v2, s[4:7], s45 offen offset:0  lds
  ds_read_b64_tr_b16 a[172:173], v15 offset:8192
  ds_read_b64_tr_b16 a[174:175], v15 offset:9216
  v_cvt_pk_bf16_f32 v205, v250, v251
  v_cvt_pk_bf16_f32 v206, v252, v253
  v_cvt_pk_bf16_f32 v207, v254, v255
  v_accvgpr_read_b32 v224, a0
  v_accvgpr_read_b32 v225, a1
  v_accvgpr_read_b32 v226, a2
  v_accvgpr_read_b32 v227, a3
  v_accvgpr_read_b32 v228, a4
  v_accvgpr_read_b32 v229, a5
  v_accvgpr_read_b32 v230, a6
  v_accvgpr_read_b32 v231, a7
  v_mfma_f32_32x32x16_bf16 v[80:95], a[140:143], a[132:135], 0
  buffer_load_dwordx4 v3, s[4:7], s45 offen offset:1024  lds
  ds_read_b128 a[176:179], v13 offset:0
  ds_read_b64_tr_b16 a[184:185], v14 offset:12288
  v_accvgpr_read_b32 v232, a8
  v_accvgpr_read_b32 v233, a9
  v_accvgpr_read_b32 v234, a10
  v_accvgpr_read_b32 v235, a11
  v_accvgpr_read_b32 v236, a12
  v_accvgpr_read_b32 v237, a13
  v_accvgpr_read_b32 v238, a14
  v_accvgpr_read_b32 v239, a15
  v_cvt_pk_bf16_f32 v208, v224, v225
  v_cvt_pk_bf16_f32 v209, v226, v227
  v_cvt_pk_bf16_f32 v210, v228, v229
  v_mfma_f32_32x32x16_bf16 v[32:47], a[152:155], a[144:147], v[32:47]
  buffer_load_dwordx4 v4, s[4:7], s45 offen offset:2048  lds
  ds_read_b64_tr_b16 a[186:187], v14 offset:13312
  ds_read_b128 a[180:183], v13 offset:4096
  v_cvt_pk_bf16_f32 v211, v230, v231
  v_cvt_pk_bf16_f32 v212, v232, v233
  v_cvt_pk_bf16_f32 v213, v234, v235
  v_cvt_pk_bf16_f32 v214, v236, v237
  v_cvt_pk_bf16_f32 v215, v238, v239
  v_accvgpr_read_b32 v224, a16
  v_accvgpr_read_b32 v225, a17
  v_accvgpr_read_b32 v226, a18
  v_accvgpr_read_b32 v227, a19
  v_accvgpr_read_b32 v228, a20
  v_accvgpr_read_b32 v229, a21
  v_mfma_f32_32x32x16_bf16 v[48:63], a[156:159], a[144:147], v[48:63]
  buffer_load_dwordx4 v5, s[4:7], s45 offen offset:3072  lds
  ds_read_b64_tr_b16 a[188:189], v15 offset:12288
  ds_read_b64_tr_b16 a[190:191], v15 offset:13312
  v_accvgpr_read_b32 v230, a22
  v_accvgpr_read_b32 v231, a23
  v_accvgpr_read_b32 v232, a24
  v_accvgpr_read_b32 v233, a25
  v_accvgpr_read_b32 v234, a26
  v_accvgpr_read_b32 v235, a27
  v_accvgpr_read_b32 v236, a28
  v_accvgpr_read_b32 v237, a29
  v_accvgpr_read_b32 v238, a30
  v_accvgpr_read_b32 v239, a31
  v_cvt_pk_bf16_f32 v216, v224, v225
  v_mfma_f32_32x32x16_bf16 v[64:79], a[152:155], a[148:151], v[64:79]
  v_cvt_pk_bf16_f32 v217, v226, v227
  v_cvt_pk_bf16_f32 v218, v228, v229
  v_cvt_pk_bf16_f32 v219, v230, v231
  v_cvt_pk_bf16_f32 v220, v232, v233
  v_cvt_pk_bf16_f32 v221, v234, v235
  v_cvt_pk_bf16_f32 v222, v236, v237
  v_cvt_pk_bf16_f32 v223, v238, v239
  v_add_u32 v10, s86, v10
  v_add_u32 v11, s86, v11
  v_add_u32 v12, s86, v12
  v_add_u32 v13, s86, v13
  v_add_u32 v14, s87, v14
  v_add_u32 v15, s87, v15
  v_mfma_f32_32x32x16_bf16 v[80:95], a[156:159], a[148:151], v[80:95]
  s_waitcnt vmcnt(20) lgkmcnt(0)
  s_barrier
  v_mfma_f32_32x32x16_bf16 v[32:47], a[168:171], a[160:163], v[32:47]
  s_mov_b32 s86, 0x4000
  s_mov_b32 s87, 0xc000
  s_add_u32 s43, s31, 0x4000
  s_mov_b32 s46, 640
  s_mov_b32 m0, s43
  s_nop 0
  buffer_load_dwordx4 v2, s[4:7], s46 offen offset:0  lds
  buffer_load_dwordx4 v3, s[4:7], s46 offen offset:1024  lds
  buffer_load_dwordx4 v4, s[4:7], s46 offen offset:2048  lds
  buffer_load_dwordx4 v5, s[4:7], s46 offen offset:3072  lds
  s_add_u32 s41, s31, 0x8000
  v_mfma_f32_32x32x16_bf16 v[48:63], a[172:175], a[160:163], v[48:63]
  s_mov_b32 s44, 983040
  s_mov_b32 s42, 0x30000
  s_brev_b32 s45, 1
  s_lshr_b32 s34, s31, 1
  s_and_b32 s34, s34, 0x800
  s_add_u32 s34, s34, s47
  s_add_u32 s34, s34, 0x0
  buffer_store_dwordx4 v[96:99], v22, s[16:19], s34 offen offset:0 sc1
  s_addk_i32 s34, 0x1000
  buffer_store_dwordx4 v[100:103], v22, s[16:19], s34 offen offset:0 sc1
  s_call_b64 s[48:49], M_b0
  v_mfma_f32_32x32x16_bf16 v[80:95], a[156:159], a[148:151], v[80:95]
  s_waitcnt vmcnt(26) lgkmcnt(0)
  s_barrier
  v_mfma_f32_32x32x16_bf16 v[32:47], a[168:171], a[160:163], v[32:47]
  s_mov_b32 s86, 0xc000
  s_mov_b32 s87, 0x4000
  s_add_u32 s43, s31, 0xc000
  s_mov_b32 s46, 1228800
  s_mov_b32 m0, s43
  s_nop 0
  buffer_load_dwordx4 v6, s[8:11], s46 offen offset:0  lds
  buffer_load_dwordx4 v7, s[8:11], s46 offen offset:1024  lds
  buffer_load_dwordx4 v8, s[8:11], s46 offen offset:2048  lds
  buffer_load_dwordx4 v9, s[8:11], s46 offen offset:3072  lds
  s_add_u32 s41, s31, 0x14000
  s_mov_b32 s44, 1474560
  v_mfma_f32_32x32x16_bf16 v[48:63], a[172:175], a[160:163], v[48:63]
  s_add_u32 s42, s31, 0x10000
  s_mov_b32 s45, 768
  v_accvgpr_write_b32 a192, v128
  v_accvgpr_write_b32 a193, v129
  v_accvgpr_write_b32 a194, v130
  v_accvgpr_write_b32 a195, v131
  v_accvgpr_write_b32 a196, v132
  v_accvgpr_write_b32 a197, v133
  v_accvgpr_write_b32 a198, v134
  v_accvgpr_write_b32 a199, v135
  v_accvgpr_write_b32 a200, v136
  v_accvgpr_write_b32 a201, v137
  s_call_b64 s[48:49], M_b0
  v_mfma_f32_32x32x16_bf16 v[80:95], a[156:159], a[148:151], v[80:95]
  s_waitcnt vmcnt(30) lgkmcnt(0)
  s_barrier
  v_mfma_f32_32x32x16_bf16 v[32:47], a[168:171], a[160:163], v[32:47]
  s_mov_b32 s86, 0xfffdc000
  s_mov_b32 s87, 0xfffe8000
  s_add_u32 s41, s31, 0x18000
  s_mov_b32 s44, 1720320
  s_add_u32 s42, s31, 0x1c000
  s_mov_b32 s45, 896
  v_mfma_f32_32x32x16_bf16 v[48:63], a[172:175], a[160:163], v[48:63]
  s_lshr_b32 s34, s31, 1
  s_and_b32 s34, s34, 0x800
  s_add_u32 s34, s34, s47
  s_add_u32 s34, s34, 0x0
  buffer_store_dwordx4 v[104:107], v22, s[16:19], s34 offen offset:1024 sc1
  s_addk_i32 s34, 0x1000
  buffer_store_dwordx4 v[108:111], v22, s[16:19], s34 offen offset:1024 sc1
  s_call_b64 s[48:49], M_b0
  v_mfma_f32_32x32x16_bf16 v[80:95], a[156:159], a[148:151], v[80:95]
  s_waitcnt vmcnt(26) lgkmcnt(0)
  s_barrier
  v_mfma_f32_32x32x16_bf16 v[32:47], a[168:171], a[160:163], v[32:47]
  s_mov_b32 s86, 0x4000
  s_mov_b32 s87, 0x4000
  s_add_u32 s41, s31, 0x24000
  s_mov_b32 s44, 1966080
  s_add_u32 s42, s31, 0x20000
  s_mov_b32 s45, 1024
  v_accvgpr_write_b32 a202, v138
  v_accvgpr_write_b32 a203, v139
  v_mfma_f32_32x32x16_bf16 v[48:63], a[172:175], a[160:163], v[48:63]
  v_accvgpr_write_b32 a204, v140
  v_accvgpr_write_b32 a205, v141
  v_accvgpr_write_b32 a206, v142
  v_accvgpr_write_b32 a207, v143
  v_accvgpr_write_b32 a208, v144
  v_accvgpr_write_b32 a209, v145
  v_accvgpr_write_b32 a210, v146
  v_accvgpr_write_b32 a211, v147
  s_call_b64 s[48:49], M_b0
  v_mfma_f32_32x32x16_bf16 v[80:95], a[156:159], a[148:151], v[80:95]
  s_waitcnt vmcnt(26) lgkmcnt(0)
  s_barrier
  v_mfma_f32_32x32x16_bf16 v[32:47], a[168:171], a[160:163], v[32:47]
  s_mov_b32 s86, 0xc000
  s_mov_b32 s87, 0x8000
  s_add_u32 s41, s31, 0x0
  s_mov_b32 s44, 2211840
  s_add_u32 s42, s31, 0x8000
  v_mfma_f32_32x32x16_bf16 v[48:63], a[172:175], a[160:163], v[48:63]
  s_mov_b32 s45, 1152
  s_and_b32 s34, s31, 0x1000
  s_add_u32 s34, s34, s47
  s_add_u32 s34, s34, 0x2000
  buffer_store_dwordx4 v[160:163], v22, s[16:19], s34 offen offset:0 sc1
  buffer_store_dwordx4 v[164:167], v22, s[16:19], s34 offen offset:1024 sc1
  s_call_b64 s[48:49], M_b0
  v_mfma_f32_32x32x16_bf16 v[80:95], a[156:159], a[148:151], v[80:95]
  s_waitcnt vmcnt(28) lgkmcnt(0)
  s_barrier
  v_mfma_f32_32x32x16_bf16 v[32:47], a[168:171], a[160:163], v[32:47]
  s_mov_b32 s86, 0xc000
  s_mov_b32 s87, 0x4000
  s_lshl_b32 s32, s28, 8
  s_add_u32 s8, s60, s32
  s_addc_u32 s9, s61, 0
  s_mov_b32 s11, 0x20000
  s_sub_u32 s10, 5242880, s32
  v_lshrrev_b32 v23, 4, v1
  v_lshlrev_b32 v24, 2, v23
  s_lshl_b32 s32, s30, 4
  v_add_u32 v23, s32, v23
  v_mul_u32_u24 v23, 8192, v23
  v_and_b32 v25, 15, v1
  v_xor_b32 v25, v25, v24
  v_lshl_add_u32 v6, v25, 4, v23
  v_add_u32 v7, 31744, v6
  v_add_u32 v8, 63488, v6
  v_add_u32 v9, 95232, v6
  v_xor_b32 v8, 32, v8
  v_mfma_f32_32x32x16_bf16 v[48:63], a[172:175], a[160:163], v[48:63]
  v_xor_b32 v9, 32, v9
  s_add_u32 s41, s31, 0x4000
  s_mov_b32 s44, 0
  s_mov_b32 s4, s56
  s_mov_b32 s5, s57
  s_mov_b32 s6, 0x280000
  s_mov_b32 s7, 0x20000
  s_add_u32 s42, s31, 0xc000
  s_add_u32 s45, s39, 0
  v_accvgpr_write_b32 a212, v148
  v_accvgpr_write_b32 a213, v149
  v_accvgpr_write_b32 a214, v150
  v_accvgpr_write_b32 a215, v151
  v_accvgpr_write_b32 a216, v152
  v_accvgpr_write_b32 a217, v153
  v_accvgpr_write_b32 a218, v154
  v_accvgpr_write_b32 a219, v155
  v_accvgpr_write_b32 a220, v156
  v_accvgpr_write_b32 a221, v157
  s_call_b64 s[48:49], M_b0
  v_mfma_f32_32x32x16_bf16 v[80:95], a[156:159], a[148:151], v[80:95]
  s_waitcnt vmcnt(26) lgkmcnt(0)
  s_barrier
  v_mfma_f32_32x32x16_bf16 v[32:47], a[168:171], a[160:163], v[32:47]
  s_mov_b32 s86, 0x4000
  s_mov_b32 s87, 0xc000
  s_add_u32 s41, s31, 0x10000
  s_mov_b32 s44, 524288
  s_add_u32 s42, s31, 0x14000
  v_mfma_f32_32x32x16_bf16 v[48:63], a[172:175], a[160:163], v[48:63]
  s_add_u32 s45, s40, 0
  s_and_b32 s34, s31, 0x1000
  s_add_u32 s34, s34, s47
  s_add_u32 s34, s34, 0x2000
  buffer_store_dwordx4 v[168:171], v22, s[16:19], s34 offen offset:2048 sc1
  buffer_store_dwordx4 v[172:175], v22, s[16:19], s34 offen offset:3072 sc1
  s_call_b64 s[48:49], M_b0
  v_mfma_f32_32x32x16_bf16 v[80:95], a[156:159], a[148:151], v[80:95]
  s_waitcnt vmcnt(28) lgkmcnt(0)
  s_barrier
  v_mfma_f32_32x32x16_bf16 v[32:47], a[168:171], a[160:163], v[32:47]
  s_mov_b32 s86, 0xfffe8000
  s_mov_b32 s87, 0xfffdc000
  s_mov_b32 s41, 0x30000
  s_brev_b32 s44, 1
  s_add_u32 s42, s31, 0x1c000
  s_add_u32 s45, s39, 128
  v_accvgpr_write_b32 a222, v158
  v_mfma_f32_32x32x16_bf16 v[48:63], a[172:175], a[160:163], v[48:63]
  v_accvgpr_write_b32 a223, v159
  v_accvgpr_write_b32 a104, v112
  v_accvgpr_write_b32 a105, v113
  v_accvgpr_write_b32 a106, v114
  v_accvgpr_write_b32 a107, v115
  v_accvgpr_write_b32 a108, v116
  v_accvgpr_write_b32 a109, v117
  v_accvgpr_write_b32 a110, v118
  s_call_b64 s[48:49], M_b0
  v_mfma_f32_32x32x16_bf16 v[80:95], a[156:159], a[148:151], v[80:95]
  s_waitcnt vmcnt(26) lgkmcnt(0)
  s_barrier
  v_mfma_f32_32x32x16_bf16 v[32:47], a[168:171], a[160:163], v[32:47]
  s_add_u32 s43, s31, 0x18000
  s_add_u32 s46, s40, 128
  s_mov_b32 m0, s43
  s_nop 0
  buffer_load_dwordx4 v2, s[4:7], s46 offen offset:0  lds
  buffer_load_dwordx4 v3, s[4:7], s46 offen offset:1024  lds
  buffer_load_dwordx4 v4, s[4:7], s46 offen offset:2048  lds
  buffer_load_dwordx4 v5, s[4:7], s46 offen offset:3072  lds
  s_add_u32 s41, s31, 0x20000
  s_mov_b32 s44, 1048576
  s_add_u32 s42, s31, 0x24000
  v_mfma_f32_32x32x16_bf16 v[48:63], a[172:175], a[160:163], v[48:63]
  s_add_u32 s45, s39, 256
  v_accvgpr_write_b32 a111, v119
  v_accvgpr_write_b32 a112, v120
  v_accvgpr_write_b32 a113, v121
  v_accvgpr_write_b32 a114, v122
  v_accvgpr_write_b32 a115, v123
  v_accvgpr_write_b32 a116, v124
  v_accvgpr_write_b32 a117, v125
  v_accvgpr_write_b32 a118, v126
  v_accvgpr_write_b32 a119, v127
  s_call_b64 s[48:49], M_b0
  v_mfma_f32_32x32x16_bf16 v[80:95], a[156:159], a[148:151], v[80:95]
  s_waitcnt vmcnt(20) lgkmcnt(0)
  s_barrier
  v_mfma_f32_32x32x16_bf16 v[32:47], a[168:171], a[160:163], v[32:47]
  s_add_u32 s41, s31, 0x8000
  s_add_u32 s44, s40, 256
  s_mov_b32 m0, s41
  v_and_b32 v23, 15, v1
  v_bfe_u32 v24, v1, 1, 3
  v_lshrrev_b32 v10, 4, v1
  v_xor_b32 v10, v10, v24
  v_lshlrev_b32 v10, 4, v10
  v_lshl_add_u32 v10, v23, 7, v10
  s_add_u32 s32, s31, 0x14000
  v_mfma_f32_32x32x16_bf16 v[48:63], a[172:175], a[160:163], v[48:63]
  buffer_load_dwordx4 v2, s[4:7], s44 offen offset:0  lds
  v_add_u32 v12, s32, v10
  s_add_u32 s32, s31, 0xc000
  v_add_u32 v10, s32, v10
  v_bfe_u32 v23, v1, 2, 2
  v_lshrrev_b32 v24, 4, v1
  v_lshlrev_b32 v14, 11, v24
  v_lshl_add_u32 v14, v23, 8, v14
  v_mfma_f32_32x32x16_bf16 v[64:79], a[168:171], a[164:167], v[64:79]
  buffer_load_dwordx4 v3, s[4:7], s44 offen offset:1024  lds
  v_lshl_add_u32 v14, v23, 6, v14
  v_and_b32 v24, 1, v24
  v_lshl_add_u32 v14, v24, 5, v14
  v_and_b32 v23, 3, v1
  v_lshl_add_u32 v14, v23, 3, v14
  v_add_u32 v14, 0x4000, v14
  v_xor_b32 v11, 64, v10
  v_mfma_f32_32x32x16_bf16 v[80:95], a[172:175], a[164:167], v[80:95]
  v_xor_b32 v13, 64, v12
  v_xor_b32 v15, 32, v14
  v_xor_b32 v16, 64, v14
  v_xor_b32 v17, 96, v14
  v_xor_b32 v18, 128, v14
  v_xor_b32 v19, 160, v14
  v_xor_b32 v20, 192, v14
  v_xor_b32 v21, 224, v14
  v_mfma_f32_32x32x16_bf16 v[32:47], a[184:187], a[176:179], v[32:47]
  buffer_load_dwordx4 v4, s[4:7], s44 offen offset:2048  lds
  ds_read_b128 a[8:11], v12 offset:0
  ds_read_b128 a[12:15], v12 offset:2048
  ds_read_b64_tr_b16 a[16:17], v14 offset:0
  ds_read_b64_tr_b16 a[18:19], v14 offset:1024
  ds_read_b64_tr_b16 a[20:21], v15 offset:0
  v_mfma_f32_32x32x16_bf16 v[48:63], a[188:191], a[176:179], v[48:63]
  ds_read_b64_tr_b16 a[22:23], v15 offset:1024
  ds_read_b64_tr_b16 a[24:25], v16 offset:0
  ds_read_b64_tr_b16 a[26:27], v16 offset:1024
  ds_read_b64_tr_b16 a[28:29], v17 offset:0
  ds_read_b64_tr_b16 a[30:31], v17 offset:1024
  v_mfma_f32_32x32x16_bf16 v[64:79], a[184:187], a[180:183], v[64:79]
  buffer_load_dwordx4 v5, s[4:7], s44 offen offset:3072  lds
  ds_read_b64_tr_b16 a[32:33], v18 offset:0
  ds_read_b64_tr_b16 a[34:35], v18 offset:1024
  ds_read_b64_tr_b16 a[36:37], v19 offset:0
  ds_read_b64_tr_b16 a[38:39], v19 offset:1024
  ds_read_b64_tr_b16 a[40:41], v20 offset:0
  v_mfma_f32_32x32x16_bf16 v[80:95], a[188:191], a[180:183], v[80:95]
  ds_read_b64_tr_b16 a[42:43], v20 offset:1024
  ds_read_b64_tr_b16 a[44:45], v21 offset:0
  ds_read_b64_tr_b16 a[46:47], v21 offset:1024
  ds_read_b128 a[0:3], v10 offset:0
  ds_read_b128 a[4:7], v10 offset:2048
  s_branch M_bdone
M_bv:
  v_mfma_f32_32x32x16_bf16 v[32:47], a[128:131], a[136:139], 0
  s_add_u32 s42, s31, 0x0
  s_mov_b32 s45, 512
  ds_read_b128 a[160:163], v12 offset:0
  ds_read_b64_tr_b16 a[168:169], v14 offset:8192
  s_mov_b32 s86, 0xc000
  s_mov_b32 s87, 0x4000
  v_cvt_pk_bf16_f32 v184, v208, v209
  v_cvt_pk_bf16_f32 v185, v210, v211
  v_cvt_pk_bf16_f32 v186, v212, v213
  v_cvt_pk_bf16_f32 v187, v214, v215
  v_cvt_pk_bf16_f32 v188, v216, v217
  v_cvt_pk_bf16_f32 v189, v218, v219
  v_cvt_pk_bf16_f32 v190, v220, v221
  v_cvt_pk_bf16_f32 v191, v222, v223
  v_cvt_pk_bf16_f32 v192, v224, v225
  v_cvt_pk_bf16_f32 v193, v226, v227
  v_mfma_f32_32x32x16_bf16 v[48:63], a[128:131], a[140:143], 0
  s_mov_b32 m0, s42
  ds_read_b64_tr_b16 a[170:171], v14 offset:9216
  ds_read_b128 a[164:167], v12 offset:4096
  v_cvt_pk_bf16_f32 v194, v228, v229
  v_cvt_pk_bf16_f32 v195, v230, v231
  v_cvt_pk_bf16_f32 v196, v232, v233
  v_cvt_pk_bf16_f32 v197, v234, v235
  v_cvt_pk_bf16_f32 v198, v236, v237
  v_cvt_pk_bf16_f32 v199, v238, v239
  v_cvt_pk_bf16_f32 v200, v240, v241
  v_cvt_pk_bf16_f32 v201, v242, v243
  v_cvt_pk_bf16_f32 v202, v244, v245
  v_cvt_pk_bf16_f32 v203, v246, v247
  v_cvt_pk_bf16_f32 v204, v248, v249
  v_mfma_f32_32x32x16_bf16 v[64:79], a[132:135], a[136:139], 0
  buffer_load_dwordx4 v2, s[4:7], s45 offen offset:0  lds
  ds_read_b64_tr_b16 a[172:173], v15 offset:8192
  ds_read_b64_tr_b16 a[174:175], v15 offset:9216
  v_cvt_pk_bf16_f32 v205, v250, v251
  v_cvt_pk_bf16_f32 v206, v252, v253
  v_cvt_pk_bf16_f32 v207, v254, v255
  v_accvgpr_read_b32 v224, a0
  v_accvgpr_read_b32 v225, a1
  v_accvgpr_read_b32 v226, a2
  v_accvgpr_read_b32 v227, a3
  v_accvgpr_read_b32 v228, a4
  v_accvgpr_read_b32 v229, a5
  v_accvgpr_read_b32 v230, a6
  v_accvgpr_read_b32 v231, a7
  v_mfma_f32_32x32x16_bf16 v[80:95], a[132:135], a[140:143], 0
  buffer_load_dwordx4 v3, s[4:7], s45 offen offset:1024  lds
  ds_read_b128 a[176:179], v13 offset:0
  ds_read_b64_tr_b16 a[184:185], v14 offset:12288
  v_accvgpr_read_b32 v232, a8
  v_accvgpr_read_b32 v233, a9
  v_accvgpr_read_b32 v234, a10
  v_accvgpr_read_b32 v235, a11
  v_accvgpr_read_b32 v236, a12
  v_accvgpr_read_b32 v237, a13
  v_accvgpr_read_b32 v238, a14
  v_accvgpr_read_b32 v239, a15
  v_cvt_pk_bf16_f32 v208, v224, v225
  v_cvt_pk_bf16_f32 v209, v226, v227
  v_cvt_pk_bf16_f32 v210, v228, v229
  v_mfma_f32_32x32x16_bf16 v[32:47], a[144:147], a[152:155], v[32:47]
  buffer_load_dwordx4 v4, s[4:7], s45 offen offset:2048  lds
  ds_read_b64_tr_b16 a[186:187], v14 offset:13312
  ds_read_b128 a[180:183], v13 offset:4096
  v_cvt_pk_bf16_f32 v211, v230, v231
  v_cvt_pk_bf16_f32 v212, v232, v233
  v_cvt_pk_bf16_f32 v213, v234, v235
  v_cvt_pk_bf16_f32 v214, v236, v237
  v_cvt_pk_bf16_f32 v215, v238, v239
  v_accvgpr_read_b32 v224, a16
  v_accvgpr_read_b32 v225, a17
  v_accvgpr_read_b32 v226, a18
  v_accvgpr_read_b32 v227, a19
  v_accvgpr_read_b32 v228, a20
  v_accvgpr_read_b32 v229, a21
  v_mfma_f32_32x32x16_bf16 v[48:63], a[144:147], a[156:159], v[48:63]
  buffer_load_dwordx4 v5, s[4:7], s45 offen offset:3072  lds
  ds_read_b64_tr_b16 a[188:189], v15 offset:12288
  ds_read_b64_tr_b16 a[190:191], v15 offset:13312
  v_accvgpr_read_b32 v230, a22
  v_accvgpr_read_b32 v231, a23
  v_accvgpr_read_b32 v232, a24
  v_accvgpr_read_b32 v233, a25
  v_accvgpr_read_b32 v234, a26
  v_accvgpr_read_b32 v235, a27
  v_accvgpr_read_b32 v236, a28
  v_accvgpr_read_b32 v237, a29
  v_accvgpr_read_b32 v238, a30
  v_accvgpr_read_b32 v239, a31
  v_cvt_pk_bf16_f32 v216, v224, v225
  v_mfma_f32_32x32x16_bf16 v[64:79], a[148:151], a[152:155], v[64:79]
  v_cvt_pk_bf16_f32 v217, v226, v227
  v_cvt_pk_bf16_f32 v218, v228, v229
  v_cvt_pk_bf16_f32 v219, v230, v231
  v_cvt_pk_bf16_f32 v220, v232, v233
  v_cvt_pk_bf16_f32 v221, v234, v235
  v_cvt_pk_bf16_f32 v222, v236, v237
  v_cvt_pk_bf16_f32 v223, v238, v239
  v_add_u32 v10, s86, v10
  v_add_u32 v11, s86, v11
  v_add_u32 v12, s86, v12
  v_add_u32 v13, s86, v13
  v_add_u32 v14, s87, v14
  v_add_u32 v15, s87, v15
  v_mfma_f32_32x32x16_bf16 v[80:95], a[148:151], a[156:159], v[80:95]
  s_waitcnt vmcnt(20) lgkmcnt(0)
  s_barrier
  v_mfma_f32_32x32x16_bf16 v[32:47], a[160:163], a[168:171], v[32:47]
  s_mov_b32 s86, 0x4000
  s_mov_b32 s87, 0xc000
  s_add_u32 s43, s31, 0x4000
  s_mov_b32 s46, 640
  s_mov_b32 m0, s43
  s_nop 0
  buffer_load_dwordx4 v2, s[4:7], s46 offen offset:0  lds
  buffer_load_dwordx4 v3, s[4:7], s46 offen offset:1024  lds
  buffer_load_dwordx4 v4, s[4:7], s46 offen offset:2048  lds
  buffer_load_dwordx4 v5, s[4:7], s46 offen offset:3072  lds
  s_add_u32 s41, s31, 0x8000
  v_mfma_f32_32x32x16_bf16 v[48:63], a[160:163], a[172:175], v[48:63]
  s_mov_b32 s44, 983040
  s_mov_b32 s42, 0x30000
  s_brev_b32 s45, 1
  s_lshr_b32 s34, s31, 1
  s_and_b32 s34, s34, 0x800
  s_add_u32 s34, s34, s47
  s_add_u32 s34, s34, 0x0
  buffer_store_dwordx4 v[96:99], v22, s[16:19], s34 offen offset:0 sc1
  s_addk_i32 s34, 0x1000
  buffer_store_dwordx4 v[100:103], v22, s[16:19], s34 offen offset:0 sc1
  s_call_b64 s[48:49], M_b1
  v_mfma_f32_32x32x16_bf16 v[80:95], a[148:151], a[156:159], v[80:95]
  s_waitcnt vmcnt(26) lgkmcnt(0)
  s_barrier
  v_mfma_f32_32x32x16_bf16 v[32:47], a[160:163], a[168:171], v[32:47]
  s_mov_b32 s86, 0xc000
  s_mov_b32 s87, 0x4000
  s_add_u32 s43, s31, 0xc000
  s_mov_b32 s46, 1228800
  s_mov_b32 m0, s43
  s_nop 0
  buffer_load_dwordx4 v6, s[8:11], s46 offen offset:0  lds
  buffer_load_dwordx4 v7, s[8:11], s46 offen offset:1024  lds
  buffer_load_dwordx4 v8, s[8:11], s46 offen offset:2048  lds
  buffer_load_dwordx4 v9, s[8:11], s46 offen offset:3072  lds
  s_add_u32 s41, s31, 0x14000
  s_mov_b32 s44, 1474560
  v_mfma_f32_32x32x16_bf16 v[48:63], a[160:163], a[172:175], v[48:63]
  s_add_u32 s42, s31, 0x10000
  s_mov_b32 s45, 768
  v_accvgpr_write_b32 a192, v128
  v_accvgpr_write_b32 a193, v129
  v_accvgpr_write_b32 a194, v130
  v_accvgpr_write_b32 a195, v131
  v_accvgpr_write_b32 a196, v132
  v_accvgpr_write_b32 a197, v133
  v_accvgpr_write_b32 a198, v134
  v_accvgpr_write_b32 a199, v135
  v_accvgpr_write_b32 a200, v136
  v_accvgpr_write_b32 a201, v137
  s_call_b64 s[48:49], M_b1
  v_mfma_f32_32x32x16_bf16 v[80:95], a[148:151], a[156:159], v[80:95]
  s_waitcnt vmcnt(30) lgkmcnt(0)
  s_barrier
  v_mfma_f32_32x32x16_bf16 v[32:47], a[160:163], a[168:171], v[32:47]
  s_mov_b32 s86, 0xfffdc000
  s_mov_b32 s87, 0xfffe8000
  s_add_u32 s41, s31, 0x18000
  s_mov_b32 s44, 1720320
  s_add_u32 s42, s31, 0x1c000
  s_mov_b32 s45, 896
  v_mfma_f32_32x32x16_bf16 v[48:63], a[160:163], a[172:175], v[48:63]
  s_lshr_b32 s34, s31, 1
  s_and_b32 s34, s34, 0x800
  s_add_u32 s34, s34, s47
  s_add_u32 s34, s34, 0x0
  buffer_store_dwordx4 v[104:107], v22, s[16:19], s34 offen offset:1024 sc1
  s_addk_i32 s34, 0x1000
  buffer_store_dwordx4 v[108:111], v22, s[16:19], s34 offen offset:1024 sc1
  s_call_b64 s[48:49], M_b1
  v_mfma_f32_32x32x16_bf16 v[80:95], a[148:151], a[156:159], v[80:95]
  s_waitcnt vmcnt(26) lgkmcnt(0)
  s_barrier
  v_mfma_f32_32x32x16_bf16 v[32:47], a[160:163], a[168:171], v[32:47]
  s_mov_b32 s86, 0x4000
  s_mov_b32 s87, 0x4000
  s_add_u32 s41, s31, 0x24000
  s_mov_b32 s44, 1966080
  s_add_u32 s42, s31, 0x20000
  s_mov_b32 s45, 1024
  v_accvgpr_write_b32 a202, v138
  v_accvgpr_write_b32 a203, v139
  v_mfma_f32_32x32x16_bf16 v[48:63], a[160:163], a[172:175], v[48:63]
  v_accvgpr_write_b32 a204, v140
  v_accvgpr_write_b32 a205, v141
  v_accvgpr_write_b32 a206, v142
  v_accvgpr_write_b32 a207, v143
  v_accvgpr_write_b32 a208, v144
  v_accvgpr_write_b32 a209, v145
  v_accvgpr_write_b32 a210, v146
  v_accvgpr_write_b32 a211, v147
  s_call_b64 s[48:49], M_b1
  v_mfma_f32_32x32x16_bf16 v[80:95], a[148:151], a[156:159], v[80:95]
  s_waitcnt vmcnt(26) lgkmcnt(0)
  s_barrier
  v_mfma_f32_32x32x16_bf16 v[32:47], a[160:163], a[168:171], v[32:47]
  s_mov_b32 s86, 0xc000
  s_mov_b32 s87, 0x8000
  s_add_u32 s41, s31, 0x0
  s_mov_b32 s44, 2211840
  s_add_u32 s42, s31, 0x8000
  v_mfma_f32_32x32x16_bf16 v[48:63], a[160:163], a[172:175], v[48:63]
  s_mov_b32 s45, 1152
  s_and_b32 s34, s31, 0x1000
  s_add_u32 s34, s34, s47
  s_add_u32 s34, s34, 0x2000
  buffer_store_dwordx4 v[160:163], v22, s[16:19], s34 offen offset:0 sc1
  buffer_store_dwordx4 v[164:167], v22, s[16:19], s34 offen offset:1024 sc1
  s_call_b64 s[48:49], M_b1
  v_mfma_f32_32x32x16_bf16 v[80:95], a[148:151], a[156:159], v[80:95]
  s_waitcnt vmcnt(28) lgkmcnt(0)
  s_barrier
  v_mfma_f32_32x32x16_bf16 v[32:47], a[160:163], a[168:171], v[32:47]
  s_mov_b32 s86, 0xc000
  s_mov_b32 s87, 0x4000
  s_lshl_b32 s32, s28, 8
  s_add_u32 s8, s60, s32
  s_addc_u32 s9, s61, 0
  s_mov_b32 s11, 0x20000
  s_sub_u32 s10, 5242880, s32
  v_lshrrev_b32 v23, 4, v1
  v_lshlrev_b32 v24, 2, v23
  s_lshl_b32 s32, s30, 4
  v_add_u32 v23, s32, v23
  v_mul_u32_u24 v23, 8192, v23
  v_and_b32 v25, 15, v1
  v_xor_b32 v25, v25, v24
  v_lshl_add_u32 v6, v25, 4, v23
  v_add_u32 v7, 31744, v6
  v_add_u32 v8, 63488, v6
  v_add_u32 v9, 95232, v6
  v_xor_b32 v8, 32, v8
  v_mfma_f32_32x32x16_bf16 v[48:63], a[160:163], a[172:175], v[48:63]
  v_xor_b32 v9, 32, v9
  s_add_u32 s41, s31, 0x4000
  s_mov_b32 s44, 0
  s_mov_b32 s4, s56
  s_mov_b32 s5, s57
  s_mov_b32 s6, 0x280000
  s_mov_b32 s7, 0x20000
  s_add_u32 s42, s31, 0xc000
  s_add_u32 s45, s39, 0
  v_accvgpr_write_b32 a212, v148
  v_accvgpr_write_b32 a213, v149
  v_accvgpr_write_b32 a214, v150
  v_accvgpr_write_b32 a215, v151
  v_accvgpr_write_b32 a216, v152
  v_accvgpr_write_b32 a217, v153
  v_accvgpr_write_b32 a218, v154
  v_accvgpr_write_b32 a219, v155
  v_accvgpr_write_b32 a220, v156
  v_accvgpr_write_b32 a221, v157
  s_call_b64 s[48:49], M_b1
  v_mfma_f32_32x32x16_bf16 v[80:95], a[148:151], a[156:159], v[80:95]
  s_waitcnt vmcnt(26) lgkmcnt(0)
  s_barrier
  v_mfma_f32_32x32x16_bf16 v[32:47], a[160:163], a[168:171], v[32:47]
  s_mov_b32 s86, 0x4000
  s_mov_b32 s87, 0xc000
  s_add_u32 s41, s31, 0x10000
  s_mov_b32 s44, 524288
  s_add_u32 s42, s31, 0x14000
  v_mfma_f32_32x32x16_bf16 v[48:63], a[160:163], a[172:175], v[48:63]
  s_add_u32 s45, s40, 0
  s_and_b32 s34, s31, 0x1000
  s_add_u32 s34, s34, s47
  s_add_u32 s34, s34, 0x2000
  buffer_store_dwordx4 v[168:171], v22, s[16:19], s34 offen offset:2048 sc1
  buffer_store_dwordx4 v[172:175], v22, s[16:19], s34 offen offset:3072 sc1
  s_call_b64 s[48:49], M_b1
  v_mfma_f32_32x32x16_bf16 v[80:95], a[148:151], a[156:159], v[80:95]
  s_waitcnt vmcnt(28) lgkmcnt(0)
  s_barrier
  v_mfma_f32_32x32x16_bf16 v[32:47], a[160:163], a[168:171], v[32:47]
  s_mov_b32 s86, 0xfffe8000
  s_mov_b32 s87, 0xfffdc000
  s_mov_b32 s41, 0x30000
  s_brev_b32 s44, 1
  s_add_u32 s42, s31, 0x1c000
  s_add_u32 s45, s39, 128
  v_accvgpr_write_b32 a222, v158
  v_mfma_f32_32x32x16_bf16 v[48:63], a[160:163], a[172:175], v[48:63]
  v_accvgpr_write_b32 a223, v159
  v_accvgpr_write_b32 a104, v112
  v_accvgpr_write_b32 a105, v113
  v_accvgpr_write_b32 a106, v114
  v_accvgpr_write_b32 a107, v115
  v_accvgpr_write_b32 a108, v116
  v_accvgpr_write_b32 a109, v117
  v_accvgpr_write_b32 a110, v118
  s_call_b64 s[48:49], M_b1
  v_mfma_f32_32x32x16_bf16 v[80:95], a[148:151], a[156:159], v[80:95]
  s_waitcnt vmcnt(26) lgkmcnt(0)
  s_barrier
  v_mfma_f32_32x32x16_bf16 v[32:47], a[160:163], a[168:171], v[32:47]
  s_add_u32 s43, s31, 0x18000
  s_add_u32 s46, s40, 128
  s_mov_b32 m0, s43
  s_nop 0
  buffer_load_dwordx4 v2, s[4:7], s46 offen offset:0  lds
  buffer_load_dwordx4 v3, s[4:7], s46 offen offset:1024  lds
  buffer_load_dwordx4 v4, s[4:7], s46 offen offset:2048  lds
  buffer_load_dwordx4 v5, s[4:7], s46 offen offset:3072  lds
  s_add_u32 s41, s31, 0x20000
  s_mov_b32 s44, 1048576
  s_add_u32 s42, s31, 0x24000
  v_mfma_f32_32x32x16_bf16 v[48:63], a[160:163], a[172:175], v[48:63]
  s_add_u32 s45, s39, 256
  v_accvgpr_write_b32 a111, v119
  v_accvgpr_write_b32 a112, v120
  v_accvgpr_write_b32 a113, v121
  v_accvgpr_write_b32 a114, v122
  v_accvgpr_write_b32 a115, v123
  v_accvgpr_write_b32 a116, v124
  v_accvgpr_write_b32 a117, v125
  v_accvgpr_write_b32 a118, v126
  v_accvgpr_write_b32 a119, v127
  s_call_b64 s[48:49], M_b1
  v_mfma_f32_32x32x16_bf16 v[80:95], a[148:151], a[156:159], v[80:95]
  s_waitcnt vmcnt(20) lgkmcnt(0)
  s_barrier
  v_mfma_f32_32x32x16_bf16 v[32:47], a[160:163], a[168:171], v[32:47]
  s_add_u32 s41, s31, 0x8000
  s_add_u32 s44, s40, 256
  s_mov_b32 m0, s41
  v_and_b32 v23, 15, v1
  v_bfe_u32 v24, v1, 1, 3
  v_lshrrev_b32 v10, 4, v1
  v_xor_b32 v10, v10, v24
  v_lshlrev_b32 v10, 4, v10
  v_lshl_add_u32 v10, v23, 7, v10
  s_add_u32 s32, s31, 0x14000
  v_mfma_f32_32x32x16_bf16 v[48:63], a[160:163], a[172:175], v[48:63]
  buffer_load_dwordx4 v2, s[4:7], s44 offen offset:0  lds
  v_add_u32 v12, s32, v10
  s_add_u32 s32, s31, 0xc000
  v_add_u32 v10, s32, v10
  v_bfe_u32 v23, v1, 2, 2
  v_lshrrev_b32 v24, 4, v1
  v_lshlrev_b32 v14, 11, v24
  v_lshl_add_u32 v14, v23, 8, v14
  v_mfma_f32_32x32x16_bf16 v[64:79], a[164:167], a[168:171], v[64:79]
  buffer_load_dwordx4 v3, s[4:7], s44 offen offset:1024  lds
  v_lshl_add_u32 v14, v23, 6, v14
  v_and_b32 v24, 1, v24
  v_lshl_add_u32 v14, v24, 5, v14
  v_and_b32 v23, 3, v1
  v_lshl_add_u32 v14, v23, 3, v14
  v_add_u32 v14, 0x4000, v14
  v_xor_b32 v11, 64, v10
  v_mfma_f32_32x32x16_bf16 v[80:95], a[164:167], a[172:175], v[80:95]
  v_xor_b32 v13, 64, v12
  v_xor_b32 v15, 32, v14
  v_xor_b32 v16, 64, v14
  v_xor_b32 v17, 96, v14
  v_xor_b32 v18, 128, v14
  v_xor_b32 v19, 160, v14
  v_xor_b32 v20, 192, v14
  v_xor_b32 v21, 224, v14
  v_mfma_f32_32x32x16_bf16 v[32:47], a[176:179], a[184:187], v[32:47]
  buffer_load_dwordx4 v4, s[4:7], s44 offen offset:2048  lds
  ds_read_b128 a[8:11], v12 offset:0
  ds_read_b128 a[12:15], v12 offset:2048
  ds_read_b64_tr_b16 a[16:17], v14 offset:0
  ds_read_b64_tr_b16 a[18:19], v14 offset:1024
  ds_read_b64_tr_b16 a[20:21], v15 offset:0
  v_mfma_f32_32x32x16_bf16 v[48:63], a[176:179], a[188:191], v[48:63]
  ds_read_b64_tr_b16 a[22:23], v15 offset:1024
  ds_read_b64_tr_b16 a[24:25], v16 offset:0
  ds_read_b64_tr_b16 a[26:27], v16 offset:1024
  ds_read_b64_tr_b16 a[28:29], v17 offset:0
  ds_read_b64_tr_b16 a[30:31], v17 offset:1024
  v_mfma_f32_32x32x16_bf16 v[64:79], a[180:183], a[184:187], v[64:79]
  buffer_load_dwordx4 v5, s[4:7], s44 offen offset:3072  lds
  ds_read_b64_tr_b16 a[32:33], v18 offset:0
  ds_read_b64_tr_b16 a[34:35], v18 offset:1024
  ds_read_b64_tr_b16 a[36:37], v19 offset:0
  ds_read_b64_tr_b16 a[38:39], v19 offset:1024
  ds_read_b64_tr_b16 a[40:41], v20 offset:0
  v_mfma_f32_32x32x16_bf16 v[80:95], a[180:183], a[188:191], v[80:95]
  ds_read_b64_tr_b16 a[42:43], v20 offset:1024
  ds_read_b64_tr_b16 a[44:45], v21 offset:0
  ds_read_b64_tr_b16 a[46:47], v21 offset:1024
  ds_read_b128 a[0:3], v10 offset:0
  ds_read_b128 a[4:7], v10 offset:2048
M_bdone:
  s_mul_i32 s32, s37, 491520
  s_lshl_b32 s33, s38, 13
  s_add_u32 s32, s32, s33
  s_add_u32 s24, s80, s32
  s_addc_u32 s25, s81, 0
  s_add_u32 s24, s24, 0x3000000
  s_addc_u32 s25, s25, 0
  s_mov_b32 s27, 0x20000
  s_cmp_lt_u32 s2, 240
  s_cselect_b32 s26, 491520, 0
  s_lshr_b32 s53, s30, 1
  s_mul_i32 s53, s53, 245760
  s_and_b32 s32, s31, 0x1000
  s_add_u32 s53, s53, s32
  s_add_u32 s42, s31, 0x0
  s_add_u32 s45, s39, 384
  s_mov_b32 s43, 0x30000
  s_brev_b32 s46, 1
  s_waitcnt lgkmcnt(0)
  v_mfma_f32_16x16x32_bf16 v[96:99], a[16:19], a[8:11], 0
  s_mov_b32 m0, s42
  ds_read_b128 a[56:59], v13 offset:0
  v_cvt_pk_bf16_f32 v224, v32, v33
  v_cvt_pk_bf16_f32 v225, v34, v35
  v_mfma_f32_16x16x32_bf16 v[128:131], a[16:19], a[12:15], 0
  buffer_load_dwordx4 v2, s[4:7], s45 offen offset:0  lds
  ds_read_b128 a[60:63], v13 offset:2048
  v_cvt_pk_bf16_f32 v226, v36, v37
  v_mfma_f32_16x16x32_bf16 v[100:103], a[20:23], a[8:11], 0
  ds_read_b64_tr_b16 a[64:65], v14 offset:8192
  v_cvt_pk_bf16_f32 v227, v38, v39
  v_cvt_pk_bf16_f32 v228, v40, v41
  v_mfma_f32_16x16x32_bf16 v[132:135], a[20:23], a[12:15], 0
  ds_read_b64_tr_b16 a[66:67], v14 offset:9216
  v_cvt_pk_bf16_f32 v229, v42, v43
  v_cvt_pk_bf16_f32 v230, v44, v45
  v_mfma_f32_16x16x32_bf16 v[104:107], a[24:27], a[8:11], 0
  buffer_load_dwordx4 v3, s[4:7], s45 offen offset:1024  lds
  ds_read_b64_tr_b16 a[68:69], v15 offset:8192
  v_mfma_f32_16x16x32_bf16 v[136:139], a[24:27], a[12:15], 0
  ds_read_b64_tr_b16 a[70:71], v15 offset:9216
  v_cvt_pk_bf16_f32 v231, v46, v47
  v_cvt_pk_bf16_f32 v232, v48, v49
  v_mfma_f32_16x16x32_bf16 v[108:111], a[28:31], a[8:11], 0
  ds_read_b64_tr_b16 a[72:73], v16 offset:8192
  v_cvt_pk_bf16_f32 v233, v50, v51
  v_cvt_pk_bf16_f32 v234, v52, v53
  v_mfma_f32_16x16x32_bf16 v[140:143], a[28:31], a[12:15], 0
  v_cvt_pk_bf16_f32 v235, v54, v55
  v_cvt_pk_bf16_f32 v236, v56, v57
  v_cvt_pk_bf16_f32 v237, v58, v59
  v_cvt_pk_bf16_f32 v238, v60, v61
  v_mfma_f32_16x16x32_bf16 v[112:115], a[32:35], a[8:11], 0
  buffer_load_dwordx4 v4, s[4:7], s45 offen offset:2048  lds
  ds_read_b64_tr_b16 a[74:75], v16 offset:9216
  v_cvt_pk_bf16_f32 v239, v62, v63
  v_mfma_f32_16x16x32_bf16 v[144:147], a[32:35], a[12:15], 0
  ds_read_b64_tr_b16 a[76:77], v17 offset:8192
  v_cvt_pk_bf16_f32 v240, v64, v65
  v_cvt_pk_bf16_f32 v241, v66, v67
  v_cvt_pk_bf16_f32 v242, v68, v69
  v_mfma_f32_16x16x32_bf16 v[116:119], a[36:39], a[8:11], 0
  ds_read_b64_tr_b16 a[78:79], v17 offset:9216
  v_cvt_pk_bf16_f32 v243, v70, v71
  v_cvt_pk_bf16_f32 v244, v72, v73
  v_cvt_pk_bf16_f32 v245, v74, v75
  v_mfma_f32_16x16x32_bf16 v[148:151], a[36:39], a[12:15], 0
  buffer_load_dwordx4 v5, s[4:7], s45 offen offset:3072  lds
  ds_read_b64_tr_b16 a[80:81], v18 offset:8192
  v_cvt_pk_bf16_f32 v246, v76, v77
  v_mfma_f32_16x16x32_bf16 v[120:123], a[40:43], a[8:11], 0
  ds_read_b64_tr_b16 a[82:83], v18 offset:9216
  v_cvt_pk_bf16_f32 v247, v78, v79
  v_cvt_pk_bf16_f32 v248, v80, v81
  v_cvt_pk_bf16_f32 v249, v82, v83
  v_mfma_f32_16x16x32_bf16 v[152:155], a[40:43], a[12:15], 0
  ds_read_b64_tr_b16 a[84:85], v19 offset:8192
  v_cvt_pk_bf16_f32 v250, v84, v85
  v_cvt_pk_bf16_f32 v251, v86, v87
  v_cvt_pk_bf16_f32 v252, v88, v89
  v_mfma_f32_16x16x32_bf16 v[124:127], a[44:47], a[8:11], 0
  ds_read_b64_tr_b16 a[86:87], v19 offset:9216
  v_cvt_pk_bf16_f32 v253, v90, v91
  v_cvt_pk_bf16_f32 v254, v92, v93
  v_cvt_pk_bf16_f32 v255, v94, v95
  v_mfma_f32_16x16x32_bf16 v[156:159], a[44:47], a[12:15], 0
  s_mov_b32 m0, s43
  v_mfma_f32_16x16x32_bf16 v[32:35], a[16:19], a[0:3], 0
  buffer_load_dwordx4 v6, s[8:11], s46 offen offset:0  lds
  ds_read_b64_tr_b16 a[88:89], v20 offset:8192
  s_mov_b32 s86, 0x10000
  s_mov_b32 s87, 0x4000
  s_mov_b32 s83, 0xc000
  v_mfma_f32_16x16x32_bf16 v[64:67], a[16:19], a[4:7], 0
  ds_read_b64_tr_b16 a[90:91], v20 offset:9216
  v_mfma_f32_16x16x32_bf16 v[36:39], a[20:23], a[0:3], 0
  ds_read_b64_tr_b16 a[92:93], v21 offset:8192
  v_mfma_f32_16x16x32_bf16 v[68:71], a[20:23], a[4:7], 0
  buffer_load_dwordx4 v7, s[8:11], s46 offen offset:1024  lds
  ds_read_b64_tr_b16 a[94:95], v21 offset:9216
  v_mfma_f32_16x16x32_bf16 v[40:43], a[24:27], a[0:3], 0
  ds_read_b128 a[48:51], v11 offset:0
  v_mfma_f32_16x16x32_bf16 v[72:75], a[24:27], a[4:7], 0
  ds_read_b128 a[52:55], v11 offset:2048
  v_mfma_f32_16x16x32_bf16 v[44:47], a[28:31], a[0:3], 0
  v_mfma_f32_16x16x32_bf16 v[76:79], a[28:31], a[4:7], 0
  buffer_load_dwordx4 v8, s[8:11], s46 offen offset:2048  lds
  v_mfma_f32_16x16x32_bf16 v[48:51], a[32:35], a[0:3], 0
  v_mfma_f32_16x16x32_bf16 v[80:83], a[32:35], a[4:7], 0
  v_add_u32 v10, s86, v10
  v_add_u32 v12, s87, v12
  v_mfma_f32_16x16x32_bf16 v[52:55], a[36:39], a[0:3], 0
  buffer_load_dwordx4 v9, s[8:11], s46 offen offset:3072  lds
  v_add_u32 v14, s83, v14
  v_xor_b32 v11, 64, v10
  v_mfma_f32_16x16x32_bf16 v[84:87], a[36:39], a[4:7], 0
  v_xor_b32 v13, 64, v12
  v_xor_b32 v15, 32, v14
  v_mfma_f32_16x16x32_bf16 v[56:59], a[40:43], a[0:3], 0
  v_xor_b32 v16, 64, v14
  v_xor_b32 v17, 96, v14
  v_mfma_f32_16x16x32_bf16 v[88:91], a[40:43], a[4:7], 0
  v_xor_b32 v18, 128, v14
  v_xor_b32 v19, 160, v14
  v_mfma_f32_16x16x32_bf16 v[60:63], a[44:47], a[0:3], 0
  v_xor_b32 v20, 192, v14
  v_xor_b32 v21, 224, v14
  v_mfma_f32_16x16x32_bf16 v[92:95], a[44:47], a[4:7], 0
  s_waitcnt vmcnt(20) lgkmcnt(0)
  s_barrier
  v_mfma_f32_16x16x32_bf16 v[96:99], a[64:67], a[56:59], v[96:99]
  s_mov_b32 s86, 0x8000
  s_mov_b32 s87, 0xffff0000
  v_mfma_f32_16x16x32_bf16 v[128:131], a[64:67], a[60:63], v[128:131]
  s_mov_b32 s83, 0x10000
  s_add_u32 s41, s31, 0xc000
  s_add_u32 s44, s40, 384
  v_mfma_f32_16x16x32_bf16 v[100:103], a[68:71], a[56:59], v[100:103]
  s_add_u32 s42, s31, 0x14000
  s_add_u32 s45, s39, 512
  s_add_u32 s43, s31, 0x4000
  v_mfma_f32_16x16x32_bf16 v[132:135], a[68:71], a[60:63], v[132:135]
  s_mov_b32 s46, 1572864
  v_cmp_gt_u32 vcc, 1, v29
  s_nop 0
  s_cbranch_vccnz M_poll_1
M_poll_1_r:
  s_cmp_lg_u32 s30, 0
  s_cbranch_scc1 M_pub_2
  s_lshl_b32 s32, s2, 7
  v_mov_b32 v23, 1
  v_lshlrev_b32 v24, 2, v1
  s_mov_b32 exec_hi, 0
  buffer_store_dword v23, v24, s[20:23], s32 offen sc1
  s_mov_b64 exec, -1
M_pub_2:
  v_mfma_f32_16x16x32_bf16 v[104:107], a[72:75], a[56:59], v[104:107]
  s_add_u32 s34, s53, 0x0
  buffer_store_dwordx4 v[224:227], v22, s[24:27], s34 offen offset:0 sc1
  buffer_store_dwordx4 v[228:231], v22, s[24:27], s34 offen offset:1024 sc1
  s_call_b64 s[48:49], M_q
  v_mfma_f32_16x16x32_bf16 v[92:95], a[44:47], a[4:7], v[92:95]
  s_waitcnt vmcnt(22) lgkmcnt(0)
  s_barrier
  v_mfma_f32_16x16x32_bf16 v[96:99], a[64:67], a[56:59], v[96:99]
  s_mov_b32 s86, 0xfffdc000
  s_mov_b32 s87, 0x4000
  v_mfma_f32_16x16x32_bf16 v[128:131], a[64:67], a[60:63], v[128:131]
  s_mov_b32 s83, 0xfffe4000
  s_add_u32 s41, s31, 0x1c000
  v_mfma_f32_16x16x32_bf16 v[100:103], a[68:71], a[56:59], v[100:103]
  s_add_u32 s44, s40, 512
  s_add_u32 s42, s31, 0x18000
  s_add_u32 s45, s39, 640
  v_mfma_f32_16x16x32_bf16 v[132:135], a[68:71], a[60:63], v[132:135]
  s_add_u32 s43, s31, 0x10000
  s_mov_b32 s46, 2097152
  v_mfma_f32_16x16x32_bf16 v[104:107], a[72:75], a[56:59], v[104:107]
  s_add_u32 s34, s53, 0x0
  buffer_store_dwordx4 v[232:235], v22, s[24:27], s34 offen offset:2048 sc1
  buffer_store_dwordx4 v[236:239], v22, s[24:27], s34 offen offset:3072 sc1
  s_call_b64 s[48:49], M_q
  v_mfma_f32_16x16x32_bf16 v[92:95], a[44:47], a[4:7], v[92:95]
  s_waitcnt vmcnt(14) lgkmcnt(0)
  s_barrier
  v_mfma_f32_16x16x32_bf16 v[96:99], a[64:67], a[56:59], v[96:99]
  s_mov_b32 s86, 0x14000
  s_mov_b32 s87, 0x10000
  v_mfma_f32_16x16x32_bf16 v[128:131], a[64:67], a[60:63], v[128:131]
  s_mov_b32 s83, 0xc000
  s_add_u32 s41, s31, 0x24000
  v_mfma_f32_16x16x32_bf16 v[100:103], a[68:71], a[56:59], v[100:103]
  s_add_u32 s44, s40, 640
  s_add_u32 s42, s31, 0x8000
  s_add_u32 s45, s39, 768
  v_mfma_f32_16x16x32_bf16 v[132:135], a[68:71], a[60:63], v[132:135]
  s_add_u32 s43, s31, 0x20000
  s_mov_b32 s46, 2621440
  v_mfma_f32_16x16x32_bf16 v[104:107], a[72:75], a[56:59], v[104:107]
  s_add_u32 s34, s53, 0x1e000
  buffer_store_dwordx4 v[240:243], v22, s[24:27], s34 offen offset:0 sc1
  buffer_store_dwordx4 v[244:247], v22, s[24:27], s34 offen offset:1024 sc1
  s_call_b64 s[48:49], M_q
  v_mfma_f32_16x16x32_bf16 v[92:95], a[44:47], a[4:7], v[92:95]
  s_waitcnt vmcnt(14) lgkmcnt(0)
  s_barrier
  v_mfma_f32_16x16x32_bf16 v[96:99], a[64:67], a[56:59], v[96:99]
  s_mov_b32 s86, 0x4000
  s_mov_b32 s87, 0x8000
  v_mfma_f32_16x16x32_bf16 v[128:131], a[64:67], a[60:63], v[128:131]
  s_mov_b32 s83, 0x10000
  s_add_u32 s41, s31, 0x0
  v_mfma_f32_16x16x32_bf16 v[100:103], a[68:71], a[56:59], v[100:103]
  s_add_u32 s44, s40, 768
  s_add_u32 s42, s31, 0xc000
  s_add_u32 s45, s39, 896
  v_mfma_f32_16x16x32_bf16 v[132:135], a[68:71], a[60:63], v[132:135]
  s_add_u32 s43, s31, 0x4000
  s_mov_b32 s46, 3145728
  v_mfma_f32_16x16x32_bf16 v[104:107], a[72:75], a[56:59], v[104:107]
  s_add_u32 s34, s53, 0x1e000
  buffer_store_dwordx4 v[248:251], v22, s[24:27], s34 offen offset:2048 sc1
  buffer_store_dwordx4 v[252:255], v22, s[24:27], s34 offen offset:3072 sc1
  s_call_b64 s[48:49], M_q
  v_mfma_f32_16x16x32_bf16 v[92:95], a[44:47], a[4:7], v[92:95]
  s_waitcnt vmcnt(14) lgkmcnt(0)
  s_barrier
  v_mfma_f32_16x16x32_bf16 v[96:99], a[64:67], a[56:59], v[96:99]
  s_mov_b32 s86, 0xffff0000
  s_mov_b32 s87, 0xfffdc000
  s_mov_b32 s83, 0xfffe4000
  s_add_u32 s41, s31, 0x14000
  v_mfma_f32_16x16x32_bf16 v[128:131], a[64:67], a[60:63], v[128:131]
  s_add_u32 s44, s40, 896
  s_add_u32 s42, s31, 0x1c000
  s_add_u32 s45, s39, 1024
  s_add_u32 s43, s31, 0x10000
  v_mfma_f32_16x16x32_bf16 v[100:103], a[68:71], a[56:59], v[100:103]
  s_mov_b32 s46, 3670016
  v_and_b32 v23, 7, v1
  v_lshlrev_b32 v23, 10, v23
  s_andn2_b32 s32, s2, 0x38
  s_lshl_b32 s32, s32, 7
  v_mfma_f32_16x16x32_bf16 v[132:135], a[68:71], a[60:63], v[132:135]
  buffer_load_dword v26, v23, s[20:23], s32 offen sc1
  v_accvgpr_write_b32 a224, v192
  v_accvgpr_write_b32 a225, v193
  v_accvgpr_write_b32 a226, v194
  v_mfma_f32_16x16x32_bf16 v[104:107], a[72:75], a[56:59], v[104:107]
  v_accvgpr_write_b32 a227, v195
  v_accvgpr_write_b32 a228, v196
  v_accvgpr_write_b32 a229, v197
  v_accvgpr_write_b32 a230, v198
  v_accvgpr_write_b32 a231, v199
  s_call_b64 s[48:49], M_q
  v_mfma_f32_16x16x32_bf16 v[92:95], a[44:47], a[4:7], v[92:95]
  s_waitcnt vmcnt(13) lgkmcnt(0)
  s_barrier
  v_mfma_f32_16x16x32_bf16 v[96:99], a[64:67], a[56:59], v[96:99]
  s_mov_b32 s86, 0x4000
  s_mov_b32 s87, 0x14000
  s_mov_b32 s83, 0xc000
  s_add_u32 s41, s31, 0x18000
  s_add_u32 s44, s40, 1024
  v_mfma_f32_16x16x32_bf16 v[128:131], a[64:67], a[60:63], v[128:131]
  s_add_u32 s42, s31, 0x24000
  s_add_u32 s45, s39, 1152
  s_add_u32 s43, s31, 0x20000
  s_mov_b32 s46, 4194304
  s_cmp_lg_u32 s30, 0
  s_cbranch_scc1 M_pub_3
  s_lshl_b32 s32, s2, 7
  v_mov_b32 v23, 2
  v_lshlrev_b32 v24, 2, v1
  s_mov_b32 exec_hi, 0
  buffer_store_dword v23, v24, s[20:23], s32 offen sc1
  s_mov_b64 exec, -1
M_pub_3:
  v_mfma_f32_16x16x32_bf16 v[100:103], a[68:71], a[56:59], v[100:103]
  s_lshl_b32 s32, s36, 2
  s_add_u32 s32, s32, s30
  s_lshl_b32 s32, s32, 9
  v_and_b32 v23, 3, v1
  v_lshl_add_u32 v23, v23, 7, s32
  v_mfma_f32_16x16x32_bf16 v[132:135], a[68:71], a[60:63], v[132:135]
  v_min_u32 v23, M_codeend-M_pc0-4, v23
  global_load_dword v28, v23, s[96:97]
  v_accvgpr_write_b32 a232, v200
  v_accvgpr_write_b32 a233, v201
  v_accvgpr_write_b32 a234, v202
  v_mfma_f32_16x16x32_bf16 v[104:107], a[72:75], a[56:59], v[104:107]
  v_accvgpr_write_b32 a235, v203
  v_accvgpr_write_b32 a236, v204
  v_accvgpr_write_b32 a237, v205
  v_accvgpr_write_b32 a238, v206
  v_accvgpr_write_b32 a239, v207
  s_call_b64 s[48:49], M_q
  v_mfma_f32_16x16x32_bf16 v[92:95], a[44:47], a[4:7], v[92:95]
  s_waitcnt vmcnt(13) lgkmcnt(0)
  s_barrier
  v_mfma_f32_16x16x32_bf16 v[96:99], a[64:67], a[56:59], v[96:99]
  s_mov_b32 s86, 0x10000
  s_mov_b32 s87, 0x4000
  s_mov_b32 s83, 0x10000
  s_add_u32 s41, s31, 0x8000
  s_add_u32 s44, s40, 1152
  v_mfma_f32_16x16x32_bf16 v[128:131], a[64:67], a[60:63], v[128:131]
  s_mov_b32 s42, 0x30000
  s_brev_b32 s45, 1
  s_add_u32 s43, s31, 0x0
  s_mov_b32 s46, 4718592
  v_cmp_gt_u32 vcc, 1, v26
  s_nop 0
  s_cbranch_vccnz M_poll_4
M_poll_4_r:
  v_mfma_f32_16x16x32_bf16 v[100:103], a[68:71], a[56:59], v[100:103]
  s_lshr_b32 s34, s31, 1
  s_and_b32 s34, s34, 0x800
  s_add_u32 s34, s34, s47
  s_add_u32 s34, s34, 0x40000
  buffer_store_dwordx4 a[104:107], v22, s[16:19], s34 offen offset:0 sc1
  v_mfma_f32_16x16x32_bf16 v[132:135], a[68:71], a[60:63], v[132:135]
  s_addk_i32 s34, 0x1000
  buffer_store_dwordx4 a[108:111], v22, s[16:19], s34 offen offset:0 sc1
  v_accvgpr_write_b32 a240, v208
  v_accvgpr_write_b32 a241, v209
  v_accvgpr_write_b32 a242, v210
  v_mfma_f32_16x16x32_bf16 v[104:107], a[72:75], a[56:59], v[104:107]
  v_accvgpr_write_b32 a243, v211
  v_accvgpr_write_b32 a244, v212
  v_accvgpr_write_b32 a245, v213
  v_accvgpr_write_b32 a246, v214
  v_accvgpr_write_b32 a247, v215
  s_call_b64 s[48:49], M_q
  v_mfma_f32_16x16x32_bf16 v[92:95], a[44:47], a[4:7], v[92:95]
  s_waitcnt vmcnt(14) lgkmcnt(0)
  s_barrier
  v_mfma_f32_16x16x32_bf16 v[96:99], a[64:67], a[56:59], v[96:99]
  s_mov_b32 s86, 0x8000
  s_mov_b32 s87, 0xffff0000
  s_mov_b32 s83, 0xfffe0000
  s_mov_b32 s41, 0x30000
  s_brev_b32 s44, 1
  s_mov_b32 s42, 0x30000
  v_mfma_f32_16x16x32_bf16 v[128:131], a[64:67], a[60:63], v[128:131]
  s_brev_b32 s45, 1
  s_mov_b32 s43, 0x30000
  s_brev_b32 s46, 1
  v_min_u32 v23, 29, v1
  v_lshlrev_b32 v23, 10, v23
  s_lshl_b32 s32, s35, 7
  buffer_load_dword v26, v23, s[20:23], s32 offen sc1
  v_mfma_f32_16x16x32_bf16 v[100:103], a[68:71], a[56:59], v[100:103]
  s_lshr_b32 s34, s31, 1
  s_and_b32 s34, s34, 0x800
  s_add_u32 s34, s34, s47
  s_add_u32 s34, s34, 0x40000
  buffer_store_dwordx4 a[112:115], v22, s[16:19], s34 offen offset:1024 sc1
  s_addk_i32 s34, 0x1000
  v_mfma_f32_16x16x32_bf16 v[132:135], a[68:71], a[60:63], v[132:135]
  buffer_store_dwordx4 a[116:119], v22, s[16:19], s34 offen offset:1024 sc1
  s_and_b32 s34, s31, 0x1000
  s_add_u32 s34, s34, s47
  s_add_u32 s34, s34, 0x42000
  buffer_store_dwordx4 v[176:179], v22, s[16:19], s34 offen offset:0 sc1
  buffer_store_dwordx4 v[180:183], v22, s[16:19], s34 offen offset:1024 sc1
  v_accvgpr_write_b32 a248, v216
  v_mfma_f32_16x16x32_bf16 v[104:107], a[72:75], a[56:59], v[104:107]
  v_accvgpr_write_b32 a249, v217
  v_accvgpr_write_b32 a250, v218
  v_accvgpr_write_b32 a251, v219
  v_accvgpr_write_b32 a252, v220
  v_accvgpr_write_b32 a253, v221
  v_accvgpr_write_b32 a254, v222
  v_accvgpr_write_b32 a255, v223
  s_call_b64 s[48:49], M_q
  v_mfma_f32_16x16x32_bf16 v[92:95], a[44:47], a[4:7], v[92:95]
  s_waitcnt vmcnt(17) lgkmcnt(0)
  s_barrier
  v_mfma_f32_16x16x32_bf16 v[96:99], a[64:67], a[56:59], v[96:99]
  s_mov_b32 s41, 0x30000
  s_brev_b32 s44, 1
  v_mfma_f32_16x16x32_bf16 v[128:131], a[64:67], a[60:63], v[128:131]
  s_mov_b32 s42, 0x30000
  s_brev_b32 s45, 1
  v_mfma_f32_16x16x32_bf16 v[100:103], a[68:71], a[56:59], v[100:103]
  s_mov_b32 s43, 0x30000
  s_brev_b32 s46, 1
  v_mfma_f32_16x16x32_bf16 v[132:135], a[68:71], a[60:63], v[132:135]
  s_and_b32 s34, s31, 0x1000
  s_add_u32 s34, s34, s47
  v_mfma_f32_16x16x32_bf16 v[104:107], a[72:75], a[56:59], v[104:107]
  s_add_u32 s34, s34, 0x42000
  buffer_store_dwordx4 v[184:187], v22, s[16:19], s34 offen offset:2048 sc1
  buffer_store_dwordx4 v[188:191], v22, s[16:19], s34 offen offset:3072 sc1
  s_call_b64 s[48:49], M_q
  v_mfma_f32_16x16x32_bf16 v[92:95], a[44:47], a[4:7], v[92:95]
  s_waitcnt lgkmcnt(0)
  s_barrier
  v_mfma_f32_16x16x32_bf16 v[96:99], a[64:67], a[56:59], v[96:99]
  s_mov_b32 s86, 0x3e0293ee
  s_mov_b32 s87, s86
  v_mfma_f32_16x16x32_bf16 v[128:131], a[64:67], a[60:63], v[128:131]
  s_mov_b32 s51, 0x3fb8aa3b
  s_lshl_b32 s32, s28, 20
  s_add_u32 s24, s80, s32
  v_mfma_f32_16x16x32_bf16 v[100:103], a[68:71], a[56:59], v[100:103]
  s_addc_u32 s25, s81, 0
  s_mov_b32 s27, 0x20000
  v_mfma_f32_16x16x32_bf16 v[132:135], a[68:71], a[60:63], v[132:135]
  s_lshl_b32 s32, s29, 16
  s_sub_u32 s26, 0x100000, s32
  s_lshl_b32 s94, s30, 11
  v_mfma_f32_16x16x32_bf16 v[104:107], a[72:75], a[56:59], v[104:107]
  v_add_u32 v2, s94, v22
  s_add_u32 m0, s94, 0x0
  s_mov_b32 s34, 0x0
  buffer_load_dwordx4 v2, s[24:27], s34 offen offset:0 sc1 lds
  buffer_load_dwordx4 v2, s[24:27], s34 offen offset:1024 sc1 lds
  v_mfma_f32_16x16x32_bf16 v[136:139], a[72:75], a[60:63], v[136:139]
  s_add_u32 m0, s94, 0x4000
  s_mov_b32 s34, 0x4000
  buffer_load_dwordx4 v2, s[24:27], s34 offen offset:0 sc1 lds
  buffer_load_dwordx4 v2, s[24:27], s34 offen offset:1024 sc1 lds
  v_mfma_f32_16x16x32_bf16 v[108:111], a[76:79], a[56:59], v[108:111]
  s_waitcnt vmcnt(34)
  v_cmp_gt_u32 vcc, 2, v26
  s_nop 0
  s_cbranch_vccnz M_poll_5
M_poll_5_r:
  s_lshl_b32 s50, s35, 3
  s_lshl_b32 s32, s30, 1
  v_mfma_f32_16x16x32_bf16 v[140:143], a[76:79], a[60:63], v[140:143]
  s_add_u32 s50, s50, s32
  s_mul_i32 s32, s50, 122880
  s_add_u32 s12, s80, s32
  v_mfma_f32_16x16x32_bf16 v[112:115], a[80:83], a[56:59], v[112:115]
  s_addc_u32 s13, s81, 0
  s_add_u32 s12, s12, 0x3000000
  v_mfma_f32_16x16x32_bf16 v[144:147], a[80:83], a[60:63], v[144:147]
  s_addc_u32 s13, s13, 0
  s_mov_b32 s14, 0x3c000
  s_mov_b32 s15, 0x20000
  v_mfma_f32_16x16x32_bf16 v[116:119], a[84:87], a[56:59], v[116:119]
  s_mul_i32 s32, s36, 5
  s_lshr_b32 s32, s32, 2
  v_mfma_f32_16x16x32_bf16 v[148:151], a[84:87], a[60:63], v[148:151]
  s_add_u32 s32, s32, 40
  s_lshl_b32 s32, s32, 10
  buffer_load_dwordx4 a[128:131], v22, s[12:15], s32 offen offset:0 sc1
  v_mfma_f32_16x16x32_bf16 v[120:123], a[88:91], a[56:59], v[120:123]
  buffer_load_dwordx4 a[132:135], v22, s[12:15], s32 offen offset:1024 sc1
  s_add_u32 s32, s32, 122880
  buffer_load_dwordx4 a[136:139], v22, s[12:15], s32 offen offset:0 sc1
  v_mfma_f32_16x16x32_bf16 v[152:155], a[88:91], a[60:63], v[152:155]
  buffer_load_dwordx4 a[140:143], v22, s[12:15], s32 offen offset:1024 sc1
  s_mul_i32 s32, s36, 20
  v_mfma_f32_16x16x32_bf16 v[124:127], a[92:95], a[56:59], v[124:127]
  v_and_b32 v25, 31, v1
  v_add_u32 v24, s32, v25
  v_lshrrev_b32 v30, 5, v24
  v_mfma_f32_16x16x32_bf16 v[156:159], a[92:95], a[60:63], v[156:159]
  v_lshlrev_b32 v30, 11, v30
  v_and_b32 v24, 31, v24
  v_lshl_add_u32 v30, v24, 4, v30
  v_mfma_f32_16x16x32_bf16 v[32:35], a[64:67], a[48:51], v[32:35]
  v_and_b32 v24, 32, v1
  v_lshl_add_u32 v30, v24, 4, v30
  v_mfma_f32_16x16x32_bf16 v[64:67], a[64:67], a[52:55], v[64:67]
  v_bfrev_b32 v24, 1
  v_cmp_gt_u32 vcc, 20, v25
  s_nop 1
  v_cndmask_b32 v30, v24, v30, vcc
  v_mfma_f32_16x16x32_bf16 v[36:39], a[68:71], a[48:51], v[36:39]
  s_mov_b32 s32, 81920
  buffer_load_dwordx4 a[144:147], v30, s[12:15], s32 offen offset:0 sc1
  v_mfma_f32_16x16x32_bf16 v[68:71], a[68:71], a[52:55], v[68:71]
  buffer_load_dwordx4 a[148:151], v30, s[12:15], s32 offen offset:1024 sc1
  s_mov_b32 s32, 204800
  buffer_load_dwordx4 a[152:155], v30, s[12:15], s32 offen offset:0 sc1
  v_mfma_f32_16x16x32_bf16 v[40:43], a[72:75], a[48:51], v[40:43]
  buffer_load_dwordx4 a[156:159], v30, s[12:15], s32 offen offset:1024 sc1
  s_lshr_b32 s38, s30, 1
  s_lshl_b32 s38, s38, 13
  v_mfma_f32_16x16x32_bf16 v[72:75], a[72:75], a[52:55], v[72:75]
  s_add_u32 s38, s38, s31
  s_add_u32 s38, s38, 73728
  v_mfma_f32_16x16x32_bf16 v[44:47], a[76:79], a[48:51], v[44:47]
  v_add_u32 v23, s38, v22
  ds_write_b128 v23, a[96:99]
  ds_write_b128 v23, a[100:103] offset:1024
  v_mfma_f32_16x16x32_bf16 v[76:79], a[76:79], a[52:55], v[76:79]
  s_and_b32 s32, s36, 3
  s_mul_i32 s32, s32, 160
  s_sub_u32 s32, s38, s32
  v_mfma_f32_16x16x32_bf16 v[48:51], a[80:83], a[48:51], v[48:51]
  s_addk_i32 s32, 480
  v_lshrrev_b32 v23, 5, v1
  v_mfma_f32_16x16x32_bf16 v[80:83], a[80:83], a[52:55], v[80:83]
  v_bfe_u32 v24, v1, 2, 2
  v_lshl_add_u32 v23, v23, 2, v24
  v_mul_u32_u24 v23, 40, v23
  v_mfma_f32_16x16x32_bf16 v[52:55], a[84:87], a[48:51], v[52:55]
  v_add_u32 v23, s32, v23
  v_bfe_u32 v24, v1, 4, 1
  v_mfma_f32_16x16x32_bf16 v[84:87], a[84:87], a[52:55], v[84:87]
  v_lshl_add_u32 v25, v24, 4, v23
  v_bfe_u32 v24, v1, 1, 1
  v_lshl_add_u32 v25, v24, 3, v25
  v_mfma_f32_16x16x32_bf16 v[56:59], a[88:91], a[48:51], v[56:59]
  ds_read_b64_tr_b16 v[240:241], v25 offset:0
  ds_read_b64_tr_b16 v[242:243], v25 offset:320
  ds_read_b64_tr_b16 v[244:245], v25 offset:640
  v_mfma_f32_16x16x32_bf16 v[88:91], a[88:91], a[52:55], v[88:91]
  ds_read_b64_tr_b16 v[246:247], v25 offset:960
  ds_read_b64_tr_b16 v[248:249], v23 offset:32
  v_mfma_f32_16x16x32_bf16 v[60:63], a[92:95], a[48:51], v[60:63]
  ds_read_b64_tr_b16 v[250:251], v23 offset:352
  ds_read_b64_tr_b16 v[252:253], v23 offset:672
  ds_read_b64_tr_b16 v[254:255], v23 offset:992
  v_mfma_f32_16x16x32_bf16 v[92:95], a[92:95], a[52:55], v[92:95]
  v_bfe_u32 v31, v1, 2, 1
  v_mul_u32_u24 v31, 0x8000, v31
  v_lshl_or_b32 v31, v31, 16, v31
  s_add_u32 m0, s94, 0x8000
  s_mov_b32 s34, 0x8000
  buffer_load_dwordx4 v2, s[24:27], s34 offen offset:0 sc1 lds
  v_pk_mul_f32 v[96:97], v[96:97], s[86:87]
  v_pk_mul_f32 v[98:99], v[98:99], s[86:87]
  v_pk_mul_f32 v[100:101], v[100:101], s[86:87]
  v_pk_mul_f32 v[102:103], v[102:103], s[86:87]
  v_pk_mul_f32 v[104:105], v[104:105], s[86:87]
  v_pk_mul_f32 v[106:107], v[106:107], s[86:87]
  v_pk_mul_f32 v[108:109], v[108:109], s[86:87]
  v_pk_mul_f32 v[110:111], v[110:111], s[86:87]
  buffer_load_dwordx4 v2, s[24:27], s34 offen offset:1024 sc1 lds
  v_pk_mul_f32 v[112:113], v[112:113], s[86:87]
  v_pk_mul_f32 v[114:115], v[114:115], s[86:87]
  v_pk_mul_f32 v[116:117], v[116:117], s[86:87]
  v_pk_mul_f32 v[118:119], v[118:119], s[86:87]
  v_pk_mul_f32 v[120:121], v[120:121], s[86:87]
  v_pk_mul_f32 v[122:123], v[122:123], s[86:87]
  v_pk_mul_f32 v[124:125], v[124:125], s[86:87]
  v_pk_mul_f32 v[126:127], v[126:127], s[86:87]
  s_add_u32 m0, s94, 0x2000
  s_mov_b32 s34, 0x2000
  buffer_load_dwordx4 v2, s[24:27], s34 offen offset:0 sc1 lds
  v_cvt_pk_bf16_f32 v192, v96, v97
  v_cvt_pk_bf16_f32 v193, v98, v99
  v_cvt_pk_bf16_f32 v194, v100, v101
  v_cvt_pk_bf16_f32 v195, v102, v103
  v_cvt_pk_bf16_f32 v196, v104, v105
  v_cvt_pk_bf16_f32 v197, v106, v107
  v_cvt_pk_bf16_f32 v198, v108, v109
  v_cvt_pk_bf16_f32 v199, v110, v111
  v_cvt_pk_bf16_f32 v200, v112, v113
  buffer_load_dwordx4 v2, s[24:27], s34 offen offset:1024 sc1 lds
  v_cvt_pk_bf16_f32 v201, v114, v115
  v_cvt_pk_bf16_f32 v202, v116, v117
  v_cvt_pk_bf16_f32 v203, v118, v119
  v_cvt_pk_bf16_f32 v204, v120, v121
  v_cvt_pk_bf16_f32 v205, v122, v123
  v_cvt_pk_bf16_f32 v206, v124, v125
  v_cvt_pk_bf16_f32 v207, v126, v127
  v_pk_mul_f32 v[128:129], v[128:129], s[86:87]
  s_add_u32 m0, s94, 0x6000
  s_mov_b32 s34, 0x6000
  buffer_load_dwordx4 v2, s[24:27], s34 offen offset:0 sc1 lds
  v_pk_mul_f32 v[130:131], v[130:131], s[86:87]
  v_pk_mul_f32 v[132:133], v[132:133], s[86:87]
  v_pk_mul_f32 v[134:135], v[134:135], s[86:87]
  v_pk_mul_f32 v[136:137], v[136:137], s[86:87]
  v_pk_mul_f32 v[138:139], v[138:139], s[86:87]
  v_pk_mul_f32 v[140:141], v[140:141], s[86:87]
  v_pk_mul_f32 v[142:143], v[142:143], s[86:87]
  v_pk_mul_f32 v[144:145], v[144:145], s[86:87]
  v_pk_mul_f32 v[146:147], v[146:147], s[86:87]
  buffer_load_dwordx4 v2, s[24:27], s34 offen offset:1024 sc1 lds
  v_pk_mul_f32 v[148:149], v[148:149], s[86:87]
  v_pk_mul_f32 v[150:151], v[150:151], s[86:87]
  v_pk_mul_f32 v[152:153], v[152:153], s[86:87]
  v_pk_mul_f32 v[154:155], v[154:155], s[86:87]
  v_pk_mul_f32 v[156:157], v[156:157], s[86:87]
  v_pk_mul_f32 v[158:159], v[158:159], s[86:87]
  v_cvt_pk_bf16_f32 v208, v128, v129
  v_cvt_pk_bf16_f32 v209, v130, v131
  s_add_u32 m0, s94, 0xc000
  s_mov_b32 s34, 0xc000
  buffer_load_dwordx4 v2, s[24:27], s34 offen offset:0 sc1 lds
  v_cvt_pk_bf16_f32 v210, v132, v133
  v_cvt_pk_bf16_f32 v211, v134, v135
  v_cvt_pk_bf16_f32 v212, v136, v137
  v_cvt_pk_bf16_f32 v213, v138, v139
  v_cvt_pk_bf16_f32 v214, v140, v141
  v_cvt_pk_bf16_f32 v215, v142, v143
  v_cvt_pk_bf16_f32 v216, v144, v145
  v_cvt_pk_bf16_f32 v217, v146, v147
  v_cvt_pk_bf16_f32 v218, v148, v149
  buffer_load_dwordx4 v2, s[24:27], s34 offen offset:1024 sc1 lds
  v_cvt_pk_bf16_f32 v219, v150, v151
  v_cvt_pk_bf16_f32 v220, v152, v153
  v_cvt_pk_bf16_f32 v221, v154, v155
  v_cvt_pk_bf16_f32 v222, v156, v157
  v_cvt_pk_bf16_f32 v223, v158, v159
  v_pk_mul_f32 v[32:33], v[32:33], s[86:87]
  v_pk_mul_f32 v[34:35], v[34:35], s[86:87]
  v_pk_mul_f32 v[36:37], v[36:37], s[86:87]
  s_add_u32 m0, s94, 0x10000
  s_mov_b32 s34, 0x10000
  buffer_load_dwordx4 v2, s[24:27], s34 offen offset:0 sc1 lds
  v_pk_mul_f32 v[38:39], v[38:39], s[86:87]
  v_pk_mul_f32 v[40:41], v[40:41], s[86:87]
  v_pk_mul_f32 v[42:43], v[42:43], s[86:87]
  v_pk_mul_f32 v[44:45], v[44:45], s[86:87]
  v_pk_mul_f32 v[46:47], v[46:47], s[86:87]
  v_pk_mul_f32 v[48:49], v[48:49], s[86:87]
  v_pk_mul_f32 v[50:51], v[50:51], s[86:87]
  v_pk_mul_f32 v[52:53], v[52:53], s[86:87]
  v_pk_mul_f32 v[54:55], v[54:55], s[86:87]
  buffer_load_dwordx4 v2, s[24:27], s34 offen offset:1024 sc1 lds
  v_pk_mul_f32 v[56:57], v[56:57], s[86:87]
  v_pk_mul_f32 v[58:59], v[58:59], s[86:87]
  v_pk_mul_f32 v[60:61], v[60:61], s[86:87]
  v_pk_mul_f32 v[62:63], v[62:63], s[86:87]
  v_cvt_pk_bf16_f32 v160, v32, v33
  v_cvt_pk_bf16_f32 v161, v34, v35
  v_cvt_pk_bf16_f32 v162, v36, v37
  v_cvt_pk_bf16_f32 v163, v38, v39
  s_add_u32 m0, s94, 0x14000
  s_mov_b32 s34, 0x14000
  buffer_load_dwordx4 v2, s[24:27], s34 offen offset:0 sc1 lds
  v_cvt_pk_bf16_f32 v164, v40, v41
  v_cvt_pk_bf16_f32 v165, v42, v43
  v_cvt_pk_bf16_f32 v166, v44, v45
  v_cvt_pk_bf16_f32 v167, v46, v47
  v_cvt_pk_bf16_f32 v168, v48, v49
  v_cvt_pk_bf16_f32 v169, v50, v51
  v_cvt_pk_bf16_f32 v170, v52, v53
  v_cvt_pk_bf16_f32 v171, v54, v55
  v_cvt_pk_bf16_f32 v172, v56, v57
  buffer_load_dwordx4 v2, s[24:27], s34 offen offset:1024 sc1 lds
  v_cvt_pk_bf16_f32 v173, v58, v59
  v_cvt_pk_bf16_f32 v174, v60, v61
  v_cvt_pk_bf16_f32 v175, v62, v63
  v_pk_mul_f32 v[64:65], v[64:65], s[86:87]
  v_pk_mul_f32 v[66:67], v[66:67], s[86:87]
  v_pk_mul_f32 v[68:69], v[68:69], s[86:87]
  v_pk_mul_f32 v[70:71], v[70:71], s[86:87]
  v_pk_mul_f32 v[72:73], v[72:73], s[86:87]
  s_add_u32 m0, s94, 0xa000
  s_mov_b32 s34, 0xa000
  buffer_load_dwordx4 v2, s[24:27], s34 offen offset:0 sc1 lds
  v_pk_mul_f32 v[74:75], v[74:75], s[86:87]
  v_pk_mul_f32 v[76:77], v[76:77], s[86:87]
  v_pk_mul_f32 v[78:79], v[78:79], s[86:87]
  v_pk_mul_f32 v[80:81], v[80:81], s[86:87]
  v_pk_mul_f32 v[82:83], v[82:83], s[86:87]
  v_pk_mul_f32 v[84:85], v[84:85], s[86:87]
  v_pk_mul_f32 v[86:87], v[86:87], s[86:87]
  v_pk_mul_f32 v[88:89], v[88:89], s[86:87]
  v_pk_mul_f32 v[90:91], v[90:91], s[86:87]
  buffer_load_dwordx4 v2, s[24:27], s34 offen offset:1024 sc1 lds
  v_pk_mul_f32 v[92:93], v[92:93], s[86:87]
  v_pk_mul_f32 v[94:95], v[94:95], s[86:87]
  v_cvt_pk_bf16_f32 v176, v64, v65
  v_cvt_pk_bf16_f32 v177, v66, v67
  v_cvt_pk_bf16_f32 v178, v68, v69
  v_cvt_pk_bf16_f32 v179, v70, v71
  v_cvt_pk_bf16_f32 v180, v72, v73
  v_cvt_pk_bf16_f32 v181, v74, v75
  s_add_u32 m0, s94, 0xe000
  s_mov_b32 s34, 0xe000
  buffer_load_dwordx4 v2, s[24:27], s34 offen offset:0 sc1 lds
  v_cvt_pk_bf16_f32 v182, v76, v77
  v_cvt_pk_bf16_f32 v183, v78, v79
  v_cvt_pk_bf16_f32 v184, v80, v81
  v_cvt_pk_bf16_f32 v185, v82, v83
  v_cvt_pk_bf16_f32 v186, v84, v85
  v_cvt_pk_bf16_f32 v187, v86, v87
  v_cvt_pk_bf16_f32 v188, v88, v89
  v_cvt_pk_bf16_f32 v189, v90, v91
  v_cvt_pk_bf16_f32 v190, v92, v93
  buffer_load_dwordx4 v2, s[24:27], s34 offen offset:1024 sc1 lds
  v_cvt_pk_bf16_f32 v191, v94, v95
  s_waitcnt lgkmcnt(7)
  v_xor_b32 v240, v240, v31
  v_xor_b32 v241, v241, v31
  s_waitcnt lgkmcnt(6)
  v_xor_b32 v242, v242, v31
  v_xor_b32 v243, v243, v31
  s_waitcnt lgkmcnt(5)
  v_xor_b32 v244, v244, v31
  v_xor_b32 v245, v245, v31
  s_waitcnt lgkmcnt(4)
  v_xor_b32 v246, v246, v31
  s_lshr_b32 s32, s2, 1
  s_mul_i32 s32, s32, 40960
  s_and_b32 s33, s2, 1
  s_lshl2_add_u32 s33, s33, s30
  s_mul_i32 s33, s33, 160
  s_add_u32 s32, s32, s33
  s_add_u32 s4, s66, s32
  s_addc_u32 s5, s67, 0
  s_mov_b32 s7, 0x20000
  s_sub_u32 s6, 5242880, s32
  s_lshl_b32 s33, s30, 13
  s_add_u32 m0, s33, 0x20000
  v_add_u32 v23, 0, v1
  v_mul_u32_u24 v24, 0x199a, v23
  v_lshrrev_b32 v24, 16, v24
  v_mul_u32_u24 v24, 1120, v24
  v_lshl_add_u32 v23, v23, 4, v24
  buffer_load_dwordx4 v23, s[4:7], 0 offen lds
  s_add_u32 m0, m0, 0x400
  v_add_u32 v23, 64, v1
  v_mul_u32_u24 v24, 0x199a, v23
  v_lshrrev_b32 v24, 16, v24
  v_mul_u32_u24 v24, 1120, v24
  v_lshl_add_u32 v23, v23, 4, v24
  buffer_load_dwordx4 v23, s[4:7], 0 offen lds
  s_add_u32 m0, m0, 0x400
  v_add_u32 v23, 128, v1
  v_mul_u32_u24 v24, 0x199a, v23
  v_lshrrev_b32 v24, 16, v24
  v_mul_u32_u24 v24, 1120, v24
  v_lshl_add_u32 v23, v23, 4, v24
  buffer_load_dwordx4 v23, s[4:7], 0 offen lds
  s_add_u32 m0, m0, 0x400
  v_add_u32 v23, 192, v1
  v_mul_u32_u24 v24, 0x199a, v23
  v_lshrrev_b32 v24, 16, v24
  v_mul_u32_u24 v24, 1120, v24
  v_lshl_add_u32 v23, v23, 4, v24
  buffer_load_dwordx4 v23, s[4:7], 0 offen lds
  s_add_u32 m0, m0, 0x400
  v_add_u32 v23, 256, v1
  v_mul_u32_u24 v24, 0x199a, v23
  v_lshrrev_b32 v24, 16, v24
  v_mul_u32_u24 v24, 1120, v24
  v_lshl_add_u32 v23, v23, 4, v24
  buffer_load_dwordx4 v23, s[4:7], 0 offen lds
  s_add_u32 m0, m0, 0x400
  s_mul_i32 s39, s2, 0x667
  s_lshr_b32 s39, s39, 16
  s_mul_i32 s32, s39, 40
  s_sub_u32 s40, s2, s32
  s_lshl2_add_u32 s39, s39, s30
  s_mul_i32 s34, s39, 0x3334
  s_lshr_b32 s34, s34, 16
  s_mul_i32 s33, s34, 5
  s_sub_u32 s33, s39, s33
  s_mul_i32 s34, s34, 160
  s_mul_i32 s32, s33, 40
  s_cmp_eq_u32 s33, 4
  s_cselect_b32 s32, 16, s32
  s_cselect_b64 vcc, -1, 0
  s_add_u32 s32, s32, s34
  s_mul_i32 s32, s32, 40
  s_add_u32 s32, s32, s40
  s_lshl_b32 s32, s32, 5
  s_mov_b32 s4, s74
  s_mov_b32 s5, s75
  s_mov_b32 s6, 0xc8000
  s_mov_b32 s7, 0x20000
  v_lshrrev_b32 v23, 5, v1
  v_mul_u32_u24 v23, 20, v23
  v_bfe_u32 v24, v1, 3, 1
  v_lshl_add_u32 v23, v24, 3, v23
  v_bfe_u32 v24, v1, 4, 1
  v_lshl_add_u32 v23, v24, 2, v23
  v_lshrrev_b32 v24, 3, v1
  v_mul_u32_u24 v24, 20, v24
  v_cndmask_b32 v23, v23, v24, vcc
  v_bfe_u32 v24, v1, 1, 2
  v_add_u32 v23, v23, v24
  v_mul_u32_u24 v23, 1280, v23
  v_and_b32 v24, 1, v1
  v_lshl_add_u32 v23, v24, 4, v23
  buffer_load_dwordx4 v23, s[4:7], s32 offen lds
  s_mul_i32 s32, s40, 0x3334
  s_lshr_b32 s32, s32, 16
  s_mul_i32 s32, s32, 95
  s_add_u32 s32, s32, s40
  s_mul_i32 s39, s39, 5
  s_add_u32 s32, s32, s39
  s_lshl_b32 s32, s32, 10
  s_add_u32 s32, s32, 0x600000
  s_cmp_lt_u32 s2, 200
  s_cselect_b32 s53, s32, 0x10000000
  s_and_b32 s32, s2, 1
  s_lshl_b32 s32, s32, 1
  s_lshr_b32 s33, s30, 1
  s_add_u32 s32, s32, s33
  s_lshl_b32 s32, s32, 8
  s_andn2_b32 s33, s2, 1
  s_add_u32 s32, s32, s33
  s_and_b32 s33, s30, 1
  s_add_u32 s32, s32, s33
  s_mul_i32 s83, s32, 5120
  v_xor_b32 v247, v247, v31
  s_waitcnt lgkmcnt(3)
  v_xor_b32 v248, v248, v31
  v_xor_b32 v249, v249, v31
  s_waitcnt lgkmcnt(2)
  v_xor_b32 v250, v250, v31
  v_xor_b32 v251, v251, v31
  s_waitcnt lgkmcnt(1)
  v_xor_b32 v252, v252, v31
  v_xor_b32 v253, v253, v31
  s_waitcnt lgkmcnt(0)
  v_xor_b32 v254, v254, v31
  v_xor_b32 v255, v255, v31
  s_waitcnt vmcnt(29)
  v_mfma_f32_32x32x16_bf16 v[48:63], v[240:243], a[128:131], 0
  s_waitcnt vmcnt(28)
  v_mfma_f32_32x32x16_bf16 v[48:63], v[244:247], a[132:135], v[48:63]
  v_mfma_f32_32x32x16_bf16 v[64:79], v[248:251], a[128:131], 0
  v_mfma_f32_32x32x16_bf16 v[64:79], v[252:255], a[132:135], v[64:79]
  s_call_b64 s[48:49], M_phi
  v_mov_b32 v32, 0
  v_mov_b32 v33, 0
  v_mov_b32 v34, 0
  v_mov_b32 v35, 0
  v_and_b32 v25, 31, v1
  s_mov_b32 s32, s38
  v_mul_u32_u24 v31, 48, v1
  v_add_u32 v31, s32, v31
  v_lshrrev_b32 v24, 5, v1
  v_mfma_f32_32x32x16_bf16 a[0:15], v[32:35], v[32:35], 0
  v_bfe_u32 v28, v1, 2, 2
  v_lshl_add_u32 v28, v24, 2, v28
  v_mul_u32_u24 v28, 48, v28
  v_bfe_u32 v24, v1, 4, 1
  v_lshl_add_u32 v28, v24, 5, v28
  v_and_b32 v24, 3, v1
  v_lshl_add_u32 v28, v24, 3, v28
  v_add_u32 v28, s32, v28
  v_mfma_f32_32x32x16_bf16 a[16:31], v[32:35], v[32:35], 0
  v_mov_b32 v23, 0x3f803f80
  v_cmp_eq_u32 vcc, 20, v25
  ds_write_b128 v31, v[80:83]
  ds_write_b128 v31, v[84:87] offset:16
  ds_write_b64 v31, v[88:89] offset:32
  ds_read_b64_tr_b16 v[224:225], v28 offset:0
  ds_read_b64_tr_b16 v[226:227], v28 offset:384
  ds_read_b64_tr_b16 v[228:229], v28 offset:768
  ds_read_b64_tr_b16 v[230:231], v28 offset:1152
  ds_read_b64_tr_b16 v[232:233], v28 offset:1536
  ds_read_b64_tr_b16 v[234:235], v28 offset:1920
  ds_read_b64_tr_b16 v[236:237], v28 offset:2304
  ds_read_b64_tr_b16 v[238:239], v28 offset:2688
  s_waitcnt vmcnt(25)
  v_accvgpr_read_b32 v96, a144
  v_accvgpr_read_b32 v97, a145
  v_accvgpr_read_b32 v98, a146
  v_accvgpr_read_b32 v99, a147
  s_waitcnt vmcnt(24)
  v_accvgpr_read_b32 v100, a148
  v_accvgpr_read_b32 v101, a149
  v_mfma_f32_32x32x16_bf16 a[32:47], v[32:35], v[32:35], 0
  v_accvgpr_read_b32 v102, a150
  v_accvgpr_read_b32 v103, a151
  s_waitcnt vmcnt(23)
  v_accvgpr_read_b32 v104, a152
  v_accvgpr_read_b32 v105, a153
  v_accvgpr_read_b32 v106, a154
  v_accvgpr_read_b32 v107, a155
  v_mfma_f32_32x32x16_bf16 a[48:63], v[32:35], v[32:35], 0
  s_waitcnt vmcnt(22)
  v_accvgpr_read_b32 v108, a156
  v_accvgpr_read_b32 v109, a157
  v_accvgpr_read_b32 v110, a158
  v_accvgpr_read_b32 v111, a159
  v_cndmask_b32 v96, v96, v23, vcc
  v_cndmask_b32 v97, v97, v23, vcc
  v_cndmask_b32 v98, v98, v23, vcc
  v_cndmask_b32 v99, v99, v23, vcc
  v_cndmask_b32 v100, v100, v23, vcc
  v_cndmask_b32 v101, v101, v23, vcc
  v_mfma_f32_32x32x16_bf16 a[64:79], v[32:35], v[32:35], 0
  v_cndmask_b32 v102, v102, v23, vcc
  v_cndmask_b32 v103, v103, v23, vcc
  v_cndmask_b32 v104, v104, v23, vcc
  v_cndmask_b32 v105, v105, v23, vcc
  v_cndmask_b32 v106, v106, v23, vcc
  v_cndmask_b32 v107, v107, v23, vcc
  v_mfma_f32_32x32x16_bf16 a[80:95], v[32:35], v[32:35], 0
  v_cndmask_b32 v108, v108, v23, vcc
  v_cndmask_b32 v109, v109, v23, vcc
  v_cndmask_b32 v110, v110, v23, vcc
  v_cndmask_b32 v111, v111, v23, vcc
  v_mfma_f32_32x32x16_bf16 v[48:63], v[240:243], a[136:139], 0
  v_mfma_f32_32x32x16_bf16 v[48:63], v[244:247], a[140:143], v[48:63]
  v_mfma_f32_32x32x16_bf16 v[64:79], v[248:251], a[136:139], 0
  v_mfma_f32_32x32x16_bf16 v[64:79], v[252:255], a[140:143], v[64:79]
  s_waitcnt lgkmcnt(6)
  v_mfma_f32_32x32x16_bf16 v[112:127], v[224:227], v[96:99], 0
  s_waitcnt lgkmcnt(2)
  v_mfma_f32_32x32x16_bf16 v[128:143], v[232:235], v[96:99], 0
  v_mfma_f32_32x32x16_bf16 v[112:127], v[228:231], v[100:103], v[112:127]
  s_waitcnt lgkmcnt(0)
  v_mfma_f32_32x32x16_bf16 v[128:143], v[236:239], v[100:103], v[128:143]
  s_call_b64 s[48:49], M_phi
  ds_write_b128 v31, v[80:83]
  ds_write_b128 v31, v[84:87] offset:16
  ds_write_b64 v31, v[88:89] offset:32
  ds_read_b64_tr_b16 v[224:225], v28 offset:0
  ds_read_b64_tr_b16 v[226:227], v28 offset:384
  ds_read_b64_tr_b16 v[228:229], v28 offset:768
  ds_read_b64_tr_b16 v[230:231], v28 offset:1152
  ds_read_b64_tr_b16 v[232:233], v28 offset:1536
  ds_read_b64_tr_b16 v[234:235], v28 offset:1920
  ds_read_b64_tr_b16 v[236:237], v28 offset:2304
  ds_read_b64_tr_b16 v[238:239], v28 offset:2688
  v_mfma_f32_32x32x16_bf16 a[96:111], v[32:35], v[32:35], 0
  v_lshrrev_b32 v23, 5, v1
  v_lshlrev_b32 v30, 10, v23
  v_lshl_add_u32 v30, v25, 4, v30
  v_and_b32 v3, 15, v1
  v_lshrrev_b32 v23, 4, v1
  v_lshlrev_b32 v23, 2, v23
  v_sub_u32 v3, v3, v23
  v_mov_b32 v4, 0xf149f2ca
  v_mov_b32 v8, 0
  v_mov_b32 v12, 0x3f803f80
  v_mov_b32 v9, 0
  v_mov_b32 v13, 0x3f803f80
  v_mov_b32 v10, 0
  v_mov_b32 v14, 0x3f803f80
  v_mov_b32 v11, 0
  v_mov_b32 v15, 0x3f803f80
  v_mfma_f32_32x32x16_bf16 a[112:127], v[32:35], v[32:35], 0
  s_mul_i32 s32, s30, 6144
  s_add_u32 s32, s32, 98304
  v_add_u32 v24, s32, v22
  s_waitcnt lgkmcnt(6)
  v_mfma_f32_32x32x16_bf16 v[112:127], v[224:227], v[104:107], v[112:127]
  s_waitcnt lgkmcnt(2)
  v_mfma_f32_32x32x16_bf16 v[128:143], v[232:235], v[104:107], v[128:143]
  v_mfma_f32_32x32x16_bf16 v[112:127], v[228:231], v[108:111], v[112:127]
  s_waitcnt lgkmcnt(0)
  v_mfma_f32_32x32x16_bf16 v[128:143], v[236:239], v[108:111], v[128:143]
  s_lshl_b32 s32, s36, 3
  s_add_u32 s32, s32, s35
  s_lshl_b32 s32, s32, 13
  s_add_u32 s4, s80, s32
  s_addc_u32 s5, s81, 0
  s_add_u32 s4, s4, 0x4400000
  s_addc_u32 s5, s5, 0
  s_mov_b32 s6, 0x1400
  s_mov_b32 s7, 0x20000
  s_add_u32 s8, s80, 0x2000000
  s_addc_u32 s9, s81, 0
  s_mov_b32 s10, 0x1000000
  s_mov_b32 s11, 0x20000
  s_lshl_b32 s32, s30, 10
  s_add_u32 s32, s32, 98304
  v_mov_b32 v6, v22
  v_add_u32 v7, 0x4000, v22
  ds_write_b128 v24, v[112:115] offset:0
  ds_write_b128 v24, v[116:119] offset:1024
  ds_write_b128 v24, v[120:123] offset:2048
  ds_write_b128 v24, v[128:131] offset:3072
  ds_write_b128 v24, v[132:135] offset:4096
  ds_write_b128 v24, v[136:139] offset:5120
  v_add_u32 v24, s32, v22
  s_waitcnt vmcnt(16) lgkmcnt(0)
  s_barrier
  ds_read_b128 a[128:131], v6 offset:0
  ds_read_b128 a[132:135], v6 offset:1024
  ds_read_b128 a[136:139], v6 offset:2048
  ds_read_b128 a[140:143], v6 offset:3072
  ds_read_b128 a[144:147], v6 offset:4096
  ds_read_b128 a[148:151], v6 offset:5120
  ds_read_b128 a[152:155], v6 offset:6144
  ds_read_b128 a[156:159], v6 offset:7168
  ds_read_b128 v[128:131], v24 offset:0
  ds_read_b128 v[132:135], v24 offset:6144
  ds_read_b128 v[136:139], v24 offset:12288
  ds_read_b128 v[140:143], v24 offset:18432
  ds_read_b128 v[144:147], v24 offset:4096
  ds_read_b128 v[148:151], v24 offset:10240
  ds_read_b128 v[152:155], v24 offset:16384
  ds_read_b128 v[156:159], v24 offset:22528
  s_cmp_eq_u32 s30, 3
  s_cselect_b32 s52, 512, s94
  s_add_u32 s34, s94, 2560
  s_waitcnt lgkmcnt(15)
  v_mfma_f32_16x16x32_bf16 v[32:35], a[128:131], v[160:163], 0
  s_mov_b32 s44, 0x5f800000
  v_mfma_f32_16x16x32_bf16 v[40:43], a[128:131], v[176:179], 0
  s_lshl_b32 s32, s29, 2
  v_mfma_f32_16x16x32_bf16 v[48:51], a[128:131], v[192:195], 0
  s_waitcnt lgkmcnt(6)
  v_add_f32 v128, v128, v132
  s_add_u32 s43, s32, s30
  s_sub_u32 s42, 60, s32
  v_mfma_f32_16x16x32_bf16 v[56:59], a[128:131], v[208:211], 0
  s_waitcnt lgkmcnt(4)
  v_add_f32 v136, v136, v140
  v_add_f32 v129, v129, v133
  s_add_u32 s42, s42, s30
  v_mfma_f32_16x16x32_bf16 v[32:35], a[132:135], v[164:167], v[32:35]
  v_add_f32 v137, v137, v141
  v_add_f32 v130, v130, v134
  s_add_u32 s95, s32, 4
  v_mfma_f32_16x16x32_bf16 v[40:43], a[132:135], v[180:183], v[40:43]
  v_add_f32 v138, v138, v142
  s_mov_b32 s54, 0
  s_mov_b32 s55, 3
  v_mfma_f32_16x16x32_bf16 v[48:51], a[132:135], v[196:199], v[48:51]
  v_add_f32 v131, v131, v135
  v_add_f32 v139, v139, v143
  s_bitset1_b64 s[54:55], s95
  v_mfma_f32_16x16x32_bf16 v[56:59], a[132:135], v[212:215], v[56:59]
  v_add_f32 v128, v128, v136
  s_bitset1_b64 s[54:55], s43
  s_add_u32 s32, s43, 1
  v_mfma_f32_16x16x32_bf16 v[32:35], a[136:139], v[168:171], v[32:35]
  v_add_f32 v129, v129, v137
  v_add_f32 v130, v130, v138
  s_bitset1_b64 s[54:55], s32
  v_mfma_f32_16x16x32_bf16 v[40:43], a[136:139], v[184:187], v[40:43]
  v_add_f32 v131, v131, v139
  s_waitcnt lgkmcnt(2)
  v_add_f32 v144, v144, v148
  s_and_b32 s41, s30, 1
  v_mfma_f32_16x16x32_bf16 v[48:51], a[136:139], v[200:203], v[48:51]
  s_waitcnt lgkmcnt(0)
  v_add_f32 v152, v152, v156
  s_sub_u32 s41, s41, s95
  s_add_u32 s41, s41, 2
  v_mfma_f32_16x16x32_bf16 v[56:59], a[136:139], v[216:219], v[56:59]
  v_add_f32 v145, v145, v149
  v_add_f32 v153, v153, v157
  s_mov_b32 s40, 0
  v_mfma_f32_16x16x32_bf16 v[32:35], a[140:143], v[172:175], v[32:35]
  v_add_f32 v146, v146, v150
  v_add_f32 v154, v154, v158
  s_mov_b32 s92, 0
  v_mfma_f32_16x16x32_bf16 v[40:43], a[140:143], v[188:191], v[40:43]
  v_add_f32 v147, v147, v151
  s_mov_b32 s93, 1.0
  s_mov_b32 s39, 0x18000
  v_mfma_f32_16x16x32_bf16 v[48:51], a[140:143], v[204:207], v[48:51]
  v_add_f32 v155, v155, v159
  v_add_f32 v144, v144, v152
  s_mov_b32 s38, 0x12000
  v_mfma_f32_16x16x32_bf16 v[56:59], a[140:143], v[220:223], v[56:59]
  v_add_f32 v145, v145, v153
  s_lshr_b32 s32, s35, 1
  s_lshl_b32 s32, s32, 6
  v_mfma_f32_16x16x32_bf16 v[36:39], a[144:147], v[160:163], 0
  v_add_f32 v146, v146, v154
  v_add_f32 v147, v147, v155
  s_lshr_b32 s33, s36, 4
  v_mfma_f32_16x16x32_bf16 v[44:47], a[144:147], v[176:179], 0
  s_add_u32 s32, s32, s33
  v_mfma_f32_16x16x32_bf16 v[52:55], a[144:147], v[192:195], 0
  buffer_store_dwordx4 v[128:131], v30, s[4:7], s52 offen sc1
  v_and_b32 v23, 31, v1
  v_lshl_add_u32 v23, v23, 1, s32
  v_mfma_f32_16x16x32_bf16 v[60:63], a[144:147], v[208:211], 0
  s_lshl_b32 s32, s36, 3
  v_mfma_f32_16x16x32_bf16 v[36:39], a[148:151], v[164:167], v[36:39]
  buffer_store_dwordx4 v[144:147], v30, s[4:7], s34 offen sc1
  v_and_b32 v24, 7, v1
  v_mfma_f32_16x16x32_bf16 v[44:47], a[148:151], v[180:183], v[44:47]
  v_add_u32 v24, s32, v24
  v_cmp_gt_u32 vcc, 32, v1
  v_mfma_f32_16x16x32_bf16 v[52:55], a[148:151], v[196:199], v[52:55]
  ds_read_b128 a[128:131], v7 offset:0
  v_cndmask_b32 v20, v23, v24, vcc
  v_mfma_f32_16x16x32_bf16 v[60:63], a[148:151], v[212:215], v[60:63]
  s_andn2_b32 s32, s2, 0x38
  v_and_b32 v24, 7, v1
  v_mfma_f32_16x16x32_bf16 v[36:39], a[152:155], v[168:171], v[36:39]
  ds_read_b128 a[132:135], v7 offset:1024
  v_lshl_add_u32 v24, v24, 3, s32
  v_mfma_f32_16x16x32_bf16 v[44:47], a[152:155], v[184:187], v[44:47]
  v_lshrrev_b32 v23, 4, v1
  v_mfma_f32_16x16x32_bf16 v[52:55], a[152:155], v[200:203], v[52:55]
  v_cmp_eq_u32 vcc, 1, v23
  s_nop 1
  v_cndmask_b32 v20, v20, v24, vcc
  v_mfma_f32_16x16x32_bf16 v[60:63], a[152:155], v[216:219], v[60:63]
  ds_read_b128 a[136:139], v7 offset:2048
  v_cndmask_b32 v21, 3, 4, vcc
  v_mfma_f32_16x16x32_bf16 v[36:39], a[156:159], v[172:175], v[36:39]
  v_lshlrev_b32 v20, 7, v20
  v_mfma_f32_16x16x32_bf16 v[44:47], a[156:159], v[188:191], v[44:47]
  ds_read_b128 a[140:143], v7 offset:3072
  s_lshl_b32 s45, s29, 1
  s_add_u32 s45, s45, 1
  v_mfma_f32_16x16x32_bf16 v[52:55], a[156:159], v[204:207], v[52:55]
  s_lshl_b32 s32, s30, 9
  v_mfma_f32_16x16x32_bf16 v[60:63], a[156:159], v[220:223], v[60:63]
  s_add_u32 s32, s32, 122880
  v_lshl_add_u32 v25, v1, 3, s32
  s_bitcmp1_b64 s[54:55], s40
  s_cbranch_scc1 M_ev_6
M_ev_6_r:
  s_mov_b32 s40, 1
  s_mov_b32 s92, 1
  v_max3_f32 v232, v32, v33, v34
  v_max3_f32 v234, v40, v41, v42
  v_max3_f32 v236, v48, v49, v50
  v_max3_f32 v238, v56, v57, v58
  v_max3_f32 v232, v232, v35, v36
  v_max3_f32 v234, v234, v43, v44
  v_max3_f32 v236, v236, v51, v52
  v_max3_f32 v238, v238, v59, v60
  v_max3_f32 v232, v232, v37, v38
  v_max3_f32 v234, v234, v45, v46
  v_max3_f32 v236, v236, v53, v54
  v_max3_f32 v238, v238, v61, v62
  v_max_f32 v232, v232, v39
  v_max_f32 v234, v234, v47
  v_max_f32 v236, v236, v55
  v_max_f32 v238, v238, v63
  v_mov_b32 v233, v232
  v_mov_b32 v235, v234
  v_mov_b32 v237, v236
  v_mov_b32 v239, v238
  v_permlane32_swap_b32 v232, v233
  v_permlane32_swap_b32 v234, v235
  v_permlane32_swap_b32 v236, v237
  v_permlane32_swap_b32 v238, v239
  v_max_f32 v232, v232, v233
  v_max_f32 v234, v234, v235
  v_max_f32 v236, v236, v237
  v_max_f32 v238, v238, v239
  v_mov_b32 v233, v232
  v_mov_b32 v235, v234
  v_mov_b32 v237, v236
  v_mov_b32 v239, v238
  v_permlane16_swap_b32 v232, v233
  v_permlane16_swap_b32 v234, v235
  v_permlane16_swap_b32 v236, v237
  v_permlane16_swap_b32 v238, v239
  v_max_f32 v232, v232, v233
  v_max_f32 v234, v234, v235
  v_max_f32 v236, v236, v237
  v_max_f32 v238, v238, v239
  v_add_f32 v232, 0x42200000, v232
  v_add_f32 v234, 0x42200000, v234
  v_add_f32 v236, 0x42200000, v236
  v_add_f32 v238, 0x42200000, v238
  v_sub_f32 v16, 0, v232
  v_sub_f32 v17, 0, v234
  v_sub_f32 v18, 0, v236
  v_sub_f32 v19, 0, v238
  ds_write_b64 v25, v[16:17]
  v_pk_add_f32 v[32:33], v[32:33], v[232:233] op_sel:[0,0] op_sel_hi:[1,0] neg_lo:[0,1] neg_hi:[0,1]
  v_pk_mov_b32 v[96:97], v[16:17], v[16:17] op_sel:[0,0]
  v_pk_add_f32 v[34:35], v[34:35], v[232:233] op_sel:[0,0] op_sel_hi:[1,0] neg_lo:[0,1] neg_hi:[0,1]
  v_pk_mov_b32 v[98:99], v[16:17], v[16:17] op_sel:[0,0]
  v_pk_add_f32 v[36:37], v[36:37], v[232:233] op_sel:[0,0] op_sel_hi:[1,0] neg_lo:[0,1] neg_hi:[0,1]
  v_pk_mov_b32 v[100:101], v[16:17], v[16:17] op_sel:[0,0]
  v_pk_add_f32 v[38:39], v[38:39], v[232:233] op_sel:[0,0] op_sel_hi:[1,0] neg_lo:[0,1] neg_hi:[0,1]
  v_pk_mov_b32 v[102:103], v[16:17], v[16:17] op_sel:[0,0]
  v_pk_add_f32 v[40:41], v[40:41], v[234:235] op_sel:[0,0] op_sel_hi:[1,0] neg_lo:[0,1] neg_hi:[0,1]
  v_pk_mov_b32 v[104:105], v[16:17], v[16:17] op_sel:[1,1]
  v_pk_add_f32 v[42:43], v[42:43], v[234:235] op_sel:[0,0] op_sel_hi:[1,0] neg_lo:[0,1] neg_hi:[0,1]
  v_pk_mov_b32 v[106:107], v[16:17], v[16:17] op_sel:[1,1]
  v_pk_add_f32 v[44:45], v[44:45], v[234:235] op_sel:[0,0] op_sel_hi:[1,0] neg_lo:[0,1] neg_hi:[0,1]
  v_pk_mov_b32 v[108:109], v[16:17], v[16:17] op_sel:[1,1]
  v_pk_add_f32 v[46:47], v[46:47], v[234:235] op_sel:[0,0] op_sel_hi:[1,0] neg_lo:[0,1] neg_hi:[0,1]
  v_pk_mov_b32 v[110:111], v[16:17], v[16:17] op_sel:[1,1]
  v_pk_add_f32 v[48:49], v[48:49], v[236:237] op_sel:[0,0] op_sel_hi:[1,0] neg_lo:[0,1] neg_hi:[0,1]
  v_pk_mov_b32 v[112:113], v[18:19], v[18:19] op_sel:[0,0]
  v_pk_add_f32 v[50:51], v[50:51], v[236:237] op_sel:[0,0] op_sel_hi:[1,0] neg_lo:[0,1] neg_hi:[0,1]
  v_pk_mov_b32 v[114:115], v[18:19], v[18:19] op_sel:[0,0]
  v_pk_add_f32 v[52:53], v[52:53], v[236:237] op_sel:[0,0] op_sel_hi:[1,0] neg_lo:[0,1] neg_hi:[0,1]
  v_pk_mov_b32 v[116:117], v[18:19], v[18:19] op_sel:[0,0]
  v_pk_add_f32 v[54:55], v[54:55], v[236:237] op_sel:[0,0] op_sel_hi:[1,0] neg_lo:[0,1] neg_hi:[0,1]
  v_pk_mov_b32 v[118:119], v[18:19], v[18:19] op_sel:[0,0]
  v_pk_add_f32 v[56:57], v[56:57], v[238:239] op_sel:[0,0] op_sel_hi:[1,0] neg_lo:[0,1] neg_hi:[0,1]
  v_pk_mov_b32 v[120:121], v[18:19], v[18:19] op_sel:[1,1]
  v_pk_add_f32 v[58:59], v[58:59], v[238:239] op_sel:[0,0] op_sel_hi:[1,0] neg_lo:[0,1] neg_hi:[0,1]
  v_pk_mov_b32 v[122:123], v[18:19], v[18:19] op_sel:[1,1]
  v_pk_add_f32 v[60:61], v[60:61], v[238:239] op_sel:[0,0] op_sel_hi:[1,0] neg_lo:[0,1] neg_hi:[0,1]
  v_pk_mov_b32 v[124:125], v[18:19], v[18:19] op_sel:[1,1]
  v_pk_add_f32 v[62:63], v[62:63], v[238:239] op_sel:[0,0] op_sel_hi:[1,0] neg_lo:[0,1] neg_hi:[0,1]
  v_pk_mov_b32 v[126:127], v[18:19], v[18:19] op_sel:[1,1]
  s_bitcmp1_b64 s[54:55], s40
  s_cbranch_scc1 M_ev_7
M_ev_7_r:
  s_waitcnt vmcnt(2)
  v_lshrrev_b32 v23, 2, v1
  v_mul_u32_u24 v29, 160, v23
  v_and_b32 v24, 3, v1
  s_lshl_b32 s32, s30, 13
  s_add_u32 s32, s32, 0x20000
  v_lshl_add_u32 v24, v24, 3, s32
  v_add_u32 v29, v29, v24
  ds_read_b64_tr_b16 v[64:65], v29 offset:0
  ds_read_b64_tr_b16 v[66:67], v29 offset:2560
  ds_read_b64_tr_b16 v[68:69], v29 offset:32
  ds_read_b64_tr_b16 v[70:71], v29 offset:2592
  ds_read_b64_tr_b16 v[72:73], v29 offset:64
  ds_read_b64_tr_b16 v[74:75], v29 offset:2624
  ds_read_b64_tr_b16 v[76:77], v29 offset:96
  ds_read_b64_tr_b16 v[78:79], v29 offset:2656
  ds_read_b64_tr_b16 v[80:81], v29 offset:128
  ds_read_b64_tr_b16 v[82:83], v29 offset:2688
  v_lshl_add_u32 v24, v23, 5, v24
  v_lshrrev_b32 v23, 4, v1
  v_lshl_add_u32 v24, v23, 7, v24
  ds_read_b64_tr_b16 v[84:85], v24 offset:5120
  ds_read_b64_tr_b16 v[86:87], v24 offset:5248
  s_add_u32 s12, s80, 0x3800000
  s_addc_u32 s13, s81, 0
  s_mov_b32 s14, 0x800000
  s_mov_b32 s15, 0x20000
  v_exp_f32 v224, v32
  v_exp_f32 v225, v33
  v_exp_f32 v226, v40
  v_cvt_pk_bf16_f32 v128, v224, v225
  v_exp_f32 v227, v41
  v_exp_f32 v228, v48
  v_cvt_pk_bf16_f32 v132, v226, v227
  v_exp_f32 v229, v49
  v_exp_f32 v230, v56
  v_cvt_pk_bf16_f32 v136, v228, v229
  v_exp_f32 v231, v57
  v_exp_f32 v224, v34
  v_cvt_pk_bf16_f32 v140, v230, v231
  v_exp_f32 v225, v35
  v_exp_f32 v226, v42
  v_cvt_pk_bf16_f32 v129, v224, v225
  v_exp_f32 v227, v43
  v_exp_f32 v228, v50
  v_cvt_pk_bf16_f32 v133, v226, v227
  v_exp_f32 v229, v51
  v_exp_f32 v230, v58
  v_cvt_pk_bf16_f32 v137, v228, v229
  v_exp_f32 v231, v59
  v_exp_f32 v224, v36
  v_cvt_pk_bf16_f32 v141, v230, v231
  v_exp_f32 v225, v37
  s_nop 0
  v_cvt_pk_bf16_f32 v130, v224, v225
  s_waitcnt lgkmcnt(10)
  buffer_store_dwordx4 v[64:67], v22, s[12:15], s83 offen offset:0 sc1
  s_waitcnt lgkmcnt(8)
  buffer_store_dwordx4 v[68:71], v22, s[12:15], s83 offen offset:1024 sc1
  s_waitcnt lgkmcnt(6)
  buffer_store_dwordx4 v[72:75], v22, s[12:15], s83 offen offset:2048 sc1
  s_waitcnt lgkmcnt(4)
  buffer_store_dwordx4 v[76:79], v22, s[12:15], s83 offen offset:3072 sc1
  s_addk_i32 s83, 0x1000
  s_waitcnt lgkmcnt(2)
  buffer_store_dwordx4 v[80:83], v22, s[12:15], s83 offen offset:0 sc1
  s_waitcnt lgkmcnt(0)
  buffer_store_dwordx4 v[84:87], v22, s[12:15], s53 offen sc1
  v_xor_b32 v25, 0x200, v25
  s_lshl_b32 s32, s30, 13
  s_add_u32 s32, s32, 0x20000
  v_add_u32 v23, s32, v22
  s_waitcnt lgkmcnt(0)
  s_barrier
  ds_read_b64 v[30:31], v25
  ds_write_b128 v23, v[160:163] offset:0
  ds_write_b128 v23, v[164:167] offset:1024
  ds_write_b128 v23, v[168:171] offset:2048
  ds_write_b128 v23, v[172:175] offset:3072
  ds_write_b128 v23, v[176:179] offset:4096
  ds_write_b128 v23, v[180:183] offset:5120
  ds_write_b128 v23, v[184:187] offset:6144
  ds_write_b128 v23, v[188:191] offset:7168
  s_lshr_b32 s34, s31, 1
  s_and_b32 s34, s34, 0x800
  s_add_u32 s34, s34, s47
  s_add_u32 s34, s34, 0x80000
  buffer_store_dwordx4 a[192:195], v22, s[16:19], s34 offen offset:0 sc1
  s_addk_i32 s34, 0x1000
  buffer_store_dwordx4 a[196:199], v22, s[16:19], s34 offen offset:0 sc1
  s_and_b32 s34, s31, 0x1000
  s_add_u32 s34, s34, s47
  s_add_u32 s34, s34, 0x82000
  buffer_store_dwordx4 a[224:227], v22, s[16:19], s34 offen offset:0 sc1
  buffer_store_dwordx4 a[228:231], v22, s[16:19], s34 offen offset:1024 sc1
  s_getpc_b64 s[82:83]
M_l1_pc:
  s_add_u32 s82, s82, M_l1-M_l1_pc
  s_addc_u32 s83, s83, 0
M_l1:
  v_mfma_f32_16x16x32_bf16 v[64:67], a[128:131], v[160:163], v[96:99]
  s_add_u32 s40, s40, 1
  v_exp_f32 v224, v44
  v_mfma_f32_16x16x32_bf16 v[72:75], a[128:131], v[176:179], v[104:107]
  s_add_u32 s41, s41, 2
  v_exp_f32 v225, v45
  v_mfma_f32_16x16x32_bf16 v[80:83], a[128:131], v[192:195], v[112:115]
  ds_read_b128 a[144:147], v7 offset:4096
  v_cvt_pk_bf16_f32 v134, v224, v225
  v_mfma_f32_16x16x32_bf16 v[88:91], a[128:131], v[208:211], v[120:123]
  s_max_i32 s92, s40, s41
  v_exp_f32 v226, v52
  v_mfma_f32_16x16x32_bf16 v[64:67], a[132:135], v[164:167], v[64:67]
  s_lshl_b32 s37, s92, 14
  v_exp_f32 v227, v53
  v_mfma_f32_16x16x32_bf16 v[72:75], a[132:135], v[180:183], v[72:75]
  s_and_b32 s37, s37, 0x1ffff
  v_exp_f32 v228, v60
  v_mfma_f32_16x16x32_bf16 v[80:83], a[132:135], v[196:199], v[80:83]
  ds_read_b128 a[148:151], v7 offset:5120
  v_cvt_pk_bf16_f32 v138, v226, v227
  v_mfma_f32_16x16x32_bf16 v[88:91], a[132:135], v[212:215], v[88:91]
  s_waitcnt lgkmcnt(2)
  v_exp_f32 v229, v61
  v_mfma_f32_16x16x32_bf16 v[64:67], a[136:139], v[168:171], v[64:67]
  v_exp_f32 v230, v38
  v_mfma_f32_16x16x32_bf16 v[72:75], a[136:139], v[184:187], v[72:75]
  v_exp_f32 v231, v39
  v_mfma_f32_16x16x32_bf16 v[80:83], a[136:139], v[200:203], v[80:83]
  ds_read_b128 a[152:155], v7 offset:6144
  v_cvt_pk_bf16_f32 v142, v228, v229
  v_mfma_f32_16x16x32_bf16 v[88:91], a[136:139], v[216:219], v[88:91]
  v_exp_f32 v224, v46
  v_mfma_f32_16x16x32_bf16 v[64:67], a[140:143], v[172:175], v[64:67]
  v_exp_f32 v225, v47
  v_mfma_f32_16x16x32_bf16 v[72:75], a[140:143], v[188:191], v[72:75]
  v_exp_f32 v226, v54
  v_mfma_f32_16x16x32_bf16 v[80:83], a[140:143], v[204:207], v[80:83]
  ds_read_b128 a[156:159], v7 offset:7168
  v_cvt_pk_bf16_f32 v131, v230, v231
  v_mfma_f32_16x16x32_bf16 v[88:91], a[140:143], v[220:223], v[88:91]
  s_waitcnt lgkmcnt(2)
  v_exp_f32 v227, v55
  v_mfma_f32_16x16x32_bf16 v[68:71], a[144:147], v[160:163], v[100:103]
  v_exp_f32 v228, v62
  v_mfma_f32_16x16x32_bf16 v[76:79], a[144:147], v[176:179], v[108:111]
  v_exp_f32 v229, v63
  v_mfma_f32_16x16x32_bf16 v[84:87], a[144:147], v[192:195], v[116:119]
  ds_read_b128 a[160:163], v6 offset:8192
  v_cvt_pk_bf16_f32 v135, v224, v225
  v_mfma_f32_16x16x32_bf16 v[92:95], a[144:147], v[208:211], v[124:127]
  v_cvt_pk_bf16_f32 v139, v226, v227
  v_cvt_pk_bf16_f32 v143, v228, v229
  v_mfma_f32_16x16x32_bf16 v[68:71], a[148:151], v[164:167], v[68:71]
  v_mfma_f32_16x16x32_bf16 v[76:79], a[148:151], v[180:183], v[76:79]
  s_and_b32 s32, s38, 0x1ffff
  v_mfma_f32_16x16x32_bf16 v[84:87], a[148:151], v[196:199], v[84:87]
  ds_read_b128 a[164:167], v6 offset:9216
  s_add_u32 m0, s32, s94
  v_mfma_f32_16x16x32_bf16 v[92:95], a[148:151], v[212:215], v[92:95]
  buffer_load_dwordx4 v2, s[24:27], s38 offen offset:0 sc1 lds
  v_mfma_f32_16x16x32_bf16 v[144:147], v[12:15], v[128:131], 0
  v_exp_f32 v224, v64
  v_mfma_f32_16x16x32_bf16 v[148:151], v[12:15], v[132:135], 0
  v_exp_f32 v225, v65
  v_mfma_f32_16x16x32_bf16 v[152:155], v[12:15], v[136:139], 0
  ds_read_b128 a[168:171], v6 offset:10240
  v_mfma_f32_16x16x32_bf16 v[156:159], v[12:15], v[140:143], 0
  s_waitcnt lgkmcnt(3)
  v_exp_f32 v226, v72
  v_mfma_f32_16x16x32_bf16 v[68:71], a[152:155], v[168:171], v[68:71]
  buffer_load_dwordx4 v2, s[24:27], s38 offen offset:1024 sc1 lds
  s_add_u32 s38, s38, 0x4000
  v_mfma_f32_16x16x32_bf16 v[76:79], a[152:155], v[184:187], v[76:79]
  v_exp_f32 v227, v73
  v_mfma_f32_16x16x32_bf16 v[84:87], a[152:155], v[200:203], v[84:87]
  ds_read_b128 a[172:175], v6 offset:11264
  v_mfma_f32_16x16x32_bf16 v[92:95], a[152:155], v[216:219], v[92:95]
  s_and_b32 s32, s39, 0x1ffff
  v_mfma_f32_16x16x32_bf16 v[68:71], a[156:159], v[172:175], v[68:71]
  s_add_u32 m0, s32, s94
  v_max3_f32 v232, v144, v148, v152
  v_max_f32 v232, v232, v156
  v_mfma_f32_16x16x32_bf16 v[76:79], a[156:159], v[188:191], v[76:79]
  buffer_load_dwordx4 v2, s[24:27], s39 offen offset:0 sc1 lds
  v_mfma_f32_16x16x32_bf16 v[84:87], a[156:159], v[204:207], v[84:87]
  ds_read_b128 a[176:179], v6 offset:12288
  v_cmp_lt_f32 vcc, s44, v232
  v_mfma_f32_16x16x32_bf16 v[92:95], a[156:159], v[220:223], v[92:95]
  s_waitcnt lgkmcnt(3)
  s_cbranch_vccnz M_sl_8
M_sl_8_r:
  v_mfma_f32_16x16x32_bf16 a[0:3], a[160:163], v[128:131], a[0:3]
  v_add_f32 v8, v8, v144
  v_add_f32 v9, v9, v148
  v_mfma_f32_16x16x32_bf16 a[32:35], a[160:163], v[132:135], a[32:35]
  v_add_f32 v10, v10, v152
  v_add_f32 v11, v11, v156
  v_mfma_f32_16x16x32_bf16 a[64:67], a[160:163], v[136:139], a[64:67]
  ds_read_b128 a[180:183], v6 offset:13312
  v_cvt_pk_bf16_f32 v144, v224, v225
  v_mfma_f32_16x16x32_bf16 a[96:99], a[160:163], v[140:143], a[96:99]
  v_exp_f32 v228, v80
  v_mfma_f32_16x16x32_bf16 a[4:7], a[164:167], v[128:131], a[4:7]
  v_exp_f32 v229, v81
  v_mfma_f32_16x16x32_bf16 a[36:39], a[164:167], v[132:135], a[36:39]
  v_exp_f32 v230, v88
  v_mfma_f32_16x16x32_bf16 a[68:71], a[164:167], v[136:139], a[68:71]
  ds_read_b128 a[184:187], v6 offset:14336
  v_cvt_pk_bf16_f32 v148, v226, v227
  v_mfma_f32_16x16x32_bf16 a[100:103], a[164:167], v[140:143], a[100:103]
  s_waitcnt lgkmcnt(3)
  v_exp_f32 v231, v89
  v_mfma_f32_16x16x32_bf16 a[8:11], a[168:171], v[128:131], a[8:11]
  v_exp_f32 v224, v66
  v_mfma_f32_16x16x32_bf16 a[40:43], a[168:171], v[132:135], a[40:43]
  buffer_load_dwordx4 v2, s[24:27], s39 offen offset:1024 sc1 lds
  s_add_u32 s39, s39, 0x4000
  v_mfma_f32_16x16x32_bf16 a[72:75], a[168:171], v[136:139], a[72:75]
  ds_read_b128 a[188:191], v6 offset:15360
  v_add_u32 v6, s37, v22
  v_mfma_f32_16x16x32_bf16 a[104:107], a[168:171], v[140:143], a[104:107]
  v_exp_f32 v225, v67
  v_mfma_f32_16x16x32_bf16 a[12:15], a[172:175], v[128:131], a[12:15]
  v_cvt_pk_bf16_f32 v152, v228, v229
  v_cvt_pk_bf16_f32 v156, v230, v231
  v_mfma_f32_16x16x32_bf16 a[44:47], a[172:175], v[132:135], a[44:47]
  v_exp_f32 v226, v74
  v_mfma_f32_16x16x32_bf16 a[76:79], a[172:175], v[136:139], a[76:79]
  v_exp_f32 v227, v75
  v_mfma_f32_16x16x32_bf16 a[108:111], a[172:175], v[140:143], a[108:111]
  s_waitcnt lgkmcnt(2)
  v_exp_f32 v228, v82
  v_mfma_f32_16x16x32_bf16 a[16:19], a[176:179], v[128:131], a[16:19]
  v_exp_f32 v229, v83
  v_mfma_f32_16x16x32_bf16 a[48:51], a[176:179], v[132:135], a[48:51]
  v_cvt_pk_bf16_f32 v145, v224, v225
  v_cvt_pk_bf16_f32 v149, v226, v227
  v_mfma_f32_16x16x32_bf16 a[80:83], a[176:179], v[136:139], a[80:83]
  ds_read_b128 a[128:131], v6 offset:0
  v_cvt_pk_bf16_f32 v153, v228, v229
  v_mfma_f32_16x16x32_bf16 a[112:115], a[176:179], v[140:143], a[112:115]
  v_exp_f32 v230, v90
  v_mfma_f32_16x16x32_bf16 a[20:23], a[180:183], v[128:131], a[20:23]
  ds_read_b128 a[132:135], v6 offset:1024
  v_mfma_f32_16x16x32_bf16 a[52:55], a[180:183], v[132:135], a[52:55]
  v_exp_f32 v231, v91
  v_mfma_f32_16x16x32_bf16 a[84:87], a[180:183], v[136:139], a[84:87]
  v_exp_f32 v224, v68
  v_mfma_f32_16x16x32_bf16 a[116:119], a[180:183], v[140:143], a[116:119]
  s_waitcnt lgkmcnt(2)
  v_exp_f32 v225, v69
  v_mfma_f32_16x16x32_bf16 a[24:27], a[184:187], v[128:131], a[24:27]
  ds_read_b128 a[136:139], v6 offset:2048
  v_cvt_pk_bf16_f32 v157, v230, v231
  v_mfma_f32_16x16x32_bf16 a[56:59], a[184:187], v[132:135], a[56:59]
  v_cvt_pk_bf16_f32 v146, v224, v225
  v_mfma_f32_16x16x32_bf16 a[88:91], a[184:187], v[136:139], a[88:91]
  ds_read_b128 a[140:143], v6 offset:3072
  v_mfma_f32_16x16x32_bf16 a[120:123], a[184:187], v[140:143], a[120:123]
  v_mfma_f32_16x16x32_bf16 a[28:31], a[188:191], v[128:131], a[28:31]
  s_bitcmp1_b64 s[54:55], s40
  s_cbranch_scc1 M_ev_9
M_ev_9_r:
  v_mfma_f32_16x16x32_bf16 a[60:63], a[188:191], v[132:135], a[60:63]
  v_mfma_f32_16x16x32_bf16 a[92:95], a[188:191], v[136:139], a[92:95]
  s_waitcnt lgkmcnt(2)
  v_mfma_f32_16x16x32_bf16 a[124:127], a[188:191], v[140:143], a[124:127]
  v_mfma_f32_16x16x32_bf16 v[32:35], a[128:131], v[160:163], v[96:99]
  s_add_u32 s40, s40, 1
  v_exp_f32 v224, v76
  v_mfma_f32_16x16x32_bf16 v[40:43], a[128:131], v[176:179], v[104:107]
  s_add_u32 s41, s41, 2
  v_exp_f32 v225, v77
  v_mfma_f32_16x16x32_bf16 v[48:51], a[128:131], v[192:195], v[112:115]
  ds_read_b128 a[144:147], v6 offset:4096
  v_cvt_pk_bf16_f32 v150, v224, v225
  v_mfma_f32_16x16x32_bf16 v[56:59], a[128:131], v[208:211], v[120:123]
  s_max_i32 s92, s40, s41
  v_exp_f32 v226, v84
  v_mfma_f32_16x16x32_bf16 v[32:35], a[132:135], v[164:167], v[32:35]
  s_lshl_b32 s37, s92, 14
  v_exp_f32 v227, v85
  v_mfma_f32_16x16x32_bf16 v[40:43], a[132:135], v[180:183], v[40:43]
  s_and_b32 s37, s37, 0x1ffff
  v_exp_f32 v228, v92
  v_mfma_f32_16x16x32_bf16 v[48:51], a[132:135], v[196:199], v[48:51]
  ds_read_b128 a[148:151], v6 offset:5120
  v_cvt_pk_bf16_f32 v154, v226, v227
  v_mfma_f32_16x16x32_bf16 v[56:59], a[132:135], v[212:215], v[56:59]
  s_waitcnt lgkmcnt(2)
  v_exp_f32 v229, v93
  v_mfma_f32_16x16x32_bf16 v[32:35], a[136:139], v[168:171], v[32:35]
  v_exp_f32 v230, v70
  v_mfma_f32_16x16x32_bf16 v[40:43], a[136:139], v[184:187], v[40:43]
  v_exp_f32 v231, v71
  v_mfma_f32_16x16x32_bf16 v[48:51], a[136:139], v[200:203], v[48:51]
  ds_read_b128 a[152:155], v6 offset:6144
  v_cvt_pk_bf16_f32 v158, v228, v229
  v_mfma_f32_16x16x32_bf16 v[56:59], a[136:139], v[216:219], v[56:59]
  v_exp_f32 v224, v78
  v_mfma_f32_16x16x32_bf16 v[32:35], a[140:143], v[172:175], v[32:35]
  v_exp_f32 v225, v79
  v_mfma_f32_16x16x32_bf16 v[40:43], a[140:143], v[188:191], v[40:43]
  v_exp_f32 v226, v86
  v_mfma_f32_16x16x32_bf16 v[48:51], a[140:143], v[204:207], v[48:51]
  ds_read_b128 a[156:159], v6 offset:7168
  v_cvt_pk_bf16_f32 v147, v230, v231
  v_mfma_f32_16x16x32_bf16 v[56:59], a[140:143], v[220:223], v[56:59]
  s_waitcnt lgkmcnt(2)
  v_exp_f32 v227, v87
  v_mfma_f32_16x16x32_bf16 v[36:39], a[144:147], v[160:163], v[100:103]
  v_exp_f32 v228, v94
  v_mfma_f32_16x16x32_bf16 v[44:47], a[144:147], v[176:179], v[108:111]
  v_exp_f32 v229, v95
  v_mfma_f32_16x16x32_bf16 v[52:55], a[144:147], v[192:195], v[116:119]
  ds_read_b128 a[160:163], v7 offset:8192
  v_cvt_pk_bf16_f32 v151, v224, v225
  v_mfma_f32_16x16x32_bf16 v[60:63], a[144:147], v[208:211], v[124:127]
  v_cvt_pk_bf16_f32 v155, v226, v227
  v_cvt_pk_bf16_f32 v159, v228, v229
  v_mfma_f32_16x16x32_bf16 v[36:39], a[148:151], v[164:167], v[36:39]
  v_mfma_f32_16x16x32_bf16 v[44:47], a[148:151], v[180:183], v[44:47]
  s_and_b32 s32, s38, 0x1ffff
  v_mfma_f32_16x16x32_bf16 v[52:55], a[148:151], v[196:199], v[52:55]
  ds_read_b128 a[164:167], v7 offset:9216
  s_add_u32 m0, s32, s94
  v_mfma_f32_16x16x32_bf16 v[60:63], a[148:151], v[212:215], v[60:63]
  buffer_load_dwordx4 v2, s[24:27], s38 offen offset:0 sc1 lds
  v_mfma_f32_16x16x32_bf16 v[128:131], v[12:15], v[144:147], 0
  v_exp_f32 v224, v32
  v_mfma_f32_16x16x32_bf16 v[132:135], v[12:15], v[148:151], 0
  v_exp_f32 v225, v33
  v_mfma_f32_16x16x32_bf16 v[136:139], v[12:15], v[152:155], 0
  ds_read_b128 a[168:171], v7 offset:10240
  v_mfma_f32_16x16x32_bf16 v[140:143], v[12:15], v[156:159], 0
  s_waitcnt lgkmcnt(3)
  v_exp_f32 v226, v40
  v_mfma_f32_16x16x32_bf16 v[36:39], a[152:155], v[168:171], v[36:39]
  buffer_load_dwordx4 v2, s[24:27], s38 offen offset:1024 sc1 lds
  s_add_u32 s38, s38, 0x4000
  v_mfma_f32_16x16x32_bf16 v[44:47], a[152:155], v[184:187], v[44:47]
  v_exp_f32 v227, v41
  v_mfma_f32_16x16x32_bf16 v[52:55], a[152:155], v[200:203], v[52:55]
  ds_read_b128 a[172:175], v7 offset:11264
  v_mfma_f32_16x16x32_bf16 v[60:63], a[152:155], v[216:219], v[60:63]
  s_and_b32 s32, s39, 0x1ffff
  v_mfma_f32_16x16x32_bf16 v[36:39], a[156:159], v[172:175], v[36:39]
  s_add_u32 m0, s32, s94
  v_max3_f32 v232, v128, v132, v136
  v_max_f32 v232, v232, v140
  v_mfma_f32_16x16x32_bf16 v[44:47], a[156:159], v[188:191], v[44:47]
  buffer_load_dwordx4 v2, s[24:27], s39 offen offset:0 sc1 lds
  v_mfma_f32_16x16x32_bf16 v[52:55], a[156:159], v[204:207], v[52:55]
  ds_read_b128 a[176:179], v7 offset:12288
  v_cmp_lt_f32 vcc, s44, v232
  v_mfma_f32_16x16x32_bf16 v[60:63], a[156:159], v[220:223], v[60:63]
  s_waitcnt lgkmcnt(3)
  s_cbranch_vccnz M_sl_10
M_sl_10_r:
  v_mfma_f32_16x16x32_bf16 a[0:3], a[160:163], v[144:147], a[0:3]
  v_add_f32 v8, v8, v128
  v_add_f32 v9, v9, v132
  v_mfma_f32_16x16x32_bf16 a[32:35], a[160:163], v[148:151], a[32:35]
  v_add_f32 v10, v10, v136
  v_add_f32 v11, v11, v140
  v_mfma_f32_16x16x32_bf16 a[64:67], a[160:163], v[152:155], a[64:67]
  ds_read_b128 a[180:183], v7 offset:13312
  v_cvt_pk_bf16_f32 v128, v224, v225
  v_mfma_f32_16x16x32_bf16 a[96:99], a[160:163], v[156:159], a[96:99]
  v_exp_f32 v228, v48
  v_mfma_f32_16x16x32_bf16 a[4:7], a[164:167], v[144:147], a[4:7]
  v_exp_f32 v229, v49
  v_mfma_f32_16x16x32_bf16 a[36:39], a[164:167], v[148:151], a[36:39]
  v_exp_f32 v230, v56
  v_mfma_f32_16x16x32_bf16 a[68:71], a[164:167], v[152:155], a[68:71]
  ds_read_b128 a[184:187], v7 offset:14336
  v_cvt_pk_bf16_f32 v132, v226, v227
  v_mfma_f32_16x16x32_bf16 a[100:103], a[164:167], v[156:159], a[100:103]
  s_waitcnt lgkmcnt(3)
  v_exp_f32 v231, v57
  v_mfma_f32_16x16x32_bf16 a[8:11], a[168:171], v[144:147], a[8:11]
  v_exp_f32 v224, v34
  v_mfma_f32_16x16x32_bf16 a[40:43], a[168:171], v[148:151], a[40:43]
  buffer_load_dwordx4 v2, s[24:27], s39 offen offset:1024 sc1 lds
  s_add_u32 s39, s39, 0x4000
  v_mfma_f32_16x16x32_bf16 a[72:75], a[168:171], v[152:155], a[72:75]
  ds_read_b128 a[188:191], v7 offset:15360
  v_add_u32 v7, s37, v22
  v_mfma_f32_16x16x32_bf16 a[104:107], a[168:171], v[156:159], a[104:107]
  v_exp_f32 v225, v35
  v_mfma_f32_16x16x32_bf16 a[12:15], a[172:175], v[144:147], a[12:15]
  v_cvt_pk_bf16_f32 v136, v228, v229
  v_cvt_pk_bf16_f32 v140, v230, v231
  v_mfma_f32_16x16x32_bf16 a[44:47], a[172:175], v[148:151], a[44:47]
  v_exp_f32 v226, v42
  v_mfma_f32_16x16x32_bf16 a[76:79], a[172:175], v[152:155], a[76:79]
  v_exp_f32 v227, v43
  v_mfma_f32_16x16x32_bf16 a[108:111], a[172:175], v[156:159], a[108:111]
  s_waitcnt lgkmcnt(2)
  v_exp_f32 v228, v50
  v_mfma_f32_16x16x32_bf16 a[16:19], a[176:179], v[144:147], a[16:19]
  v_exp_f32 v229, v51
  v_mfma_f32_16x16x32_bf16 a[48:51], a[176:179], v[148:151], a[48:51]
  s_waitcnt vmcnt(8)
  s_barrier
  v_mfma_f32_16x16x32_bf16 a[80:83], a[176:179], v[152:155], a[80:83]
  ds_read_b128 a[128:131], v7 offset:0
  v_cvt_pk_bf16_f32 v129, v224, v225
  v_mfma_f32_16x16x32_bf16 a[112:115], a[176:179], v[156:159], a[112:115]
  s_sub_u32 s45, s45, 1
  v_exp_f32 v230, v58
  v_mfma_f32_16x16x32_bf16 a[20:23], a[180:183], v[144:147], a[20:23]
  ds_read_b128 a[132:135], v7 offset:1024
  s_cselect_b32 s32, M_l1x-M_l1, 0
  v_cvt_pk_bf16_f32 v133, v226, v227
  v_mfma_f32_16x16x32_bf16 a[52:55], a[180:183], v[148:151], a[52:55]
  s_cselect_b32 s33, -1, 0x2000a2a8
  v_exp_f32 v231, v59
  v_mfma_f32_16x16x32_bf16 a[84:87], a[180:183], v[152:155], a[84:87]
  s_add_u32 s82, s82, s32
  v_exp_f32 v224, v36
  v_mfma_f32_16x16x32_bf16 a[116:119], a[180:183], v[156:159], a[116:119]
  s_waitcnt lgkmcnt(2)
  s_addc_u32 s83, s83, 0
  v_cvt_pk_bf16_f32 v137, v228, v229
  v_mfma_f32_16x16x32_bf16 a[24:27], a[184:187], v[144:147], a[24:27]
  ds_read_b128 a[136:139], v7 offset:2048
  v_cvt_pk_bf16_f32 v141, v230, v231
  v_mfma_f32_16x16x32_bf16 a[56:59], a[184:187], v[148:151], a[56:59]
  v_exp_f32 v225, v37
  v_mfma_f32_16x16x32_bf16 a[88:91], a[184:187], v[152:155], a[88:91]
  ds_read_b128 a[140:143], v7 offset:3072
  v_cvt_pk_bf16_f32 v130, v224, v225
  v_mfma_f32_16x16x32_bf16 a[120:123], a[184:187], v[156:159], a[120:123]
  v_mfma_f32_16x16x32_bf16 a[28:31], a[188:191], v[144:147], a[28:31]
  s_bitcmp1_b64 s[54:55], s40
  s_cbranch_scc1 M_ev_11
M_ev_11_r:
  v_mfma_f32_16x16x32_bf16 a[60:63], a[188:191], v[148:151], a[60:63]
  v_mfma_f32_16x16x32_bf16 a[92:95], a[188:191], v[152:155], a[92:95]
  s_waitcnt lgkmcnt(2)
  v_mfma_f32_16x16x32_bf16 a[124:127], a[188:191], v[156:159], a[124:127]
  s_bitcmp1_b32 s33, s40
  s_cbranch_scc0 M_l1
  s_cmp_eq_u32 s40, 3
  s_cbranch_scc1 M_hook3
  s_cmp_eq_u32 s40, 5
  s_cbranch_scc1 M_hook5
  s_cmp_eq_u32 s40, 7
  s_cbranch_scc1 M_hook7
  s_cmp_eq_u32 s40, 9
  s_cbranch_scc1 M_hook9
  s_cmp_eq_u32 s40, 13
  s_cbranch_scc1 M_hook13
  s_cmp_eq_u32 s40, 15
  s_cbranch_scc1 M_hook15
  s_cmp_eq_u32 s40, 29
  s_cbranch_scc1 M_hook29
M_l1x:
  s_lshl_b32 s32, s29, 20
  s_lshl_b32 s33, s28, 15
  s_add_u32 s32, s32, s33
  s_add_u32 s46, s32, s94
  v_rcp_f32 v234, v10
  v_mov_b32 v10, 0
  v_rcp_f32 v235, v11
  v_mov_b32 v11, 0
  v_mov_b32 v144, 0
  v_mov_b32 v145, 0
  v_mov_b32 v146, 0
  v_mov_b32 v147, 0
  v_accvgpr_read_b32 v64, a64
  v_accvgpr_read_b32 v65, a65
  v_accvgpr_read_b32 v66, a66
  v_accvgpr_read_b32 v67, a67
  v_accvgpr_read_b32 v68, a68
  v_accvgpr_read_b32 v69, a69
  v_accvgpr_read_b32 v70, a70
  v_accvgpr_read_b32 v71, a71
  v_accvgpr_read_b32 v72, a96
  v_accvgpr_read_b32 v73, a97
  v_accvgpr_read_b32 v74, a98
  v_accvgpr_read_b32 v75, a99
  v_accvgpr_read_b32 v76, a100
  v_accvgpr_read_b32 v77, a101
  v_accvgpr_read_b32 v78, a102
  v_accvgpr_read_b32 v79, a103
  v_pk_mul_f32 v[64:65], v[64:65], v[234:235] op_sel:[0,0] op_sel_hi:[1,0]
  v_pk_mul_f32 v[66:67], v[66:67], v[234:235] op_sel:[0,0] op_sel_hi:[1,0]
  v_pk_mul_f32 v[68:69], v[68:69], v[234:235] op_sel:[0,0] op_sel_hi:[1,0]
  v_pk_mul_f32 v[70:71], v[70:71], v[234:235] op_sel:[0,0] op_sel_hi:[1,0]
  v_pk_mul_f32 v[72:73], v[72:73], v[234:235] op_sel:[0,1] op_sel_hi:[1,1]
  v_pk_mul_f32 v[74:75], v[74:75], v[234:235] op_sel:[0,1] op_sel_hi:[1,1]
  v_pk_mul_f32 v[76:77], v[76:77], v[234:235] op_sel:[0,1] op_sel_hi:[1,1]
  v_pk_mul_f32 v[78:79], v[78:79], v[234:235] op_sel:[0,1] op_sel_hi:[1,1]
  v_cvt_pk_bf16_f32 v64, v64, v65
  v_cvt_pk_bf16_f32 v65, v66, v67
  v_cvt_pk_bf16_f32 v66, v68, v69
  v_cvt_pk_bf16_f32 v67, v70, v71
  v_cvt_pk_bf16_f32 v68, v72, v73
  v_cvt_pk_bf16_f32 v69, v74, v75
  v_cvt_pk_bf16_f32 v70, v76, v77
  v_cvt_pk_bf16_f32 v71, v78, v79
  buffer_store_dwordx4 v[64:67], v22, s[8:11], s46 offen offset:0 sc1
  buffer_store_dwordx4 v[68:71], v22, s[8:11], s46 offen offset:1024 sc1
  s_add_u32 s46, s46, 0x2000
  v_accvgpr_read_b32 v80, a72
  v_accvgpr_read_b32 v81, a73
  v_accvgpr_read_b32 v82, a74
  v_accvgpr_read_b32 v83, a75
  v_accvgpr_read_b32 v84, a76
  v_accvgpr_read_b32 v85, a77
  v_accvgpr_read_b32 v86, a78
  v_accvgpr_read_b32 v87, a79
  v_accvgpr_read_b32 v88, a104
  v_accvgpr_read_b32 v89, a105
  v_accvgpr_read_b32 v90, a106
  v_accvgpr_read_b32 v91, a107
  v_accvgpr_read_b32 v92, a108
  v_accvgpr_read_b32 v93, a109
  v_accvgpr_read_b32 v94, a110
  v_accvgpr_read_b32 v95, a111
  v_pk_mul_f32 v[80:81], v[80:81], v[234:235] op_sel:[0,0] op_sel_hi:[1,0]
  v_pk_mul_f32 v[82:83], v[82:83], v[234:235] op_sel:[0,0] op_sel_hi:[1,0]
  v_pk_mul_f32 v[84:85], v[84:85], v[234:235] op_sel:[0,0] op_sel_hi:[1,0]
  v_pk_mul_f32 v[86:87], v[86:87], v[234:235] op_sel:[0,0] op_sel_hi:[1,0]
  v_pk_mul_f32 v[88:89], v[88:89], v[234:235] op_sel:[0,1] op_sel_hi:[1,1]
  v_pk_mul_f32 v[90:91], v[90:91], v[234:235] op_sel:[0,1] op_sel_hi:[1,1]
  v_pk_mul_f32 v[92:93], v[92:93], v[234:235] op_sel:[0,1] op_sel_hi:[1,1]
  v_pk_mul_f32 v[94:95], v[94:95], v[234:235] op_sel:[0,1] op_sel_hi:[1,1]
  v_cvt_pk_bf16_f32 v80, v80, v81
  v_cvt_pk_bf16_f32 v81, v82, v83
  v_cvt_pk_bf16_f32 v82, v84, v85
  v_cvt_pk_bf16_f32 v83, v86, v87
  v_cvt_pk_bf16_f32 v84, v88, v89
  v_cvt_pk_bf16_f32 v85, v90, v91
  v_cvt_pk_bf16_f32 v86, v92, v93
  v_cvt_pk_bf16_f32 v87, v94, v95
  v_mfma_f32_32x32x16_bf16 a[64:79], v[144:147], v[144:147], 0
  v_mfma_f32_32x32x16_bf16 a[96:111], v[144:147], v[144:147], 0
  buffer_store_dwordx4 v[80:83], v22, s[8:11], s46 offen offset:0 sc1
  buffer_store_dwordx4 v[84:87], v22, s[8:11], s46 offen offset:1024 sc1
  s_add_u32 s46, s46, 0x2000
  v_accvgpr_read_b32 v64, a80
  v_accvgpr_read_b32 v65, a81
  v_accvgpr_read_b32 v66, a82
  v_accvgpr_read_b32 v67, a83
  v_accvgpr_read_b32 v68, a84
  v_accvgpr_read_b32 v69, a85
  v_accvgpr_read_b32 v70, a86
  v_accvgpr_read_b32 v71, a87
  v_accvgpr_read_b32 v72, a112
  v_accvgpr_read_b32 v73, a113
  v_accvgpr_read_b32 v74, a114
  v_accvgpr_read_b32 v75, a115
  v_accvgpr_read_b32 v76, a116
  v_accvgpr_read_b32 v77, a117
  v_accvgpr_read_b32 v78, a118
  v_accvgpr_read_b32 v79, a119
  v_pk_mul_f32 v[64:65], v[64:65], v[234:235] op_sel:[0,0] op_sel_hi:[1,0]
  v_pk_mul_f32 v[66:67], v[66:67], v[234:235] op_sel:[0,0] op_sel_hi:[1,0]
  v_pk_mul_f32 v[68:69], v[68:69], v[234:235] op_sel:[0,0] op_sel_hi:[1,0]
  v_pk_mul_f32 v[70:71], v[70:71], v[234:235] op_sel:[0,0] op_sel_hi:[1,0]
  v_pk_mul_f32 v[72:73], v[72:73], v[234:235] op_sel:[0,1] op_sel_hi:[1,1]
  v_pk_mul_f32 v[74:75], v[74:75], v[234:235] op_sel:[0,1] op_sel_hi:[1,1]
  v_pk_mul_f32 v[76:77], v[76:77], v[234:235] op_sel:[0,1] op_sel_hi:[1,1]
  v_pk_mul_f32 v[78:79], v[78:79], v[234:235] op_sel:[0,1] op_sel_hi:[1,1]
  v_cvt_pk_bf16_f32 v64, v64, v65
  v_cvt_pk_bf16_f32 v65, v66, v67
  v_cvt_pk_bf16_f32 v66, v68, v69
  v_cvt_pk_bf16_f32 v67, v70, v71
  v_cvt_pk_bf16_f32 v68, v72, v73
  v_cvt_pk_bf16_f32 v69, v74, v75
  v_cvt_pk_bf16_f32 v70, v76, v77
  v_cvt_pk_bf16_f32 v71, v78, v79
  buffer_store_dwordx4 v[64:67], v22, s[8:11], s46 offen offset:0 sc1
  buffer_store_dwordx4 v[68:71], v22, s[8:11], s46 offen offset:1024 sc1
  s_add_u32 s46, s46, 0x2000
  v_accvgpr_read_b32 v80, a88
  v_accvgpr_read_b32 v81, a89
  v_accvgpr_read_b32 v82, a90
  v_accvgpr_read_b32 v83, a91
  v_accvgpr_read_b32 v84, a92
  v_accvgpr_read_b32 v85, a93
  v_accvgpr_read_b32 v86, a94
  v_accvgpr_read_b32 v87, a95
  v_accvgpr_read_b32 v88, a120
  v_accvgpr_read_b32 v89, a121
  v_accvgpr_read_b32 v90, a122
  v_accvgpr_read_b32 v91, a123
  v_accvgpr_read_b32 v92, a124
  v_accvgpr_read_b32 v93, a125
  v_accvgpr_read_b32 v94, a126
  v_accvgpr_read_b32 v95, a127
  v_pk_mul_f32 v[80:81], v[80:81], v[234:235] op_sel:[0,0] op_sel_hi:[1,0]
  v_pk_mul_f32 v[82:83], v[82:83], v[234:235] op_sel:[0,0] op_sel_hi:[1,0]
  v_pk_mul_f32 v[84:85], v[84:85], v[234:235] op_sel:[0,0] op_sel_hi:[1,0]
  v_pk_mul_f32 v[86:87], v[86:87], v[234:235] op_sel:[0,0] op_sel_hi:[1,0]
  v_pk_mul_f32 v[88:89], v[88:89], v[234:235] op_sel:[0,1] op_sel_hi:[1,1]
  v_pk_mul_f32 v[90:91], v[90:91], v[234:235] op_sel:[0,1] op_sel_hi:[1,1]
  v_pk_mul_f32 v[92:93], v[92:93], v[234:235] op_sel:[0,1] op_sel_hi:[1,1]
  v_pk_mul_f32 v[94:95], v[94:95], v[234:235] op_sel:[0,1] op_sel_hi:[1,1]
  v_cvt_pk_bf16_f32 v80, v80, v81
  v_cvt_pk_bf16_f32 v81, v82, v83
  v_cvt_pk_bf16_f32 v82, v84, v85
  v_cvt_pk_bf16_f32 v83, v86, v87
  v_cvt_pk_bf16_f32 v84, v88, v89
  v_cvt_pk_bf16_f32 v85, v90, v91
  v_cvt_pk_bf16_f32 v86, v92, v93
  v_cvt_pk_bf16_f32 v87, v94, v95
  v_mfma_f32_32x32x16_bf16 a[80:95], v[144:147], v[144:147], 0
  v_mfma_f32_32x32x16_bf16 a[112:127], v[144:147], v[144:147], 0
  buffer_store_dwordx4 v[80:83], v22, s[8:11], s46 offen offset:0 sc1
  buffer_store_dwordx4 v[84:87], v22, s[8:11], s46 offen offset:1024 sc1
  s_and_b32 s32, s39, 0x1ffff
  s_add_u32 m0, s32, s94
  s_nop 0
  buffer_load_dwordx4 v2, s[24:27], s39 offen offset:0 sc1 lds
  buffer_load_dwordx4 v2, s[24:27], s39 offen offset:1024 sc1 lds
  s_add_u32 s39, s39, 0x4000
  s_and_b32 s32, s39, 0x1ffff
  s_add_u32 m0, s32, s94
  s_nop 0
  buffer_load_dwordx4 v2, s[24:27], s39 offen offset:0 sc1 lds
  buffer_load_dwordx4 v2, s[24:27], s39 offen offset:1024 sc1 lds
  s_add_u32 s39, s39, 0x4000
  s_mov_b32 s93, 1.0
  s_lshl_b32 s45, s29, 1
  s_sub_u32 s45, 14, s45
  s_getpc_b64 s[82:83]
M_l2_pc:
  s_add_u32 s82, s82, M_l2-M_l2_pc
  s_addc_u32 s83, s83, 0
M_l2:
  v_mfma_f32_16x16x32_bf16 v[64:67], a[128:131], v[160:163], v[96:99]
  s_add_u32 s40, s40, 1
  v_exp_f32 v224, v44
  v_exp_f32 v225, v45
  v_mfma_f32_16x16x32_bf16 v[72:75], a[128:131], v[176:179], v[104:107]
  s_add_u32 s41, s41, 2
  v_exp_f32 v226, v52
  v_mfma_f32_16x16x32_bf16 v[80:83], a[128:131], v[192:195], v[112:115]
  ds_read_b128 a[144:147], v7 offset:4096
  v_cvt_pk_bf16_f32 v134, v224, v225
  v_mfma_f32_16x16x32_bf16 v[88:91], a[128:131], v[208:211], v[120:123]
  s_max_i32 s92, s40, s41
  v_exp_f32 v227, v53
  v_mfma_f32_16x16x32_bf16 v[64:67], a[132:135], v[164:167], v[64:67]
  s_lshl_b32 s37, s92, 14
  v_exp_f32 v228, v60
  v_mfma_f32_16x16x32_bf16 v[72:75], a[132:135], v[180:183], v[72:75]
  s_and_b32 s37, s37, 0x1ffff
  v_exp_f32 v229, v61
  v_mfma_f32_16x16x32_bf16 v[80:83], a[132:135], v[196:199], v[80:83]
  ds_read_b128 a[148:151], v7 offset:5120
  s_and_b32 s32, s38, 0x1ffff
  v_cvt_pk_bf16_f32 v138, v226, v227
  v_mfma_f32_16x16x32_bf16 v[88:91], a[132:135], v[212:215], v[88:91]
  s_waitcnt lgkmcnt(2)
  s_add_u32 m0, s32, s94
  v_cvt_pk_bf16_f32 v142, v228, v229
  v_mfma_f32_16x16x32_bf16 v[64:67], a[136:139], v[168:171], v[64:67]
  buffer_load_dwordx4 v2, s[24:27], s38 offen offset:0 sc1 lds
  v_mfma_f32_16x16x32_bf16 v[72:75], a[136:139], v[184:187], v[72:75]
  v_exp_f32 v230, v38
  v_mfma_f32_16x16x32_bf16 v[80:83], a[136:139], v[200:203], v[80:83]
  ds_read_b128 a[152:155], v7 offset:6144
  v_mfma_f32_16x16x32_bf16 v[88:91], a[136:139], v[216:219], v[88:91]
  v_exp_f32 v231, v39
  v_exp_f32 v224, v46
  v_mfma_f32_16x16x32_bf16 v[64:67], a[140:143], v[172:175], v[64:67]
  v_exp_f32 v225, v47
  v_mfma_f32_16x16x32_bf16 v[72:75], a[140:143], v[188:191], v[72:75]
  v_exp_f32 v226, v54
  v_mfma_f32_16x16x32_bf16 v[80:83], a[140:143], v[204:207], v[80:83]
  ds_read_b128 a[156:159], v7 offset:7168
  v_cvt_pk_bf16_f32 v131, v230, v231
  v_mfma_f32_16x16x32_bf16 v[88:91], a[140:143], v[220:223], v[88:91]
  s_waitcnt lgkmcnt(2)
  v_exp_f32 v227, v55
  v_mfma_f32_16x16x32_bf16 v[68:71], a[144:147], v[160:163], v[100:103]
  buffer_load_dwordx4 v2, s[24:27], s38 offen offset:1024 sc1 lds
  s_add_u32 s38, s38, 0x4000
  v_mfma_f32_16x16x32_bf16 v[76:79], a[144:147], v[176:179], v[108:111]
  v_exp_f32 v228, v62
  v_mfma_f32_16x16x32_bf16 v[84:87], a[144:147], v[192:195], v[116:119]
  ds_read_b128 a[160:163], v6 offset:8192
  v_cvt_pk_bf16_f32 v135, v224, v225
  v_mfma_f32_16x16x32_bf16 v[92:95], a[144:147], v[208:211], v[124:127]
  v_exp_f32 v229, v63
  v_mfma_f32_16x16x32_bf16 v[68:71], a[148:151], v[164:167], v[68:71]
  v_cvt_pk_bf16_f32 v139, v226, v227
  v_cvt_pk_bf16_f32 v143, v228, v229
  v_mfma_f32_16x16x32_bf16 v[76:79], a[148:151], v[180:183], v[76:79]
  s_and_b32 s32, s38, 0x1ffff
  v_mfma_f32_16x16x32_bf16 v[84:87], a[148:151], v[196:199], v[84:87]
  ds_read_b128 a[164:167], v6 offset:9216
  s_add_u32 m0, s32, s94
  v_mfma_f32_16x16x32_bf16 v[92:95], a[148:151], v[212:215], v[92:95]
  buffer_load_dwordx4 v2, s[24:27], s38 offen offset:0 sc1 lds
  v_mfma_f32_16x16x32_bf16 v[144:147], v[12:15], v[128:131], 0
  v_exp_f32 v224, v64
  v_mfma_f32_16x16x32_bf16 v[148:151], v[12:15], v[132:135], 0
  v_exp_f32 v225, v65
  v_mfma_f32_16x16x32_bf16 v[152:155], v[12:15], v[136:139], 0
  ds_read_b128 a[168:171], v6 offset:10240
  v_mfma_f32_16x16x32_bf16 v[156:159], v[12:15], v[140:143], 0
  s_waitcnt lgkmcnt(3)
  v_exp_f32 v226, v72
  v_mfma_f32_16x16x32_bf16 v[68:71], a[152:155], v[168:171], v[68:71]
  buffer_load_dwordx4 v2, s[24:27], s38 offen offset:1024 sc1 lds
  s_add_u32 s38, s38, 0x4000
  v_mfma_f32_16x16x32_bf16 v[76:79], a[152:155], v[184:187], v[76:79]
  v_exp_f32 v227, v73
  v_mfma_f32_16x16x32_bf16 v[84:87], a[152:155], v[200:203], v[84:87]
  ds_read_b128 a[172:175], v6 offset:11264
  v_mfma_f32_16x16x32_bf16 v[92:95], a[152:155], v[216:219], v[92:95]
  s_and_b32 s32, s39, 0x1ffff
  v_mfma_f32_16x16x32_bf16 v[68:71], a[156:159], v[172:175], v[68:71]
  s_add_u32 m0, s32, s94
  v_max3_f32 v232, v144, v148, v152
  v_max_f32 v232, v232, v156
  v_mfma_f32_16x16x32_bf16 v[76:79], a[156:159], v[188:191], v[76:79]
  buffer_load_dwordx4 v2, s[24:27], s39 offen offset:0 sc1 lds
  v_mfma_f32_16x16x32_bf16 v[84:87], a[156:159], v[204:207], v[84:87]
  ds_read_b128 a[176:179], v6 offset:12288
  v_cmp_lt_f32 vcc, s44, v232
  v_mfma_f32_16x16x32_bf16 v[92:95], a[156:159], v[220:223], v[92:95]
  s_waitcnt lgkmcnt(3)
  s_cbranch_vccnz M_sl_12
M_sl_12_r:
  v_mfma_f32_16x16x32_bf16 a[0:3], a[160:163], v[128:131], a[0:3]
  v_add_f32 v8, v8, v144
  v_add_f32 v9, v9, v148
  v_mfma_f32_16x16x32_bf16 a[32:35], a[160:163], v[132:135], a[32:35]
  v_add_f32 v10, v10, v152
  v_add_f32 v11, v11, v156
  v_mfma_f32_16x16x32_bf16 a[64:67], a[160:163], v[136:139], a[64:67]
  ds_read_b128 a[180:183], v6 offset:13312
  v_cvt_pk_bf16_f32 v144, v224, v225
  v_mfma_f32_16x16x32_bf16 a[96:99], a[160:163], v[140:143], a[96:99]
  v_exp_f32 v228, v80
  v_mfma_f32_16x16x32_bf16 a[4:7], a[164:167], v[128:131], a[4:7]
  buffer_load_dwordx4 v2, s[24:27], s39 offen offset:1024 sc1 lds
  s_add_u32 s39, s39, 0x4000
  v_mfma_f32_16x16x32_bf16 a[36:39], a[164:167], v[132:135], a[36:39]
  v_exp_f32 v229, v81
  v_mfma_f32_16x16x32_bf16 a[68:71], a[164:167], v[136:139], a[68:71]
  ds_read_b128 a[184:187], v6 offset:14336
  v_cvt_pk_bf16_f32 v148, v226, v227
  v_mfma_f32_16x16x32_bf16 a[100:103], a[164:167], v[140:143], a[100:103]
  s_waitcnt lgkmcnt(3)
  s_and_b32 s32, s39, 0x1ffff
  v_cvt_pk_bf16_f32 v152, v228, v229
  v_mfma_f32_16x16x32_bf16 a[8:11], a[168:171], v[128:131], a[8:11]
  s_add_u32 m0, s32, s94
  v_exp_f32 v230, v88
  v_mfma_f32_16x16x32_bf16 a[40:43], a[168:171], v[132:135], a[40:43]
  buffer_load_dwordx4 v2, s[24:27], s39 offen offset:0 sc1 lds
  v_mfma_f32_16x16x32_bf16 a[72:75], a[168:171], v[136:139], a[72:75]
  ds_read_b128 a[188:191], v6 offset:15360
  v_add_u32 v6, s37, v22
  v_mfma_f32_16x16x32_bf16 a[104:107], a[168:171], v[140:143], a[104:107]
  v_exp_f32 v231, v89
  v_mfma_f32_16x16x32_bf16 a[12:15], a[172:175], v[128:131], a[12:15]
  v_exp_f32 v224, v66
  v_mfma_f32_16x16x32_bf16 a[44:47], a[172:175], v[132:135], a[44:47]
  v_exp_f32 v225, v67
  v_mfma_f32_16x16x32_bf16 a[76:79], a[172:175], v[136:139], a[76:79]
  buffer_load_dwordx4 v2, s[24:27], s39 offen offset:1024 sc1 lds
  s_add_u32 s39, s39, 0x4000
  v_mfma_f32_16x16x32_bf16 a[108:111], a[172:175], v[140:143], a[108:111]
  s_waitcnt lgkmcnt(2)
  v_exp_f32 v226, v74
  v_mfma_f32_16x16x32_bf16 a[16:19], a[176:179], v[128:131], a[16:19]
  v_exp_f32 v227, v75
  v_mfma_f32_16x16x32_bf16 a[48:51], a[176:179], v[132:135], a[48:51]
  s_waitcnt vmcnt(12)
  s_barrier
  v_mfma_f32_16x16x32_bf16 a[80:83], a[176:179], v[136:139], a[80:83]
  ds_read_b128 a[128:131], v6 offset:0
  v_cvt_pk_bf16_f32 v156, v230, v231
  v_mfma_f32_16x16x32_bf16 a[112:115], a[176:179], v[140:143], a[112:115]
  v_exp_f32 v228, v82
  v_mfma_f32_16x16x32_bf16 a[20:23], a[180:183], v[128:131], a[20:23]
  ds_read_b128 a[132:135], v6 offset:1024
  v_cvt_pk_bf16_f32 v145, v224, v225
  v_mfma_f32_16x16x32_bf16 a[52:55], a[180:183], v[132:135], a[52:55]
  v_exp_f32 v229, v83
  v_mfma_f32_16x16x32_bf16 a[84:87], a[180:183], v[136:139], a[84:87]
  v_exp_f32 v230, v90
  v_mfma_f32_16x16x32_bf16 a[116:119], a[180:183], v[140:143], a[116:119]
  s_waitcnt lgkmcnt(2)
  v_exp_f32 v231, v91
  v_mfma_f32_16x16x32_bf16 a[24:27], a[184:187], v[128:131], a[24:27]
  ds_read_b128 a[136:139], v6 offset:2048
  v_cvt_pk_bf16_f32 v149, v226, v227
  v_mfma_f32_16x16x32_bf16 a[56:59], a[184:187], v[132:135], a[56:59]
  v_exp_f32 v224, v68
  v_mfma_f32_16x16x32_bf16 a[88:91], a[184:187], v[136:139], a[88:91]
  ds_read_b128 a[140:143], v6 offset:3072
  v_cvt_pk_bf16_f32 v153, v228, v229
  v_mfma_f32_16x16x32_bf16 a[120:123], a[184:187], v[140:143], a[120:123]
  v_exp_f32 v225, v69
  v_mfma_f32_16x16x32_bf16 a[28:31], a[188:191], v[128:131], a[28:31]
  s_bitcmp1_b64 s[54:55], s40
  s_cbranch_scc1 M_ev_13
M_ev_13_r:
  v_mfma_f32_16x16x32_bf16 a[60:63], a[188:191], v[132:135], a[60:63]
  v_cvt_pk_bf16_f32 v157, v230, v231
  v_cvt_pk_bf16_f32 v146, v224, v225
  v_mfma_f32_16x16x32_bf16 a[92:95], a[188:191], v[136:139], a[92:95]
  s_waitcnt lgkmcnt(2)
  v_mfma_f32_16x16x32_bf16 a[124:127], a[188:191], v[140:143], a[124:127]
  s_sub_u32 s45, s45, 1
  s_cbranch_scc1 M_l2x
  v_mfma_f32_16x16x32_bf16 v[32:35], a[128:131], v[160:163], v[96:99]
  s_add_u32 s40, s40, 1
  v_exp_f32 v224, v76
  v_exp_f32 v225, v77
  v_mfma_f32_16x16x32_bf16 v[40:43], a[128:131], v[176:179], v[104:107]
  s_add_u32 s41, s41, 2
  v_exp_f32 v226, v84
  v_mfma_f32_16x16x32_bf16 v[48:51], a[128:131], v[192:195], v[112:115]
  ds_read_b128 a[144:147], v6 offset:4096
  v_cvt_pk_bf16_f32 v150, v224, v225
  v_mfma_f32_16x16x32_bf16 v[56:59], a[128:131], v[208:211], v[120:123]
  s_max_i32 s92, s40, s41
  v_exp_f32 v227, v85
  v_mfma_f32_16x16x32_bf16 v[32:35], a[132:135], v[164:167], v[32:35]
  s_lshl_b32 s37, s92, 14
  v_exp_f32 v228, v92
  v_mfma_f32_16x16x32_bf16 v[40:43], a[132:135], v[180:183], v[40:43]
  s_and_b32 s37, s37, 0x1ffff
  v_exp_f32 v229, v93
  v_mfma_f32_16x16x32_bf16 v[48:51], a[132:135], v[196:199], v[48:51]
  ds_read_b128 a[148:151], v6 offset:5120
  s_and_b32 s32, s38, 0x1ffff
  v_cvt_pk_bf16_f32 v154, v226, v227
  v_mfma_f32_16x16x32_bf16 v[56:59], a[132:135], v[212:215], v[56:59]
  s_waitcnt lgkmcnt(2)
  s_add_u32 m0, s32, s94
  v_cvt_pk_bf16_f32 v158, v228, v229
  v_mfma_f32_16x16x32_bf16 v[32:35], a[136:139], v[168:171], v[32:35]
  buffer_load_dwordx4 v2, s[24:27], s38 offen offset:0 sc1 lds
  v_mfma_f32_16x16x32_bf16 v[40:43], a[136:139], v[184:187], v[40:43]
  v_exp_f32 v230, v70
  v_mfma_f32_16x16x32_bf16 v[48:51], a[136:139], v[200:203], v[48:51]
  ds_read_b128 a[152:155], v6 offset:6144
  v_mfma_f32_16x16x32_bf16 v[56:59], a[136:139], v[216:219], v[56:59]
  v_exp_f32 v231, v71
  v_exp_f32 v224, v78
  v_mfma_f32_16x16x32_bf16 v[32:35], a[140:143], v[172:175], v[32:35]
  v_exp_f32 v225, v79
  v_mfma_f32_16x16x32_bf16 v[40:43], a[140:143], v[188:191], v[40:43]
  v_exp_f32 v226, v86
  v_mfma_f32_16x16x32_bf16 v[48:51], a[140:143], v[204:207], v[48:51]
  ds_read_b128 a[156:159], v6 offset:7168
  v_cvt_pk_bf16_f32 v147, v230, v231
  v_mfma_f32_16x16x32_bf16 v[56:59], a[140:143], v[220:223], v[56:59]
  s_waitcnt lgkmcnt(2)
  v_exp_f32 v227, v87
  v_mfma_f32_16x16x32_bf16 v[36:39], a[144:147], v[160:163], v[100:103]
  buffer_load_dwordx4 v2, s[24:27], s38 offen offset:1024 sc1 lds
  s_add_u32 s38, s38, 0x4000
  v_mfma_f32_16x16x32_bf16 v[44:47], a[144:147], v[176:179], v[108:111]
  v_exp_f32 v228, v94
  v_mfma_f32_16x16x32_bf16 v[52:55], a[144:147], v[192:195], v[116:119]
  ds_read_b128 a[160:163], v7 offset:8192
  v_cvt_pk_bf16_f32 v151, v224, v225
  v_mfma_f32_16x16x32_bf16 v[60:63], a[144:147], v[208:211], v[124:127]
  v_exp_f32 v229, v95
  v_mfma_f32_16x16x32_bf16 v[36:39], a[148:151], v[164:167], v[36:39]
  v_cvt_pk_bf16_f32 v155, v226, v227
  v_cvt_pk_bf16_f32 v159, v228, v229
  v_mfma_f32_16x16x32_bf16 v[44:47], a[148:151], v[180:183], v[44:47]
  s_and_b32 s32, s38, 0x1ffff
  v_mfma_f32_16x16x32_bf16 v[52:55], a[148:151], v[196:199], v[52:55]
  ds_read_b128 a[164:167], v7 offset:9216
  s_add_u32 m0, s32, s94
  v_mfma_f32_16x16x32_bf16 v[60:63], a[148:151], v[212:215], v[60:63]
  buffer_load_dwordx4 v2, s[24:27], s38 offen offset:0 sc1 lds
  v_mfma_f32_16x16x32_bf16 v[128:131], v[12:15], v[144:147], 0
  v_exp_f32 v224, v32
  v_mfma_f32_16x16x32_bf16 v[132:135], v[12:15], v[148:151], 0
  v_exp_f32 v225, v33
  v_mfma_f32_16x16x32_bf16 v[136:139], v[12:15], v[152:155], 0
  ds_read_b128 a[168:171], v7 offset:10240
  v_mfma_f32_16x16x32_bf16 v[140:143], v[12:15], v[156:159], 0
  s_waitcnt lgkmcnt(3)
  v_exp_f32 v226, v40
  v_mfma_f32_16x16x32_bf16 v[36:39], a[152:155], v[168:171], v[36:39]
  buffer_load_dwordx4 v2, s[24:27], s38 offen offset:1024 sc1 lds
  s_add_u32 s38, s38, 0x4000
  v_mfma_f32_16x16x32_bf16 v[44:47], a[152:155], v[184:187], v[44:47]
  v_exp_f32 v227, v41
  v_mfma_f32_16x16x32_bf16 v[52:55], a[152:155], v[200:203], v[52:55]
  ds_read_b128 a[172:175], v7 offset:11264
  v_mfma_f32_16x16x32_bf16 v[60:63], a[152:155], v[216:219], v[60:63]
  s_and_b32 s32, s39, 0x1ffff
  v_mfma_f32_16x16x32_bf16 v[36:39], a[156:159], v[172:175], v[36:39]
  s_add_u32 m0, s32, s94
  v_max3_f32 v232, v128, v132, v136
  v_max_f32 v232, v232, v140
  v_mfma_f32_16x16x32_bf16 v[44:47], a[156:159], v[188:191], v[44:47]
  buffer_load_dwordx4 v2, s[24:27], s39 offen offset:0 sc1 lds
  v_mfma_f32_16x16x32_bf16 v[52:55], a[156:159], v[204:207], v[52:55]
  ds_read_b128 a[176:179], v7 offset:12288
  v_cmp_lt_f32 vcc, s44, v232
  v_mfma_f32_16x16x32_bf16 v[60:63], a[156:159], v[220:223], v[60:63]
  s_waitcnt lgkmcnt(3)
  s_cbranch_vccnz M_sl_14
M_sl_14_r:
  v_mfma_f32_16x16x32_bf16 a[0:3], a[160:163], v[144:147], a[0:3]
  v_add_f32 v8, v8, v128
  v_add_f32 v9, v9, v132
  v_mfma_f32_16x16x32_bf16 a[32:35], a[160:163], v[148:151], a[32:35]
  v_add_f32 v10, v10, v136
  v_add_f32 v11, v11, v140
  v_mfma_f32_16x16x32_bf16 a[64:67], a[160:163], v[152:155], a[64:67]
  ds_read_b128 a[180:183], v7 offset:13312
  v_cvt_pk_bf16_f32 v128, v224, v225
  v_mfma_f32_16x16x32_bf16 a[96:99], a[160:163], v[156:159], a[96:99]
  v_exp_f32 v228, v48
  v_mfma_f32_16x16x32_bf16 a[4:7], a[164:167], v[144:147], a[4:7]
  buffer_load_dwordx4 v2, s[24:27], s39 offen offset:1024 sc1 lds
  s_add_u32 s39, s39, 0x4000
  v_mfma_f32_16x16x32_bf16 a[36:39], a[164:167], v[148:151], a[36:39]
  v_exp_f32 v229, v49
  v_mfma_f32_16x16x32_bf16 a[68:71], a[164:167], v[152:155], a[68:71]
  ds_read_b128 a[184:187], v7 offset:14336
  v_cvt_pk_bf16_f32 v132, v226, v227
  v_mfma_f32_16x16x32_bf16 a[100:103], a[164:167], v[156:159], a[100:103]
  s_waitcnt lgkmcnt(3)
  s_and_b32 s32, s39, 0x1ffff
  v_cvt_pk_bf16_f32 v136, v228, v229
  v_mfma_f32_16x16x32_bf16 a[8:11], a[168:171], v[144:147], a[8:11]
  s_add_u32 m0, s32, s94
  v_exp_f32 v230, v56
  v_mfma_f32_16x16x32_bf16 a[40:43], a[168:171], v[148:151], a[40:43]
  buffer_load_dwordx4 v2, s[24:27], s39 offen offset:0 sc1 lds
  v_mfma_f32_16x16x32_bf16 a[72:75], a[168:171], v[152:155], a[72:75]
  ds_read_b128 a[188:191], v7 offset:15360
  v_add_u32 v7, s37, v22
  v_mfma_f32_16x16x32_bf16 a[104:107], a[168:171], v[156:159], a[104:107]
  v_exp_f32 v231, v57
  v_mfma_f32_16x16x32_bf16 a[12:15], a[172:175], v[144:147], a[12:15]
  v_exp_f32 v224, v34
  v_mfma_f32_16x16x32_bf16 a[44:47], a[172:175], v[148:151], a[44:47]
  v_exp_f32 v225, v35
  v_mfma_f32_16x16x32_bf16 a[76:79], a[172:175], v[152:155], a[76:79]
  buffer_load_dwordx4 v2, s[24:27], s39 offen offset:1024 sc1 lds
  s_add_u32 s39, s39, 0x4000
  v_mfma_f32_16x16x32_bf16 a[108:111], a[172:175], v[156:159], a[108:111]
  s_waitcnt lgkmcnt(2)
  v_exp_f32 v226, v42
  v_mfma_f32_16x16x32_bf16 a[16:19], a[176:179], v[144:147], a[16:19]
  v_exp_f32 v227, v43
  v_mfma_f32_16x16x32_bf16 a[48:51], a[176:179], v[148:151], a[48:51]
  s_waitcnt vmcnt(12)
  s_barrier
  v_mfma_f32_16x16x32_bf16 a[80:83], a[176:179], v[152:155], a[80:83]
  ds_read_b128 a[128:131], v7 offset:0
  v_cvt_pk_bf16_f32 v140, v230, v231
  v_mfma_f32_16x16x32_bf16 a[112:115], a[176:179], v[156:159], a[112:115]
  v_exp_f32 v228, v50
  v_mfma_f32_16x16x32_bf16 a[20:23], a[180:183], v[144:147], a[20:23]
  ds_read_b128 a[132:135], v7 offset:1024
  v_cvt_pk_bf16_f32 v129, v224, v225
  v_mfma_f32_16x16x32_bf16 a[52:55], a[180:183], v[148:151], a[52:55]
  v_exp_f32 v229, v51
  v_mfma_f32_16x16x32_bf16 a[84:87], a[180:183], v[152:155], a[84:87]
  v_exp_f32 v230, v58
  v_mfma_f32_16x16x32_bf16 a[116:119], a[180:183], v[156:159], a[116:119]
  s_waitcnt lgkmcnt(2)
  v_exp_f32 v231, v59
  v_mfma_f32_16x16x32_bf16 a[24:27], a[184:187], v[144:147], a[24:27]
  ds_read_b128 a[136:139], v7 offset:2048
  v_cvt_pk_bf16_f32 v133, v226, v227
  v_mfma_f32_16x16x32_bf16 a[56:59], a[184:187], v[148:151], a[56:59]
  v_exp_f32 v224, v36
  v_mfma_f32_16x16x32_bf16 a[88:91], a[184:187], v[152:155], a[88:91]
  ds_read_b128 a[140:143], v7 offset:3072
  v_cvt_pk_bf16_f32 v137, v228, v229
  v_mfma_f32_16x16x32_bf16 a[120:123], a[184:187], v[156:159], a[120:123]
  v_exp_f32 v225, v37
  v_mfma_f32_16x16x32_bf16 a[28:31], a[188:191], v[144:147], a[28:31]
  s_bitcmp1_b64 s[54:55], s40
  s_cbranch_scc1 M_ev_15
M_ev_15_r:
  v_mfma_f32_16x16x32_bf16 a[60:63], a[188:191], v[148:151], a[60:63]
  v_cvt_pk_bf16_f32 v141, v230, v231
  v_cvt_pk_bf16_f32 v130, v224, v225
  v_mfma_f32_16x16x32_bf16 a[92:95], a[188:191], v[152:155], a[92:95]
  s_waitcnt lgkmcnt(2)
  v_mfma_f32_16x16x32_bf16 a[124:127], a[188:191], v[156:159], a[124:127]
  s_mov_b32 s32, 0x2000a2a8
  s_bitcmp1_b32 s32, s40
  s_cbranch_scc0 M_l2
  s_cmp_eq_u32 s40, 3
  s_cbranch_scc1 M_hook3
  s_cmp_eq_u32 s40, 5
  s_cbranch_scc1 M_hook5
  s_cmp_eq_u32 s40, 7
  s_cbranch_scc1 M_hook7
  s_cmp_eq_u32 s40, 9
  s_cbranch_scc1 M_hook9
  s_cmp_eq_u32 s40, 13
  s_cbranch_scc1 M_hook13
  s_cmp_eq_u32 s40, 15
  s_cbranch_scc1 M_hook15
M_hook29:
  s_lshl_b32 s32, s36, 2
  s_add_u32 s32, s32, s30
  s_lshl_b32 s32, s32, 9
  v_and_b32 v23, 3, v1
  v_lshl_add_u32 v23, v23, 7, s32
  v_min_u32 v23, M_codeend-M_pc0-4, v23
  global_load_dword v5, v23, s[96:97]
  s_setpc_b64 s[82:83]
M_hook15:
  s_waitcnt vmcnt(8)
  v_cmp_gt_u32 vcc, v21, v26
  s_nop 0
  s_cbranch_vccnz M_poll_19
M_poll_19_r:
  s_lshr_b32 s33, s35, 1
  s_xor_b32 s32, s33, 3
  s_lshl2_add_u32 s32, s32, s33
  s_mul_i32 s32, s32, 10240
  buffer_store_dwordx4 a[248:251], v5, s[16:19], s32 offen offset:0 sc1
  buffer_store_dwordx4 a[248:251], v5, s[16:19], s32 offen offset:1024 sc1
  buffer_store_dwordx2 a[248:249], v28, s[16:19], s32 offen offset:2048 sc1
  s_lshl_b32 s50, s35, 3
  s_lshl_b32 s32, s30, 1
  s_add_u32 s50, s50, s32
  s_mul_i32 s32, s50, 122880
  s_add_u32 s12, s80, s32
  s_addc_u32 s13, s81, 0
  s_add_u32 s12, s12, 0x3000000
  s_addc_u32 s13, s13, 0
  s_mov_b32 s14, 0x3c000
  s_mov_b32 s15, 0x20000
  s_mul_i32 s32, s36, 5
  s_lshr_b32 s32, s32, 2
  s_add_u32 s32, s32, 0
  s_lshl_b32 s32, s32, 10
  buffer_load_dwordx4 a[232:235], v22, s[12:15], s32 offen offset:0 sc1
  buffer_load_dwordx4 a[236:239], v22, s[12:15], s32 offen offset:1024 sc1
  s_add_u32 s32, s32, 122880
  buffer_load_dwordx4 a[240:243], v22, s[12:15], s32 offen offset:0 sc1
  buffer_load_dwordx4 a[244:247], v22, s[12:15], s32 offen offset:1024 sc1
  s_lshl_b32 s32, s36, 16
  s_lshl_b32 s33, s30, 14
  s_add_u32 s32, s32, s33
  s_add_u32 s16, s80, s32
  s_addc_u32 s17, s81, 0
  s_add_u32 s16, s16, 0x4400000
  s_addc_u32 s17, s17, 0
  s_mov_b32 s18, 0x4000
  s_mov_b32 s19, 0x20000
  s_mov_b32 s32, 0
  buffer_load_dwordx4 a[192:195], v22, s[16:19], s32 offen offset:0 sc1
  buffer_load_dwordx4 a[196:199], v22, s[16:19], s32 offen offset:1024 sc1
  buffer_load_dwordx4 a[200:203], v22, s[16:19], s32 offen offset:2048 sc1
  buffer_load_dwordx4 a[204:207], v22, s[16:19], s32 offen offset:3072 sc1
  s_mov_b32 s32, 4096
  buffer_load_dwordx4 a[208:211], v22, s[16:19], s32 offen offset:0 sc1
  s_mov_b32 s32, 8192
  buffer_load_dwordx4 a[212:215], v22, s[16:19], s32 offen offset:0 sc1
  buffer_load_dwordx4 a[216:219], v22, s[16:19], s32 offen offset:1024 sc1
  buffer_load_dwordx4 a[220:223], v22, s[16:19], s32 offen offset:2048 sc1
  buffer_load_dwordx4 a[224:227], v22, s[16:19], s32 offen offset:3072 sc1
  s_mov_b32 s32, 12288
  buffer_load_dwordx4 a[228:231], v22, s[16:19], s32 offen offset:0 sc1
  s_setpc_b64 s[82:83]
M_hook13:
  buffer_load_dword v26, v20, s[20:23], 0 offen sc1
  s_lshr_b32 s33, s35, 1
  s_xor_b32 s32, s33, 2
  s_lshl2_add_u32 s32, s32, s33
  s_mul_i32 s32, s32, 10240
  buffer_store_dwordx4 a[248:251], v5, s[16:19], s32 offen offset:0 sc1
  buffer_store_dwordx4 a[248:251], v5, s[16:19], s32 offen offset:1024 sc1
  buffer_store_dwordx2 a[248:249], v28, s[16:19], s32 offen offset:2048 sc1
  s_setpc_b64 s[82:83]
M_hook9:
  s_cmp_lg_u32 s30, 0
  s_cbranch_scc1 M_pub_18
  s_lshl_b32 s32, s2, 7
  v_mov_b32 v23, 4
  v_lshlrev_b32 v24, 2, v1
  s_mov_b32 exec_hi, 0
  buffer_store_dword v23, v24, s[20:23], s32 offen sc1
  s_mov_b64 exec, -1
M_pub_18:
  s_and_b32 s32, s35, 1
  s_lshl_b32 s32, s32, 5
  s_add_u32 s32, s32, s36
  s_mul_i32 s32, s32, 163840
  s_add_u32 s16, s80, s32
  s_addc_u32 s17, s81, 0
  s_add_u32 s16, s16, 0x4c00000
  s_addc_u32 s17, s17, 0
  s_mov_b32 s18, 0x28000
  s_mov_b32 s19, 0x20000
  s_mul_i32 s32, s30, 2560
  v_add_u32 v5, s32, v22
  v_lshl_add_u32 v28, v1, 3, s32
  v_accvgpr_write_b32 a248, -1
  v_accvgpr_write_b32 a249, -1
  v_accvgpr_write_b32 a250, -1
  v_accvgpr_write_b32 a251, -1
  s_lshr_b32 s33, s35, 1
  s_xor_b32 s32, s33, 1
  s_lshl2_add_u32 s32, s32, s33
  s_mul_i32 s32, s32, 10240
  buffer_store_dwordx4 a[248:251], v5, s[16:19], s32 offen offset:0 sc1
  buffer_store_dwordx4 a[248:251], v5, s[16:19], s32 offen offset:1024 sc1
  buffer_store_dwordx2 a[248:249], v28, s[16:19], s32 offen offset:2048 sc1
  s_setpc_b64 s[82:83]
M_hook7:
  s_waitcnt vmcnt(8)
  v_cmp_gt_u32 vcc, 3, v5
  s_nop 0
  s_cbranch_vccnz M_poll_17
M_poll_17_r:
  s_lshr_b32 s34, s31, 1
  s_and_b32 s34, s34, 0x800
  s_add_u32 s34, s34, s47
  s_add_u32 s34, s34, 0xc0000
  buffer_store_dwordx4 a[216:219], v22, s[16:19], s34 offen offset:1024 sc1
  s_addk_i32 s34, 0x1000
  buffer_store_dwordx4 a[220:223], v22, s[16:19], s34 offen offset:1024 sc1
  s_and_b32 s34, s31, 0x1000
  s_add_u32 s34, s34, s47
  s_add_u32 s34, s34, 0xc2000
  buffer_store_dwordx4 a[248:251], v22, s[16:19], s34 offen offset:2048 sc1
  buffer_store_dwordx4 a[252:255], v22, s[16:19], s34 offen offset:3072 sc1
  s_setpc_b64 s[82:83]
M_hook5:
  v_and_b32 v23, 7, v1
  v_lshlrev_b32 v23, 10, v23
  s_andn2_b32 s32, s2, 0x38
  s_lshl_b32 s32, s32, 7
  buffer_load_dword v5, v23, s[20:23], s32 offen sc1
  s_lshr_b32 s34, s31, 1
  s_and_b32 s34, s34, 0x800
  s_add_u32 s34, s34, s47
  s_add_u32 s34, s34, 0xc0000
  buffer_store_dwordx4 a[208:211], v22, s[16:19], s34 offen offset:0 sc1
  s_addk_i32 s34, 0x1000
  buffer_store_dwordx4 a[212:215], v22, s[16:19], s34 offen offset:0 sc1
  s_and_b32 s34, s31, 0x1000
  s_add_u32 s34, s34, s47
  s_add_u32 s34, s34, 0xc2000
  buffer_store_dwordx4 a[240:243], v22, s[16:19], s34 offen offset:0 sc1
  buffer_store_dwordx4 a[244:247], v22, s[16:19], s34 offen offset:1024 sc1
  s_setpc_b64 s[82:83]
M_hook3:
  s_cmp_lg_u32 s30, 0
  s_cbranch_scc1 M_pub_16
  s_lshl_b32 s32, s2, 7
  v_mov_b32 v23, 3
  v_lshlrev_b32 v24, 2, v1
  s_mov_b32 exec_hi, 0
  buffer_store_dword v23, v24, s[20:23], s32 offen sc1
  s_mov_b64 exec, -1
M_pub_16:
  s_lshr_b32 s34, s31, 1
  s_and_b32 s34, s34, 0x800
  s_add_u32 s34, s34, s47
  s_add_u32 s34, s34, 0x80000
  buffer_store_dwordx4 a[200:203], v22, s[16:19], s34 offen offset:1024 sc1
  s_addk_i32 s34, 0x1000
  buffer_store_dwordx4 a[204:207], v22, s[16:19], s34 offen offset:1024 sc1
  s_and_b32 s34, s31, 0x1000
  s_add_u32 s34, s34, s47
  s_add_u32 s34, s34, 0x82000
  buffer_store_dwordx4 a[232:235], v22, s[16:19], s34 offen offset:2048 sc1
  buffer_store_dwordx4 a[236:239], v22, s[16:19], s34 offen offset:3072 sc1
  s_setpc_b64 s[82:83]
M_l2x:
  ds_read_b128 a[160:163], v7 offset:8192
  ds_read_b128 a[164:167], v7 offset:9216
  ds_read_b128 a[168:171], v7 offset:10240
  ds_read_b128 a[172:175], v7 offset:11264
  ds_read_b128 a[176:179], v7 offset:12288
  ds_read_b128 a[180:183], v7 offset:13312
  ds_read_b128 a[184:187], v7 offset:14336
  ds_read_b128 a[188:191], v7 offset:15360
  v_exp_f32 v224, v76
  v_exp_f32 v225, v77
  v_exp_f32 v226, v84
  v_cvt_pk_bf16_f32 v150, v224, v225
  v_exp_f32 v227, v85
  v_exp_f32 v228, v92
  v_cvt_pk_bf16_f32 v154, v226, v227
  v_exp_f32 v229, v93
  v_exp_f32 v230, v70
  v_cvt_pk_bf16_f32 v158, v228, v229
  v_exp_f32 v231, v71
  v_exp_f32 v224, v78
  v_cvt_pk_bf16_f32 v147, v230, v231
  v_exp_f32 v225, v79
  v_exp_f32 v226, v86
  v_cvt_pk_bf16_f32 v151, v224, v225
  v_exp_f32 v227, v87
  v_exp_f32 v228, v94
  v_cvt_pk_bf16_f32 v155, v226, v227
  v_exp_f32 v229, v95
  s_nop 0
  v_cvt_pk_bf16_f32 v159, v228, v229
  v_mfma_f32_16x16x32_bf16 v[128:131], v[12:15], v[144:147], 0
  v_mfma_f32_16x16x32_bf16 v[132:135], v[12:15], v[148:151], 0
  v_mfma_f32_16x16x32_bf16 v[136:139], v[12:15], v[152:155], 0
  v_mfma_f32_16x16x32_bf16 v[140:143], v[12:15], v[156:159], 0
  s_nop 6
  v_max3_f32 v232, v128, v132, v136
  v_max_f32 v232, v232, v140
  v_cmp_lt_f32 vcc, s44, v232
  s_nop 0
  s_cbranch_vccnz M_sl_20
M_sl_20_r:
  v_add_f32 v8, v8, v128
  v_add_f32 v9, v9, v132
  v_add_f32 v10, v10, v136
  v_add_f32 v11, v11, v140
  s_waitcnt vmcnt(0) lgkmcnt(0)
  s_barrier
  s_cmp_lg_u32 s30, 0
  s_cbranch_scc1 M_pub_21
  s_lshl_b32 s32, s2, 7
  v_mov_b32 v23, 5
  v_lshlrev_b32 v24, 2, v1
  s_mov_b32 exec_hi, 0
  buffer_store_dword v23, v24, s[20:23], s32 offen sc1
  s_mov_b64 exec, -1
M_pub_21:
  s_mul_i32 s32, s30, 36864
  v_add_u32 v6, s32, v22
  v_lshlrev_b32 v7, 4, v0
  v_add_u32 v7, 0x1f000, v7
  v_mov_b32 v12, v18
  v_mov_b32 v13, v19
  v_mfma_f32_16x16x32_bf16 a[64:67], a[160:163], v[152:155], a[64:67]
  ds_write_b128 v7, v[10:13]
  v_accvgpr_read_b32 v96, a192
  s_lshr_b32 s37, s35, 1
  v_mfma_f32_16x16x32_bf16 a[96:99], a[160:163], v[156:159], a[96:99]
  v_accvgpr_read_b32 v97, a193
  v_accvgpr_read_b32 v98, a194
  s_lshr_b32 s39, s36, 3
  v_mfma_f32_16x16x32_bf16 a[68:71], a[164:167], v[152:155], a[68:71]
  v_accvgpr_read_b32 v99, a195
  s_sub_u32 s32, 15, s29
  s_bitcmp1_b32 s35, 0
  v_mfma_f32_16x16x32_bf16 a[100:103], a[164:167], v[156:159], a[100:103]
  v_accvgpr_read_b32 v100, a196
  v_accvgpr_read_b32 v101, a197
  s_cselect_b32 s38, s32, s29
  v_mfma_f32_16x16x32_bf16 a[72:75], a[168:171], v[152:155], a[72:75]
  v_accvgpr_read_b32 v102, a198
  v_accvgpr_read_b32 v103, a199
  s_cselect_b32 s33, 6, 5
  v_mfma_f32_16x16x32_bf16 a[104:107], a[168:171], v[156:159], a[104:107]
  v_accvgpr_read_b32 v104, a200
  v_mov_b32 v21, s33
  s_and_b32 s32, s2, 0x3e
  v_mfma_f32_16x16x32_bf16 a[76:79], a[172:175], v[152:155], a[76:79]
  v_accvgpr_read_b32 v105, a201
  v_accvgpr_read_b32 v106, a202
  v_bfe_u32 v24, v1, 1, 2
  v_mfma_f32_16x16x32_bf16 a[108:111], a[172:175], v[156:159], a[108:111]
  v_accvgpr_read_b32 v107, a203
  v_accvgpr_read_b32 v108, a204
  v_lshl_add_u32 v24, v24, 6, s32
  v_mfma_f32_16x16x32_bf16 a[80:83], a[176:179], v[152:155], a[80:83]
  v_accvgpr_read_b32 v109, a205
  v_and_b32 v25, 1, v1
  v_add_lshl_u32 v20, v24, v25, 7
  v_mfma_f32_16x16x32_bf16 a[112:115], a[176:179], v[156:159], a[112:115]
  v_accvgpr_read_b32 v110, a206
  v_accvgpr_read_b32 v111, a207
  v_accvgpr_read_b32 v112, a208
  s_lshl_b32 s32, s38, 20
  v_mfma_f32_16x16x32_bf16 a[84:87], a[180:183], v[152:155], a[84:87]
  v_accvgpr_read_b32 v113, a209
  v_accvgpr_read_b32 v114, a210
  v_accvgpr_read_b32 v115, a211
  s_lshl_b32 s33, s37, 18
  v_mfma_f32_16x16x32_bf16 a[116:119], a[180:183], v[156:159], a[116:119]
  v_accvgpr_read_b32 v116, a212
  v_accvgpr_read_b32 v117, a213
  s_add_u32 s32, s32, s33
  s_add_u32 s24, s80, s32
  v_mfma_f32_16x16x32_bf16 a[88:91], a[184:187], v[152:155], a[88:91]
  v_accvgpr_read_b32 v118, a214
  v_accvgpr_read_b32 v119, a215
  v_accvgpr_read_b32 v120, a216
  s_addc_u32 s25, s81, 0
  v_mfma_f32_16x16x32_bf16 a[120:123], a[184:187], v[156:159], a[120:123]
  v_accvgpr_read_b32 v121, a217
  v_accvgpr_read_b32 v122, a218
  v_accvgpr_read_b32 v123, a219
  s_add_u32 s24, s24, 0x2000000
  v_mfma_f32_16x16x32_bf16 a[92:95], a[188:191], v[152:155], a[92:95]
  v_accvgpr_read_b32 v124, a220
  v_accvgpr_read_b32 v125, a221
  s_addc_u32 s25, s25, 0
  s_mov_b32 s26, 0x40000
  v_mfma_f32_16x16x32_bf16 a[124:127], a[188:191], v[156:159], a[124:127]
  v_accvgpr_read_b32 v126, a222
  v_accvgpr_read_b32 v127, a223
  v_accvgpr_read_b32 v128, a224
  s_mov_b32 s27, 0x20000
  v_mfma_f32_16x16x32_bf16 a[0:3], a[160:163], v[144:147], a[0:3]
  ds_write_b128 v6, a[64:67] offset:0
  v_accvgpr_read_b32 v129, a225
  v_accvgpr_read_b32 v130, a226
  s_lshl_b32 s32, s39, 2
  v_mfma_f32_16x16x32_bf16 a[32:35], a[160:163], v[148:151], a[32:35]
  ds_write_b128 v6, a[96:99] offset:1024
  v_accvgpr_read_b32 v131, a227
  s_add_u32 s32, s32, s37
  s_mul_i32 s32, s32, 327680
  v_mfma_f32_16x16x32_bf16 a[4:7], a[164:167], v[144:147], a[4:7]
  ds_write_b128 v6, a[68:71] offset:2048
  v_accvgpr_read_b32 v132, a228
  v_accvgpr_read_b32 v133, a229
  s_add_u32 s12, s80, s32
  v_mfma_f32_16x16x32_bf16 a[36:39], a[164:167], v[148:151], a[36:39]
  ds_write_b128 v6, a[100:103] offset:3072
  v_accvgpr_read_b32 v134, a230
  v_accvgpr_read_b32 v135, a231
  s_addc_u32 s13, s81, 0
  v_mfma_f32_16x16x32_bf16 a[8:11], a[168:171], v[144:147], a[8:11]
  ds_write_b128 v6, a[72:75] offset:4096
  v_add_f32 v96, v96, v116
  s_add_u32 s12, s12, 0x3800000
  s_addc_u32 s13, s13, 0
  v_mfma_f32_16x16x32_bf16 a[40:43], a[168:171], v[148:151], a[40:43]
  ds_write_b128 v6, a[104:107] offset:5120
  v_add_f32 v97, v97, v117
  v_add_f32 v98, v98, v118
  s_mov_b32 s14, 0x50000
  v_mfma_f32_16x16x32_bf16 a[12:15], a[172:175], v[144:147], a[12:15]
  ds_write_b128 v6, a[76:79] offset:6144
  v_add_f32 v99, v99, v119
  v_add_f32 v100, v100, v120
  s_mov_b32 s15, 0x20000
  v_mfma_f32_16x16x32_bf16 a[44:47], a[172:175], v[148:151], a[44:47]
  ds_write_b128 v6, a[108:111] offset:7168
  v_add_f32 v101, v101, v121
  s_mul_i32 s45, s30, 5120
  v_add_u32 v3, s45, v22
  v_mfma_f32_16x16x32_bf16 a[16:19], a[176:179], v[144:147], a[16:19]
  ds_write_b128 v6, a[80:83] offset:8192
  v_add_f32 v102, v102, v122
  v_add_f32 v103, v103, v123
  s_add_u32 s45, s45, 0x4000
  v_mfma_f32_16x16x32_bf16 a[48:51], a[176:179], v[148:151], a[48:51]
  ds_write_b128 v6, a[112:115] offset:9216
  v_add_f32 v104, v104, v124
  v_add_f32 v105, v105, v125
  s_movk_i32 s47, 0x4000
  v_mfma_f32_16x16x32_bf16 a[20:23], a[180:183], v[144:147], a[20:23]
  ds_write_b128 v6, a[84:87] offset:10240
  v_add_f32 v106, v106, v126
  s_movk_i32 s92, 0x5000
  s_and_b32 s86, s28, 7
  v_mfma_f32_16x16x32_bf16 a[52:55], a[180:183], v[148:151], a[52:55]
  ds_write_b128 v6, a[116:119] offset:11264
  v_add_f32 v107, v107, v127
  v_add_f32 v108, v108, v128
  s_lshl_b32 s86, s86, 1
  v_mfma_f32_16x16x32_bf16 a[24:27], a[184:187], v[144:147], a[24:27]
  ds_write_b128 v6, a[88:91] offset:12288
  v_add_f32 v109, v109, v129
  v_add_f32 v110, v110, v130
  s_mov_b32 s43, 0
  v_mfma_f32_16x16x32_bf16 a[56:59], a[184:187], v[148:151], a[56:59]
  ds_write_b128 v6, a[120:123] offset:13312
  v_add_f32 v111, v111, v131
  s_mov_b32 s87, 0
  v_add_u32 v5, 0x20000, v3
  v_mfma_f32_16x16x32_bf16 a[28:31], a[188:191], v[144:147], a[28:31]
  ds_write_b128 v6, a[92:95] offset:14336
  v_add_f32 v112, v112, v132
  v_add_f32 v113, v113, v133
  v_mfma_f32_16x16x32_bf16 a[60:63], a[188:191], v[148:151], a[60:63]
  ds_write_b128 v6, a[124:127] offset:15360
  v_add_f32 v114, v114, v134
  v_add_f32 v115, v115, v135
  ds_write_b128 v5, v[96:99] offset:0
  ds_write_b128 v5, v[100:103] offset:1024
  ds_write_b128 v5, v[104:107] offset:2048
  ds_write_b128 v5, v[108:111] offset:3072
  ds_write_b128 v5, v[112:115] offset:4096
  v_add_u32 v2, s31, v22
  v_and_b32 v25, 31, v1
  v_min_u32 v25, 20, v25
  v_and_b32 v24, 32, v1
  v_add_lshl_u32 v28, v24, v25, 4
  v_add_u32 v28, 0x20000, v28
  s_xor_b32 s32, s30, 1
  s_mul_i32 s32, s32, 36864
  v_add_u32 v23, s32, v22
  v_xor_b32 v7, 0x400, v7
  s_sub_u32 s34, 15, s29
  s_lshl_b32 s32, s34, 20
  s_lshl_b32 s33, s28, 15
  s_add_u32 s32, s32, s33
  s_add_u32 s46, s32, s94
  s_waitcnt lgkmcnt(0)
  s_barrier
  ds_read_b128 v[224:227], v7
  ds_read_b128 v[144:147], v23 offset:0
  ds_read_b128 v[152:155], v23 offset:1024
  ds_read_b128 v[148:151], v23 offset:2048
  ds_read_b128 v[156:159], v23 offset:3072
  ds_read_b128 v[160:163], v23 offset:4096
  ds_read_b128 v[168:171], v23 offset:5120
  ds_read_b128 v[164:167], v23 offset:6144
  ds_read_b128 v[172:175], v23 offset:7168
  ds_read_b128 v[176:179], v23 offset:8192
  ds_read_b128 v[184:187], v23 offset:9216
  ds_read_b128 v[180:183], v23 offset:10240
  ds_read_b128 v[188:191], v23 offset:11264
  ds_read_b128 v[192:195], v23 offset:12288
  ds_read_b128 v[200:203], v23 offset:13312
  ds_read_b128 v[196:199], v23 offset:14336
  ds_read_b128 v[204:207], v23 offset:15360
  s_mul_i32 s40, s86, s47
  s_mul_i32 s41, s86, s92
  s_add_u32 s41, s41, s87
  s_add_u32 s42, s41, 0x1000
  s_add_u32 m0, s43, s45
  s_waitcnt lgkmcnt(15)
  v_min_f32 v24, v16, v226
  v_sub_f32 v232, v24, v16
  v_sub_f32 v233, v24, v226
  v_exp_f32 v232, v232
  v_exp_f32 v233, v233
  v_mul_f32 v8, v8, v232
  buffer_load_dwordx4 v3, s[12:15], s41 offen offset:0 sc1 lds
  v_fmac_f32 v8, v224, v233
  v_rcp_f32 v24, v8
  s_nop 0
  v_mul_f32 v232, v232, v24
  v_mul_f32 v233, v233, v24
  v_min_f32 v24, v17, v227
  v_sub_f32 v234, v24, v17
  buffer_load_dwordx4 v3, s[12:15], s41 offen offset:1024 sc1 lds
  v_sub_f32 v235, v24, v227
  v_exp_f32 v234, v234
  v_exp_f32 v235, v235
  v_mul_f32 v9, v9, v234
  v_fmac_f32 v9, v225, v235
  v_rcp_f32 v24, v9
  buffer_load_dwordx4 v3, s[12:15], s41 offen offset:2048 sc1 lds
  v_mul_f32 v234, v234, v24
  v_mul_f32 v235, v235, v24
  v_accvgpr_read_b32 v48, a0
  v_accvgpr_read_b32 v49, a1
  v_accvgpr_read_b32 v50, a2
  v_accvgpr_read_b32 v51, a3
  buffer_load_dwordx4 v3, s[12:15], s41 offen offset:3072 sc1 lds
  v_accvgpr_read_b32 v52, a4
  v_accvgpr_read_b32 v53, a5
  v_accvgpr_read_b32 v54, a6
  v_accvgpr_read_b32 v55, a7
  v_accvgpr_read_b32 v56, a32
  v_accvgpr_read_b32 v57, a33
  s_add_u32 m0, m0, 0x1000
  v_accvgpr_read_b32 v58, a34
  v_accvgpr_read_b32 v59, a35
  v_accvgpr_read_b32 v60, a36
  v_accvgpr_read_b32 v61, a37
  v_accvgpr_read_b32 v62, a38
  v_accvgpr_read_b32 v63, a39
  buffer_load_dwordx4 v3, s[12:15], s42 offen offset:0 sc1 lds
  v_pk_mul_f32 v[48:49], v[48:49], v[232:233] op_sel:[0,0] op_sel_hi:[1,0]
  v_pk_mul_f32 v[50:51], v[50:51], v[232:233] op_sel:[0,0] op_sel_hi:[1,0]
  v_pk_mul_f32 v[52:53], v[52:53], v[232:233] op_sel:[0,0] op_sel_hi:[1,0]
  v_pk_mul_f32 v[54:55], v[54:55], v[232:233] op_sel:[0,0] op_sel_hi:[1,0]
  v_pk_fma_f32 v[48:49], v[144:145], v[232:233], v[48:49] op_sel:[0,1,0] op_sel_hi:[1,1,1]
  v_pk_fma_f32 v[50:51], v[146:147], v[232:233], v[50:51] op_sel:[0,1,0] op_sel_hi:[1,1,1]
  s_add_u32 s86, s86, 1
  s_and_b32 s86, s86, 15
  s_add_u32 s43, s43, 36864
  s_cmp_eq_u32 s43, 147456
  s_cselect_b32 s43, 0, s43
  s_mul_i32 s40, s86, s47
  s_mul_i32 s41, s86, s92
  s_add_u32 s41, s41, s87
  s_add_u32 s42, s41, 0x1000
  s_add_u32 m0, s43, s45
  s_waitcnt lgkmcnt(13)
  v_pk_fma_f32 v[52:53], v[148:149], v[232:233], v[52:53] op_sel:[0,1,0] op_sel_hi:[1,1,1]
  v_pk_fma_f32 v[54:55], v[150:151], v[232:233], v[54:55] op_sel:[0,1,0] op_sel_hi:[1,1,1]
  v_pk_mul_f32 v[56:57], v[56:57], v[234:235] op_sel:[0,0] op_sel_hi:[1,0]
  v_pk_mul_f32 v[58:59], v[58:59], v[234:235] op_sel:[0,0] op_sel_hi:[1,0]
  v_pk_mul_f32 v[60:61], v[60:61], v[234:235] op_sel:[0,0] op_sel_hi:[1,0]
  v_pk_mul_f32 v[62:63], v[62:63], v[234:235] op_sel:[0,0] op_sel_hi:[1,0]
  buffer_load_dwordx4 v3, s[12:15], s41 offen offset:0 sc1 lds
  v_pk_fma_f32 v[56:57], v[152:153], v[234:235], v[56:57] op_sel:[0,1,0] op_sel_hi:[1,1,1]
  v_pk_fma_f32 v[58:59], v[154:155], v[234:235], v[58:59] op_sel:[0,1,0] op_sel_hi:[1,1,1]
  s_waitcnt lgkmcnt(12)
  v_pk_fma_f32 v[60:61], v[156:157], v[234:235], v[60:61] op_sel:[0,1,0] op_sel_hi:[1,1,1]
  v_pk_fma_f32 v[62:63], v[158:159], v[234:235], v[62:63] op_sel:[0,1,0] op_sel_hi:[1,1,1]
  v_cvt_pk_bf16_f32 v32, v48, v49
  v_cvt_pk_bf16_f32 v33, v50, v51
  buffer_load_dwordx4 v3, s[12:15], s41 offen offset:1024 sc1 lds
  v_cvt_pk_bf16_f32 v34, v52, v53
  v_cvt_pk_bf16_f32 v35, v54, v55
  v_cvt_pk_bf16_f32 v36, v56, v57
  v_cvt_pk_bf16_f32 v37, v58, v59
  v_cvt_pk_bf16_f32 v38, v60, v61
  v_cvt_pk_bf16_f32 v39, v62, v63
  buffer_load_dwordx4 v3, s[12:15], s41 offen offset:2048 sc1 lds
  buffer_store_dwordx4 v[32:35], v22, s[8:11], s46 offen offset:0 sc1
  buffer_store_dwordx4 v[36:39], v22, s[8:11], s46 offen offset:1024 sc1
  s_addk_i32 s46, 0x2000
  v_accvgpr_read_b32 v64, a8
  v_accvgpr_read_b32 v65, a9
  v_accvgpr_read_b32 v66, a10
  buffer_load_dwordx4 v3, s[12:15], s41 offen offset:3072 sc1 lds
  v_accvgpr_read_b32 v67, a11
  v_accvgpr_read_b32 v68, a12
  v_accvgpr_read_b32 v69, a13
  v_accvgpr_read_b32 v70, a14
  v_accvgpr_read_b32 v71, a15
  v_accvgpr_read_b32 v72, a40
  s_add_u32 m0, m0, 0x1000
  v_accvgpr_read_b32 v73, a41
  v_accvgpr_read_b32 v74, a42
  v_accvgpr_read_b32 v75, a43
  v_accvgpr_read_b32 v76, a44
  v_accvgpr_read_b32 v77, a45
  v_accvgpr_read_b32 v78, a46
  buffer_load_dwordx4 v3, s[12:15], s42 offen offset:0 sc1 lds
  v_accvgpr_read_b32 v79, a47
  v_pk_mul_f32 v[64:65], v[64:65], v[232:233] op_sel:[0,0] op_sel_hi:[1,0]
  v_pk_mul_f32 v[66:67], v[66:67], v[232:233] op_sel:[0,0] op_sel_hi:[1,0]
  v_pk_mul_f32 v[68:69], v[68:69], v[232:233] op_sel:[0,0] op_sel_hi:[1,0]
  v_pk_mul_f32 v[70:71], v[70:71], v[232:233] op_sel:[0,0] op_sel_hi:[1,0]
  s_waitcnt lgkmcnt(11)
  v_pk_fma_f32 v[64:65], v[160:161], v[232:233], v[64:65] op_sel:[0,1,0] op_sel_hi:[1,1,1]
  s_add_u32 s86, s86, 1
  s_and_b32 s86, s86, 15
  s_add_u32 s43, s43, 36864
  s_cmp_eq_u32 s43, 147456
  s_cselect_b32 s43, 0, s43
  s_mul_i32 s40, s86, s47
  s_mul_i32 s41, s86, s92
  s_add_u32 s41, s41, s87
  s_add_u32 s42, s41, 0x1000
  s_add_u32 m0, s43, s45
  v_pk_fma_f32 v[66:67], v[162:163], v[232:233], v[66:67] op_sel:[0,1,0] op_sel_hi:[1,1,1]
  s_waitcnt lgkmcnt(9)
  v_pk_fma_f32 v[68:69], v[164:165], v[232:233], v[68:69] op_sel:[0,1,0] op_sel_hi:[1,1,1]
  v_pk_fma_f32 v[70:71], v[166:167], v[232:233], v[70:71] op_sel:[0,1,0] op_sel_hi:[1,1,1]
  v_pk_mul_f32 v[72:73], v[72:73], v[234:235] op_sel:[0,0] op_sel_hi:[1,0]
  v_pk_mul_f32 v[74:75], v[74:75], v[234:235] op_sel:[0,0] op_sel_hi:[1,0]
  v_pk_mul_f32 v[76:77], v[76:77], v[234:235] op_sel:[0,0] op_sel_hi:[1,0]
  buffer_load_dwordx4 v3, s[12:15], s41 offen offset:0 sc1 lds
  v_pk_mul_f32 v[78:79], v[78:79], v[234:235] op_sel:[0,0] op_sel_hi:[1,0]
  v_pk_fma_f32 v[72:73], v[168:169], v[234:235], v[72:73] op_sel:[0,1,0] op_sel_hi:[1,1,1]
  v_pk_fma_f32 v[74:75], v[170:171], v[234:235], v[74:75] op_sel:[0,1,0] op_sel_hi:[1,1,1]
  s_waitcnt lgkmcnt(8)
  v_pk_fma_f32 v[76:77], v[172:173], v[234:235], v[76:77] op_sel:[0,1,0] op_sel_hi:[1,1,1]
  v_pk_fma_f32 v[78:79], v[174:175], v[234:235], v[78:79] op_sel:[0,1,0] op_sel_hi:[1,1,1]
  v_cvt_pk_bf16_f32 v40, v64, v65
  buffer_load_dwordx4 v3, s[12:15], s41 offen offset:1024 sc1 lds
  v_cvt_pk_bf16_f32 v41, v66, v67
  v_cvt_pk_bf16_f32 v42, v68, v69
  v_cvt_pk_bf16_f32 v43, v70, v71
  v_cvt_pk_bf16_f32 v44, v72, v73
  v_cvt_pk_bf16_f32 v45, v74, v75
  v_cvt_pk_bf16_f32 v46, v76, v77
  buffer_load_dwordx4 v3, s[12:15], s41 offen offset:2048 sc1 lds
  v_cvt_pk_bf16_f32 v47, v78, v79
  buffer_store_dwordx4 v[40:43], v22, s[8:11], s46 offen offset:0 sc1
  buffer_store_dwordx4 v[44:47], v22, s[8:11], s46 offen offset:1024 sc1
  s_addk_i32 s46, 0x2000
  v_accvgpr_read_b32 v48, a16
  v_accvgpr_read_b32 v49, a17
  buffer_load_dwordx4 v3, s[12:15], s41 offen offset:3072 sc1 lds
  v_accvgpr_read_b32 v50, a18
  v_accvgpr_read_b32 v51, a19
  v_accvgpr_read_b32 v52, a20
  v_accvgpr_read_b32 v53, a21
  v_accvgpr_read_b32 v54, a22
  v_accvgpr_read_b32 v55, a23
  s_add_u32 m0, m0, 0x1000
  v_accvgpr_read_b32 v56, a48
  v_accvgpr_read_b32 v57, a49
  v_accvgpr_read_b32 v58, a50
  v_accvgpr_read_b32 v59, a51
  v_accvgpr_read_b32 v60, a52
  v_accvgpr_read_b32 v61, a53
  buffer_load_dwordx4 v3, s[12:15], s42 offen offset:0 sc1 lds
  v_accvgpr_read_b32 v62, a54
  v_accvgpr_read_b32 v63, a55
  v_pk_mul_f32 v[48:49], v[48:49], v[232:233] op_sel:[0,0] op_sel_hi:[1,0]
  v_pk_mul_f32 v[50:51], v[50:51], v[232:233] op_sel:[0,0] op_sel_hi:[1,0]
  v_pk_mul_f32 v[52:53], v[52:53], v[232:233] op_sel:[0,0] op_sel_hi:[1,0]
  v_pk_mul_f32 v[54:55], v[54:55], v[232:233] op_sel:[0,0] op_sel_hi:[1,0]
  s_waitcnt lgkmcnt(7)
  v_pk_fma_f32 v[48:49], v[176:177], v[232:233], v[48:49] op_sel:[0,1,0] op_sel_hi:[1,1,1]
  v_pk_fma_f32 v[50:51], v[178:179], v[232:233], v[50:51] op_sel:[0,1,0] op_sel_hi:[1,1,1]
  s_waitcnt lgkmcnt(5)
  v_pk_fma_f32 v[52:53], v[180:181], v[232:233], v[52:53] op_sel:[0,1,0] op_sel_hi:[1,1,1]
  v_pk_fma_f32 v[54:55], v[182:183], v[232:233], v[54:55] op_sel:[0,1,0] op_sel_hi:[1,1,1]
  v_pk_mul_f32 v[56:57], v[56:57], v[234:235] op_sel:[0,0] op_sel_hi:[1,0]
  v_pk_mul_f32 v[58:59], v[58:59], v[234:235] op_sel:[0,0] op_sel_hi:[1,0]
  v_pk_mul_f32 v[60:61], v[60:61], v[234:235] op_sel:[0,0] op_sel_hi:[1,0]
  v_pk_mul_f32 v[62:63], v[62:63], v[234:235] op_sel:[0,0] op_sel_hi:[1,0]
  v_pk_fma_f32 v[56:57], v[184:185], v[234:235], v[56:57] op_sel:[0,1,0] op_sel_hi:[1,1,1]
  v_pk_fma_f32 v[58:59], v[186:187], v[234:235], v[58:59] op_sel:[0,1,0] op_sel_hi:[1,1,1]
  s_waitcnt lgkmcnt(4)
  v_pk_fma_f32 v[60:61], v[188:189], v[234:235], v[60:61] op_sel:[0,1,0] op_sel_hi:[1,1,1]
  v_pk_fma_f32 v[62:63], v[190:191], v[234:235], v[62:63] op_sel:[0,1,0] op_sel_hi:[1,1,1]
  v_cvt_pk_bf16_f32 v212, v48, v49
  v_cvt_pk_bf16_f32 v213, v50, v51
  v_cvt_pk_bf16_f32 v214, v52, v53
  v_cvt_pk_bf16_f32 v215, v54, v55
  v_cvt_pk_bf16_f32 v216, v56, v57
  v_cvt_pk_bf16_f32 v217, v58, v59
  v_cvt_pk_bf16_f32 v218, v60, v61
  v_cvt_pk_bf16_f32 v219, v62, v63
  buffer_store_dwordx4 v[212:215], v22, s[8:11], s46 offen offset:0 sc1
  buffer_store_dwordx4 v[216:219], v22, s[8:11], s46 offen offset:1024 sc1
  s_addk_i32 s46, 0x2000
  v_accvgpr_read_b32 v64, a24
  v_accvgpr_read_b32 v65, a25
  v_accvgpr_read_b32 v66, a26
  v_accvgpr_read_b32 v67, a27
  v_accvgpr_read_b32 v68, a28
  v_accvgpr_read_b32 v69, a29
  v_accvgpr_read_b32 v70, a30
  v_accvgpr_read_b32 v71, a31
  v_accvgpr_read_b32 v72, a56
  v_accvgpr_read_b32 v73, a57
  v_accvgpr_read_b32 v74, a58
  v_accvgpr_read_b32 v75, a59
  v_accvgpr_read_b32 v76, a60
  v_accvgpr_read_b32 v77, a61
  v_accvgpr_read_b32 v78, a62
  v_accvgpr_read_b32 v79, a63
  v_pk_mul_f32 v[64:65], v[64:65], v[232:233] op_sel:[0,0] op_sel_hi:[1,0]
  v_pk_mul_f32 v[66:67], v[66:67], v[232:233] op_sel:[0,0] op_sel_hi:[1,0]
  v_pk_mul_f32 v[68:69], v[68:69], v[232:233] op_sel:[0,0] op_sel_hi:[1,0]
  v_pk_mul_f32 v[70:71], v[70:71], v[232:233] op_sel:[0,0] op_sel_hi:[1,0]
  s_waitcnt lgkmcnt(3)
  v_pk_fma_f32 v[64:65], v[192:193], v[232:233], v[64:65] op_sel:[0,1,0] op_sel_hi:[1,1,1]
  v_pk_fma_f32 v[66:67], v[194:195], v[232:233], v[66:67] op_sel:[0,1,0] op_sel_hi:[1,1,1]
  s_waitcnt lgkmcnt(1)
  v_pk_fma_f32 v[68:69], v[196:197], v[232:233], v[68:69] op_sel:[0,1,0] op_sel_hi:[1,1,1]
  v_pk_fma_f32 v[70:71], v[198:199], v[232:233], v[70:71] op_sel:[0,1,0] op_sel_hi:[1,1,1]
  v_pk_mul_f32 v[72:73], v[72:73], v[234:235] op_sel:[0,0] op_sel_hi:[1,0]
  v_pk_mul_f32 v[74:75], v[74:75], v[234:235] op_sel:[0,0] op_sel_hi:[1,0]
  v_pk_mul_f32 v[76:77], v[76:77], v[234:235] op_sel:[0,0] op_sel_hi:[1,0]
  v_pk_mul_f32 v[78:79], v[78:79], v[234:235] op_sel:[0,0] op_sel_hi:[1,0]
  v_pk_fma_f32 v[72:73], v[200:201], v[234:235], v[72:73] op_sel:[0,1,0] op_sel_hi:[1,1,1]
  v_pk_fma_f32 v[74:75], v[202:203], v[234:235], v[74:75] op_sel:[0,1,0] op_sel_hi:[1,1,1]
  s_waitcnt lgkmcnt(0)
  v_pk_fma_f32 v[76:77], v[204:205], v[234:235], v[76:77] op_sel:[0,1,0] op_sel_hi:[1,1,1]
  v_pk_fma_f32 v[78:79], v[206:207], v[234:235], v[78:79] op_sel:[0,1,0] op_sel_hi:[1,1,1]
  v_cvt_pk_bf16_f32 v220, v64, v65
  v_cvt_pk_bf16_f32 v221, v66, v67
  v_cvt_pk_bf16_f32 v222, v68, v69
  v_cvt_pk_bf16_f32 v223, v70, v71
  v_cvt_pk_bf16_f32 v224, v72, v73
  v_cvt_pk_bf16_f32 v225, v74, v75
  v_cvt_pk_bf16_f32 v226, v76, v77
  v_cvt_pk_bf16_f32 v227, v78, v79
  buffer_store_dwordx4 v[220:223], v22, s[8:11], s46 offen offset:0 sc1
  buffer_store_dwordx4 v[224:227], v22, s[8:11], s46 offen offset:1024 sc1
  ds_read_b128 v[96:99], v28 offset:0
  ds_read_b128 v[100:103], v28 offset:1024
  ds_read_b128 v[104:107], v28 offset:2048
  ds_read_b128 v[108:111], v28 offset:3072
  ds_read_b128 v[112:115], v28 offset:4096
  ds_read_b128 v[116:119], v28 offset:5120
  ds_read_b128 v[120:123], v28 offset:6144
  ds_read_b128 v[124:127], v28 offset:7168
  ds_read_b128 v[128:131], v28 offset:8192
  ds_read_b128 v[132:135], v28 offset:9216
  ds_read_b128 v[136:139], v28 offset:10240
  ds_read_b128 v[140:143], v28 offset:11264
  ds_read_b128 v[144:147], v28 offset:12288
  ds_read_b128 v[148:151], v28 offset:13312
  ds_read_b128 v[152:155], v28 offset:14336
  ds_read_b128 v[156:159], v28 offset:15360
  ds_read_b128 v[160:163], v28 offset:16384
  ds_read_b128 v[164:167], v28 offset:17408
  ds_read_b128 v[168:171], v28 offset:18432
  ds_read_b128 v[172:175], v28 offset:19456
  v_mfma_f32_32x32x16_bf16 v[48:63], v[240:243], a[232:235], 0
  v_mfma_f32_32x32x16_bf16 v[48:63], v[244:247], a[236:239], v[48:63]
  v_mfma_f32_32x32x16_bf16 v[64:79], v[248:251], a[232:235], 0
  v_mfma_f32_32x32x16_bf16 v[64:79], v[252:255], a[236:239], v[64:79]
  s_call_b64 s[48:49], M_phi
  s_waitcnt lgkmcnt(14)
  v_pk_add_f32 v[96:97], v[96:97], v[116:117]
  s_waitcnt lgkmcnt(4)
  v_pk_add_f32 v[136:137], v[136:137], v[156:157]
  v_pk_add_f32 v[98:99], v[98:99], v[118:119]
  v_pk_add_f32 v[138:139], v[138:139], v[158:159]
  v_pk_add_f32 v[100:101], v[100:101], v[120:121]
  s_waitcnt lgkmcnt(3)
  v_pk_add_f32 v[140:141], v[140:141], v[160:161]
  v_pk_add_f32 v[102:103], v[102:103], v[122:123]
  v_pk_add_f32 v[142:143], v[142:143], v[162:163]
  v_pk_add_f32 v[104:105], v[104:105], v[124:125]
  s_waitcnt lgkmcnt(2)
  v_pk_add_f32 v[144:145], v[144:145], v[164:165]
  v_pk_add_f32 v[106:107], v[106:107], v[126:127]
  v_pk_add_f32 v[146:147], v[146:147], v[166:167]
  v_pk_add_f32 v[108:109], v[108:109], v[128:129]
  s_waitcnt lgkmcnt(1)
  v_pk_add_f32 v[148:149], v[148:149], v[168:169]
  v_pk_add_f32 v[110:111], v[110:111], v[130:131]
  v_pk_add_f32 v[150:151], v[150:151], v[170:171]
  v_pk_add_f32 v[112:113], v[112:113], v[132:133]
  s_waitcnt lgkmcnt(0)
  v_pk_add_f32 v[152:153], v[152:153], v[172:173]
  v_pk_add_f32 v[114:115], v[114:115], v[134:135]
  v_pk_add_f32 v[154:155], v[154:155], v[174:175]
  v_pk_add_f32 v[176:177], v[96:97], v[136:137]
  v_pk_add_f32 v[178:179], v[98:99], v[138:139]
  v_pk_add_f32 v[180:181], v[100:101], v[140:141]
  v_pk_add_f32 v[182:183], v[102:103], v[142:143]
  v_pk_add_f32 v[184:185], v[104:105], v[144:145]
  v_pk_add_f32 v[186:187], v[106:107], v[146:147]
  v_pk_add_f32 v[188:189], v[108:109], v[148:149]
  v_pk_add_f32 v[190:191], v[110:111], v[150:151]
  v_pk_add_f32 v[192:193], v[112:113], v[152:153]
  v_pk_add_f32 v[194:195], v[114:115], v[154:155]
  v_cvt_pk_bf16_f32 v200, v176, v177
  v_cvt_pk_bf16_f32 v201, v178, v179
  v_cvt_pk_bf16_f32 v202, v180, v181
  v_cvt_pk_bf16_f32 v203, v182, v183
  v_cvt_pk_bf16_f32 v204, v184, v185
  v_cvt_pk_bf16_f32 v205, v186, v187
  v_cvt_pk_bf16_f32 v206, v188, v189
  v_cvt_pk_bf16_f32 v207, v190, v191
  v_cvt_pk_bf16_f32 v208, v192, v193
  v_cvt_pk_bf16_f32 v209, v194, v195
  v_mov_b32 v210, 0
  v_mov_b32 v211, 0
  v_mov_b32 v90, 0
  v_mov_b32 v91, 0
  v_mfma_f32_32x32x16_bf16 v[96:111], v[200:203], v[80:83], 0
  v_mfma_f32_32x32x16_bf16 v[96:111], v[204:207], v[84:87], v[96:111]
  v_mfma_f32_32x32x16_bf16 v[96:111], v[208:211], v[88:91], v[96:111]
  s_waitcnt vmcnt(0) lgkmcnt(0)
  s_barrier
  s_cmp_lg_u32 s30, 0
  s_cbranch_scc1 M_pub_22
  s_lshl_b32 s32, s2, 7
  v_mov_b32 v23, 6
  v_lshlrev_b32 v24, 2, v1
  s_mov_b32 exec_hi, 0
  buffer_store_dword v23, v24, s[20:23], s32 offen sc1
  s_mov_b64 exec, -1
M_pub_22:
  s_bitcmp1_b32 s35, 0
  s_cbranch_scc0 M_own0
  v_add_u32 v25, s94, v22
  ds_write_b128 v25, v[32:35] offset:0
  ds_write_b128 v25, v[36:39] offset:1024
  ds_write_b128 v25, v[40:43] offset:8192
  ds_write_b128 v25, v[44:47] offset:9216
  ds_write_b128 v25, v[212:215] offset:36864
  ds_write_b128 v25, v[216:219] offset:37888
  ds_write_b128 v25, v[220:223] offset:45056
  ds_write_b128 v25, v[224:227] offset:46080
  s_branch M_own1
M_own0:
  s_and_b32 s40, s28, 7
  s_lshl_b32 s40, s40, 15
  s_mov_b32 m0, s31
  s_nop 0
  buffer_load_dwordx4 v2, s[24:27], s40 offen offset:0 sc1 lds
  buffer_load_dwordx4 v2, s[24:27], s40 offen offset:1024 sc1 lds
  buffer_load_dwordx4 v2, s[24:27], s40 offen offset:2048 sc1 lds
  buffer_load_dwordx4 v2, s[24:27], s40 offen offset:3072 sc1 lds
  s_add_u32 m0, m0, 36864
  s_addk_i32 s40, 0x4000
  buffer_load_dwordx4 v2, s[24:27], s40 offen offset:0 sc1 lds
  buffer_load_dwordx4 v2, s[24:27], s40 offen offset:1024 sc1 lds
  buffer_load_dwordx4 v2, s[24:27], s40 offen offset:2048 sc1 lds
  buffer_load_dwordx4 v2, s[24:27], s40 offen offset:3072 sc1 lds
  s_mul_i32 s40, s86, s47
M_own1:
  v_mfma_f32_32x32x16_bf16 v[48:63], v[240:243], a[240:243], 0
  v_mfma_f32_32x32x16_bf16 v[48:63], v[244:247], a[244:247], v[48:63]
  v_mfma_f32_32x32x16_bf16 v[64:79], v[248:251], a[240:243], 0
  v_mfma_f32_32x32x16_bf16 v[64:79], v[252:255], a[244:247], v[64:79]
  s_call_b64 s[48:49], M_phi
  buffer_load_dword v26, v20, s[20:23], 0 offen sc1
  v_mfma_f32_32x32x16_bf16 v[128:143], v[200:203], v[80:83], 0
  v_mfma_f32_32x32x16_bf16 v[128:143], v[204:207], v[84:87], v[128:143]
  v_mfma_f32_32x32x16_bf16 v[128:143], v[208:211], v[88:91], v[128:143]
  s_lshr_b32 s32, s50, 1
  s_mul_i32 s32, s32, 81920
  s_add_u32 s4, s80, s32
  s_addc_u32 s5, s81, 0
  s_add_u32 s4, s4, 0x4000000
  s_addc_u32 s5, s5, 0
  s_mov_b32 s6, 0x14000
  s_mov_b32 s7, 0x20000
  v_and_b32 v23, 15, v1
  v_bfe_u32 v25, v1, 4, 1
  v_lshlrev_b32 v25, 10, v25
  v_lshrrev_b32 v24, 5, v1
  v_lshl_add_u32 v28, v23, 4, v25
  v_lshl_add_u32 v28, v24, 8, v28
  v_lshl_add_u32 v29, v23, 3, v25
  v_lshl_add_u32 v29, v24, 31, v29
  s_lshr_b32 s32, s36, 3
  s_mul_i32 s32, s32, 20480
  s_bfe_u32 s33, s36, 0x20001
  s_and_b32 s52, s36, 1
  s_lshl_b32 s34, s29, 7
  s_add_u32 s34, s34, s32
  s_addk_i32 s34, 0x4000
  s_lshl_b32 s33, s33, 12
  s_lshl_b32 s52, s52, 9
  s_add_u32 s32, s32, s33
  s_add_u32 s32, s32, s52
  v_add_f32 v108, 0x358637bd, v108
  v_rcp_f32 v108, v108
  s_nop 0
  v_pk_mul_f32 v[96:97], v[96:97], v[108:109] op_sel:[0,0] op_sel_hi:[1,0]
  v_pk_mul_f32 v[98:99], v[98:99], v[108:109] op_sel:[0,0] op_sel_hi:[1,0]
  v_pk_mul_f32 v[100:101], v[100:101], v[108:109] op_sel:[0,0] op_sel_hi:[1,0]
  v_pk_mul_f32 v[102:103], v[102:103], v[108:109] op_sel:[0,0] op_sel_hi:[1,0]
  v_pk_mul_f32 v[104:105], v[104:105], v[108:109] op_sel:[0,0] op_sel_hi:[1,0]
  v_pk_mul_f32 v[106:107], v[106:107], v[108:109] op_sel:[0,0] op_sel_hi:[1,0]
  v_cvt_pk_bf16_f32 v112, v96, v97
  v_cvt_pk_bf16_f32 v113, v98, v99
  v_cvt_pk_bf16_f32 v114, v100, v101
  v_cvt_pk_bf16_f32 v115, v102, v103
  v_cvt_pk_bf16_f32 v116, v104, v105
  v_cvt_pk_bf16_f32 v117, v106, v107
  buffer_store_dwordx4 v[112:115], v28, s[4:7], s32 offen offset:0 sc1
  buffer_store_dwordx2 v[116:117], v29, s[4:7], s34 offen offset:0 sc1
  v_add_f32 v140, 0x358637bd, v140
  v_rcp_f32 v140, v140
  s_nop 0
  v_pk_mul_f32 v[128:129], v[128:129], v[140:141] op_sel:[0,0] op_sel_hi:[1,0]
  v_pk_mul_f32 v[130:131], v[130:131], v[140:141] op_sel:[0,0] op_sel_hi:[1,0]
  v_pk_mul_f32 v[132:133], v[132:133], v[140:141] op_sel:[0,0] op_sel_hi:[1,0]
  v_pk_mul_f32 v[134:135], v[134:135], v[140:141] op_sel:[0,0] op_sel_hi:[1,0]
  v_pk_mul_f32 v[136:137], v[136:137], v[140:141] op_sel:[0,0] op_sel_hi:[1,0]
  v_pk_mul_f32 v[138:139], v[138:139], v[140:141] op_sel:[0,0] op_sel_hi:[1,0]
  v_cvt_pk_bf16_f32 v144, v128, v129
  v_cvt_pk_bf16_f32 v145, v130, v131
  v_cvt_pk_bf16_f32 v146, v132, v133
  v_cvt_pk_bf16_f32 v147, v134, v135
  v_cvt_pk_bf16_f32 v148, v136, v137
  v_cvt_pk_bf16_f32 v149, v138, v139
  buffer_store_dwordx4 v[144:147], v28, s[4:7], s32 offen offset:2048 sc1
  buffer_store_dwordx2 v[148:149], v29, s[4:7], s34 offen offset:2048 sc1
  s_lshr_b32 s32, s30, 1
  s_lshl_b32 s32, s32, 2
  s_add_u32 s32, s32, s37
  s_lshl_b32 s32, s32, 10
  v_add_u32 v4, s32, v22
  v_xor_b32 v5, 0x400, v4
  v_xor_b32 v6, 0x800, v4
  v_xor_b32 v7, 0xc00, v4
  s_and_b32 s32, s30, 1
  s_mul_i32 s32, s32, 5120
  s_add_u32 s32, s32, 0x4000
  v_add_u32 v8, s32, v22
  s_mov_b32 s44, 0
  v_mov_b32 v32, 0
  v_mov_b32 v33, 0
  v_mov_b32 v34, 0
  v_mov_b32 v35, 0
  s_nop 1
  v_mfma_f32_32x32x16_bf16 v[160:175], v[32:35], v[32:35], 0
  v_mfma_f32_32x32x16_bf16 v[176:191], v[32:35], v[32:35], 0
  v_mfma_f32_32x32x16_bf16 v[192:207], v[32:35], v[32:35], 0
  v_mfma_f32_32x32x16_bf16 v[208:223], v[32:35], v[32:35], 0
  v_mfma_f32_32x32x16_bf16 v[224:239], v[32:35], v[32:35], 0
  s_waitcnt vmcnt(4)
  v_cmp_gt_u32 vcc, v21, v26
  s_nop 0
  s_cbranch_vccnz M_poll_23
M_poll_23_r:
  s_add_u32 m0, s43, s31
  s_nop 0
  buffer_load_dwordx4 v2, s[24:27], s40 offen offset:0 sc1 lds
  buffer_load_dwordx4 v2, s[24:27], s40 offen offset:1024 sc1 lds
  buffer_load_dwordx4 v2, s[24:27], s40 offen offset:2048 sc1 lds
  buffer_load_dwordx4 v2, s[24:27], s40 offen offset:3072 sc1 lds
  s_add_u32 s86, s86, 1
  s_and_b32 s86, s86, 15
  s_add_u32 s43, s43, 36864
  s_cmp_eq_u32 s43, 147456
  s_cselect_b32 s43, 0, s43
  s_mul_i32 s40, s86, s47
  s_mul_i32 s41, s86, s92
  s_add_u32 s41, s41, s87
  s_add_u32 s42, s41, 0x1000
  s_waitcnt vmcnt(8) lgkmcnt(0)
  s_barrier
  ds_read_b128 a[16:19], v8 offset:0
  ds_read_b128 a[0:3], v4 offset:0
  ds_read_b128 a[4:7], v5 offset:0
  ds_read_b128 a[8:11], v6 offset:0
  ds_read_b128 a[12:15], v7 offset:0
  ds_read_b128 a[20:23], v8 offset:1024
  ds_read_b128 a[24:27], v8 offset:2048
  ds_read_b128 a[28:31], v8 offset:3072
  ds_read_b128 a[32:35], v8 offset:4096
  s_waitcnt lgkmcnt(0)
  s_mov_b32 s95, 2
  s_call_b64 s[48:49], M_p3
  s_cmp_lg_u32 s30, 0
  s_cbranch_scc1 M_pub_24
  s_lshl_b32 s32, s2, 7
  v_mov_b32 v23, 7
  v_lshlrev_b32 v24, 2, v1
  s_mov_b32 exec_hi, 0
  buffer_store_dword v23, v24, s[20:23], s32 offen sc1
  s_mov_b64 exec, -1
M_pub_24:
  s_mov_b32 s95, 4
  s_call_b64 s[48:49], M_p3
  s_lshr_b32 s32, s36, 2
  s_mul_i32 s32, s32, 5
  v_mul_u32_u24 v24, 0x3334, v1
  v_lshrrev_b32 v24, 16, v24
  v_mul_u32_u24 v24, 35, v24
  v_add3_u32 v23, v24, v1, s32
  s_andn2_b32 s32, s2, 6
  v_and_b32 v24, 3, v1
  v_lshl_add_u32 v24, v24, 1, s32
  v_cmp_gt_u32 vcc, 25, v1
  s_nop 1
  v_cndmask_b32 v23, v24, v23, vcc
  v_and_b32 v24, 31, v1
  v_lshl_add_u32 v24, v24, 3, s35
  v_cmp_gt_u32 vcc, 32, v1
  s_nop 1
  v_cndmask_b32 v20, v24, v23, vcc
  v_lshlrev_b32 v20, 7, v20
  v_cndmask_b32 v21, 7, 5, vcc
  buffer_load_dword v26, v20, s[20:23], 0 offen sc1
  s_lshl_b32 s50, s35, 2
  s_and_b32 s32, s36, 3
  s_add_u32 s50, s50, s32
  s_mul_i32 s32, s50, 81920
  s_add_u32 s4, s80, s32
  s_addc_u32 s5, s81, 0
  s_add_u32 s4, s4, 0x4000000
  s_addc_u32 s5, s5, 0
  s_mov_b32 s6, 0x14000
  s_mov_b32 s7, 0x20000
  s_lshl_b32 s34, s30, 10
  v_and_b32 v23, 15, v1
  v_lshlrev_b32 v23, 3, v23
  v_sub_u32 v28, v22, v23
  s_mov_b32 s95, 1
  s_call_b64 s[48:49], M_p3
  s_waitcnt vmcnt(9)
  v_cmp_gt_u32 vcc, v21, v26
  s_nop 0
  s_cbranch_vccnz M_poll_25
M_poll_25_r:
  buffer_load_dwordx4 a[80:83], v22, s[4:7], s34 offen sc1
  s_addk_i32 s34, 0x1000
  buffer_load_dwordx4 a[84:87], v22, s[4:7], s34 offen sc1
  s_addk_i32 s34, 0x1000
  buffer_load_dwordx4 a[88:91], v22, s[4:7], s34 offen sc1
  s_addk_i32 s34, 0x1000
  s_mov_b32 s95, 0
  s_call_b64 s[48:49], M_p3
  buffer_load_dwordx4 a[92:95], v22, s[4:7], s34 offen sc1
  s_addk_i32 s34, 0x1000
  buffer_load_dwordx2 a[96:97], v28, s[4:7], s34 offen offset:0 sc1
  buffer_load_dwordx2 a[98:99], v28, s[4:7], s34 offen offset:128 sc1
  s_addk_i32 s34, 0x1000
  buffer_load_dwordx4 a[100:103], v22, s[4:7], s34 offen sc1
  s_addk_i32 s34, 0x1000
  s_mov_b32 s95, 0
  s_call_b64 s[48:49], M_p3
  buffer_load_dwordx4 a[104:107], v22, s[4:7], s34 offen sc1
  s_addk_i32 s34, 0x1000
  buffer_load_dwordx4 a[108:111], v22, s[4:7], s34 offen sc1
  s_addk_i32 s34, 0x1000
  buffer_load_dwordx4 a[112:115], v22, s[4:7], s34 offen sc1
  s_addk_i32 s34, 0x1000
  buffer_load_dwordx2 a[116:117], v28, s[4:7], s34 offen offset:0 sc1
  buffer_load_dwordx2 a[118:119], v28, s[4:7], s34 offen offset:128 sc1
  s_addk_i32 s34, 0x1000
  s_mov_b32 s95, 0
  s_call_b64 s[48:49], M_p3
  s_lshr_b32 s32, s36, 2
  s_mul_i32 s32, s32, 102400
  s_add_u32 s24, s80, s32
  s_addc_u32 s25, s81, 0
  s_add_u32 s24, s24, 0x3e00000
  s_addc_u32 s25, s25, 0
  s_mov_b32 s26, 0x19000
  s_mov_b32 s27, 0x20000
  s_mov_b64 s[12:13], s[24:25]
  s_mov_b32 s14, s26
  s_mov_b32 s86, 0
  s_mov_b32 s47, 36864
  s_mov_b32 s92, 36864
  s_movk_i32 s87, 0x4000
  s_mul_i32 s40, s86, s47
  s_mul_i32 s41, s86, s92
  s_add_u32 s41, s41, s87
  s_add_u32 s42, s41, 0x1000
  buffer_load_dwordx4 a[120:123], v22, s[4:7], s34 offen sc1
  s_addk_i32 s34, 0x1000
  buffer_load_dwordx4 a[124:127], v22, s[4:7], s34 offen sc1
  s_addk_i32 s34, 0x1000
  buffer_load_dwordx4 a[128:131], v22, s[4:7], s34 offen sc1
  s_addk_i32 s34, 0x1000
  s_mov_b32 s95, 0
  s_call_b64 s[48:49], M_p3
  buffer_load_dwordx4 a[132:135], v22, s[4:7], s34 offen sc1
  s_addk_i32 s34, 0x1000
  buffer_load_dwordx2 a[136:137], v28, s[4:7], s34 offen offset:0 sc1
  buffer_load_dwordx2 a[138:139], v28, s[4:7], s34 offen offset:128 sc1
  s_addk_i32 s34, 0x1000
  buffer_load_dwordx4 a[140:143], v22, s[4:7], s34 offen sc1
  s_addk_i32 s34, 0x1000
  s_mov_b32 s95, 0
  s_call_b64 s[48:49], M_p3
  buffer_load_dwordx4 a[144:147], v22, s[4:7], s34 offen sc1
  s_addk_i32 s34, 0x1000
  buffer_load_dwordx4 a[148:151], v22, s[4:7], s34 offen sc1
  s_addk_i32 s34, 0x1000
  buffer_load_dwordx4 a[152:155], v22, s[4:7], s34 offen sc1
  s_addk_i32 s34, 0x1000
  buffer_load_dwordx2 a[156:157], v28, s[4:7], s34 offen offset:0 sc1
  buffer_load_dwordx2 a[158:159], v28, s[4:7], s34 offen offset:128 sc1
  s_addk_i32 s34, 0x1000
  s_mov_b32 s95, 0
  s_call_b64 s[48:49], M_p3
  s_and_b32 s32, s35, 1
  s_lshl_b32 s32, s32, 5
  s_add_u32 s32, s32, s36
  s_mul_i32 s32, s32, 163840
  s_add_u32 s16, s80, s32
  s_addc_u32 s17, s81, 0
  s_add_u32 s16, s16, 0x4c00000
  s_addc_u32 s17, s17, 0
  s_mov_b32 s18, 0x28000
  s_mov_b32 s19, 0x20000
  s_mul_i32 s32, s30, 2560
  v_add_u32 v3, s32, v22
  v_lshl_add_u32 v4, v1, 3, s32
  v_cvt_pk_bf16_f32 v180, v180, v181
  v_cvt_pk_bf16_f32 v181, v182, v183
  v_cvt_pk_bf16_f32 v182, v184, v185
  v_cvt_pk_bf16_f32 v183, v186, v187
  v_cvt_pk_bf16_f32 v184, v188, v189
  v_cvt_pk_bf16_f32 v185, v190, v191
  v_cvt_pk_bf16_f32 v186, v192, v193
  v_cvt_pk_bf16_f32 v187, v194, v195
  v_cvt_pk_bf16_f32 v188, v196, v197
  v_cvt_pk_bf16_f32 v189, v198, v199
  v_min_u32 v180, -2, v180
  v_min_u32 v181, -2, v181
  v_min_u32 v182, -2, v182
  v_min_u32 v183, -2, v183
  v_min_u32 v184, -2, v184
  v_min_u32 v185, -2, v185
  v_min_u32 v186, -2, v186
  v_min_u32 v187, -2, v187
  v_min_u32 v188, -2, v188
  v_min_u32 v189, -2, v189
  s_lshr_b32 s33, s35, 1
  s_xor_b32 s32, s33, 1
  s_lshl2_add_u32 s32, s32, s33
  s_mul_i32 s32, s32, 10240
  buffer_store_dwordx4 v[180:183], v3, s[16:19], s32 offen offset:0 sc1
  buffer_store_dwordx4 v[184:187], v3, s[16:19], s32 offen offset:1024 sc1
  buffer_store_dwordx2 v[188:189], v4, s[16:19], s32 offen offset:2048 sc1
  v_cvt_pk_bf16_f32 v200, v200, v201
  v_cvt_pk_bf16_f32 v201, v202, v203
  v_cvt_pk_bf16_f32 v202, v204, v205
  v_cvt_pk_bf16_f32 v203, v206, v207
  v_cvt_pk_bf16_f32 v204, v208, v209
  v_cvt_pk_bf16_f32 v205, v210, v211
  v_cvt_pk_bf16_f32 v206, v212, v213
  v_cvt_pk_bf16_f32 v207, v214, v215
  v_cvt_pk_bf16_f32 v208, v216, v217
  v_cvt_pk_bf16_f32 v209, v218, v219
  v_min_u32 v200, -2, v200
  v_min_u32 v201, -2, v201
  v_min_u32 v202, -2, v202
  v_min_u32 v203, -2, v203
  v_min_u32 v204, -2, v204
  v_min_u32 v205, -2, v205
  v_min_u32 v206, -2, v206
  v_min_u32 v207, -2, v207
  v_min_u32 v208, -2, v208
  v_min_u32 v209, -2, v209
  s_lshr_b32 s33, s35, 1
  s_xor_b32 s32, s33, 2
  s_lshl2_add_u32 s32, s32, s33
  s_mul_i32 s32, s32, 10240
  buffer_store_dwordx4 v[200:203], v3, s[16:19], s32 offen offset:0 sc1
  buffer_store_dwordx4 v[204:207], v3, s[16:19], s32 offen offset:1024 sc1
  buffer_store_dwordx2 v[208:209], v4, s[16:19], s32 offen offset:2048 sc1
  v_cvt_pk_bf16_f32 v220, v220, v221
  v_cvt_pk_bf16_f32 v221, v222, v223
  v_cvt_pk_bf16_f32 v222, v224, v225
  v_cvt_pk_bf16_f32 v223, v226, v227
  v_cvt_pk_bf16_f32 v224, v228, v229
  v_cvt_pk_bf16_f32 v225, v230, v231
  v_cvt_pk_bf16_f32 v226, v232, v233
  v_cvt_pk_bf16_f32 v227, v234, v235
  v_cvt_pk_bf16_f32 v228, v236, v237
  v_cvt_pk_bf16_f32 v229, v238, v239
  v_min_u32 v220, -2, v220
  v_min_u32 v221, -2, v221
  v_min_u32 v222, -2, v222
  v_min_u32 v223, -2, v223
  v_min_u32 v224, -2, v224
  v_min_u32 v225, -2, v225
  v_min_u32 v226, -2, v226
  v_min_u32 v227, -2, v227
  v_min_u32 v228, -2, v228
  v_min_u32 v229, -2, v229
  s_lshr_b32 s33, s35, 1
  s_xor_b32 s32, s33, 3
  s_lshl2_add_u32 s32, s32, s33
  s_mul_i32 s32, s32, 10240
  buffer_store_dwordx4 v[220:223], v3, s[16:19], s32 offen offset:0 sc1
  buffer_store_dwordx4 v[224:227], v3, s[16:19], s32 offen offset:1024 sc1
  buffer_store_dwordx2 v[228:229], v4, s[16:19], s32 offen offset:2048 sc1
  v_add_u32 v8, 51200, v22
  s_waitcnt vmcnt(9)
  s_barrier
  ds_read_b128 a[0:3], v22 offset:0
  ds_read_b128 a[4:7], v22 offset:1024
  ds_read_b128 a[8:11], v22 offset:2048
  ds_read_b128 a[12:15], v22 offset:3072
  ds_read_b128 a[16:19], v22 offset:4096
  ds_read_b128 a[20:23], v22 offset:5120
  ds_read_b128 a[24:27], v22 offset:6144
  ds_read_b128 a[28:31], v22 offset:7168
  ds_read_b128 a[32:35], v22 offset:8192
  ds_read_b128 a[36:39], v22 offset:9216
  s_waitcnt lgkmcnt(5)
  v_mfma_f32_16x16x32_bf16 v[32:35], a[0:3], a[80:83], 0
  ds_read_b128 a[40:43], v22 offset:10240
  v_mfma_f32_16x16x32_bf16 v[36:39], a[4:7], a[80:83], 0
  ds_read_b128 a[44:47], v22 offset:11264
  v_mfma_f32_16x16x32_bf16 v[40:43], a[8:11], a[80:83], 0
  ds_read_b128 a[48:51], v22 offset:12288
  v_mfma_f32_16x16x32_bf16 v[44:47], a[12:15], a[80:83], 0
  ds_read_b128 a[52:55], v22 offset:13312
  v_mfma_f32_16x16x32_bf16 v[48:51], a[16:19], a[80:83], 0
  ds_read_b128 a[56:59], v22 offset:14336
  s_waitcnt lgkmcnt(5)
  v_mfma_f32_16x16x32_bf16 v[32:35], a[20:23], a[84:87], v[32:35]
  ds_read_b128 a[0:3], v22 offset:15360
  v_mfma_f32_16x16x32_bf16 v[36:39], a[24:27], a[84:87], v[36:39]
  ds_read_b128 a[4:7], v22 offset:16384
  v_mfma_f32_16x16x32_bf16 v[40:43], a[28:31], a[84:87], v[40:43]
  ds_read_b128 a[8:11], v22 offset:17408
  v_mfma_f32_16x16x32_bf16 v[44:47], a[32:35], a[84:87], v[44:47]
  ds_read_b128 a[12:15], v22 offset:18432
  v_mfma_f32_16x16x32_bf16 v[48:51], a[36:39], a[84:87], v[48:51]
  ds_read_b128 a[16:19], v22 offset:19456
  s_waitcnt lgkmcnt(5)
  v_mfma_f32_16x16x32_bf16 v[32:35], a[40:43], a[88:91], v[32:35]
  ds_read_b128 a[20:23], v22 offset:20480
  v_mfma_f32_16x16x32_bf16 v[36:39], a[44:47], a[88:91], v[36:39]
  ds_read_b128 a[24:27], v22 offset:21504
  v_mfma_f32_16x16x32_bf16 v[40:43], a[48:51], a[88:91], v[40:43]
  ds_read_b128 a[28:31], v22 offset:22528
  v_mfma_f32_16x16x32_bf16 v[44:47], a[52:55], a[88:91], v[44:47]
  ds_read_b128 a[32:35], v22 offset:23552
  v_mfma_f32_16x16x32_bf16 v[48:51], a[56:59], a[88:91], v[48:51]
  ds_read_b128 a[36:39], v22 offset:24576
  s_waitcnt lgkmcnt(5)
  v_mfma_f32_16x16x32_bf16 v[32:35], a[0:3], a[92:95], v[32:35]
  ds_read_b128 a[40:43], v22 offset:25600
  v_mfma_f32_16x16x32_bf16 v[36:39], a[4:7], a[92:95], v[36:39]
  ds_read_b128 a[44:47], v22 offset:26624
  v_mfma_f32_16x16x32_bf16 v[40:43], a[8:11], a[92:95], v[40:43]
  ds_read_b128 a[48:51], v22 offset:27648
  v_mfma_f32_16x16x32_bf16 v[44:47], a[12:15], a[92:95], v[44:47]
  ds_read_b128 a[52:55], v22 offset:28672
  v_mfma_f32_16x16x32_bf16 v[48:51], a[16:19], a[92:95], v[48:51]
  ds_read_b128 a[56:59], v22 offset:29696
  s_waitcnt lgkmcnt(5)
  v_mfma_f32_16x16x32_bf16 v[32:35], a[20:23], a[96:99], v[32:35]
  ds_read_b128 a[0:3], v22 offset:30720
  v_mfma_f32_16x16x32_bf16 v[36:39], a[24:27], a[96:99], v[36:39]
  ds_read_b128 a[4:7], v22 offset:31744
  v_mfma_f32_16x16x32_bf16 v[40:43], a[28:31], a[96:99], v[40:43]
  ds_read_b128 a[8:11], v22 offset:32768
  v_mfma_f32_16x16x32_bf16 v[44:47], a[32:35], a[96:99], v[44:47]
  ds_read_b128 a[12:15], v22 offset:33792
  v_mfma_f32_16x16x32_bf16 v[48:51], a[36:39], a[96:99], v[48:51]
  ds_read_b128 a[16:19], v22 offset:34816
  s_waitcnt lgkmcnt(5)
  v_mfma_f32_16x16x32_bf16 v[32:35], a[40:43], a[100:103], v[32:35]
  ds_read_b128 a[20:23], v22 offset:35840
  v_mfma_f32_16x16x32_bf16 v[36:39], a[44:47], a[100:103], v[36:39]
  ds_read_b128 a[24:27], v22 offset:36864
  v_mfma_f32_16x16x32_bf16 v[40:43], a[48:51], a[100:103], v[40:43]
  ds_read_b128 a[28:31], v22 offset:37888
  v_mfma_f32_16x16x32_bf16 v[44:47], a[52:55], a[100:103], v[44:47]
  ds_read_b128 a[32:35], v22 offset:38912
  v_mfma_f32_16x16x32_bf16 v[48:51], a[56:59], a[100:103], v[48:51]
  ds_read_b128 a[36:39], v22 offset:39936
  s_waitcnt lgkmcnt(5)
  v_mfma_f32_16x16x32_bf16 v[32:35], a[0:3], a[104:107], v[32:35]
  ds_read_b128 a[40:43], v22 offset:40960
  v_mfma_f32_16x16x32_bf16 v[36:39], a[4:7], a[104:107], v[36:39]
  ds_read_b128 a[44:47], v22 offset:41984
  v_mfma_f32_16x16x32_bf16 v[40:43], a[8:11], a[104:107], v[40:43]
  ds_read_b128 a[48:51], v22 offset:43008
  v_mfma_f32_16x16x32_bf16 v[44:47], a[12:15], a[104:107], v[44:47]
  ds_read_b128 a[52:55], v22 offset:44032
  v_mfma_f32_16x16x32_bf16 v[48:51], a[16:19], a[104:107], v[48:51]
  ds_read_b128 a[56:59], v22 offset:45056
  s_waitcnt lgkmcnt(5)
  v_mfma_f32_16x16x32_bf16 v[32:35], a[20:23], a[108:111], v[32:35]
  ds_read_b128 a[0:3], v22 offset:46080
  v_mfma_f32_16x16x32_bf16 v[36:39], a[24:27], a[108:111], v[36:39]
  ds_read_b128 a[4:7], v22 offset:47104
  v_mfma_f32_16x16x32_bf16 v[40:43], a[28:31], a[108:111], v[40:43]
  ds_read_b128 a[8:11], v22 offset:48128
  v_mfma_f32_16x16x32_bf16 v[44:47], a[32:35], a[108:111], v[44:47]
  ds_read_b128 a[12:15], v22 offset:49152
  v_mfma_f32_16x16x32_bf16 v[48:51], a[36:39], a[108:111], v[48:51]
  ds_read_b128 a[16:19], v22 offset:50176
  s_waitcnt lgkmcnt(5)
  v_mfma_f32_16x16x32_bf16 v[32:35], a[40:43], a[112:115], v[32:35]
  ds_read_b128 a[20:23], v8 offset:0
  v_mfma_f32_16x16x32_bf16 v[36:39], a[44:47], a[112:115], v[36:39]
  ds_read_b128 a[24:27], v8 offset:1024
  v_mfma_f32_16x16x32_bf16 v[40:43], a[48:51], a[112:115], v[40:43]
  ds_read_b128 a[28:31], v8 offset:2048
  v_mfma_f32_16x16x32_bf16 v[44:47], a[52:55], a[112:115], v[44:47]
  ds_read_b128 a[32:35], v8 offset:3072
  v_mfma_f32_16x16x32_bf16 v[48:51], a[56:59], a[112:115], v[48:51]
  ds_read_b128 a[36:39], v8 offset:4096
  s_waitcnt lgkmcnt(5)
  v_mfma_f32_16x16x32_bf16 v[32:35], a[0:3], a[116:119], v[32:35]
  ds_read_b128 a[40:43], v8 offset:5120
  v_mfma_f32_16x16x32_bf16 v[36:39], a[4:7], a[116:119], v[36:39]
  ds_read_b128 a[44:47], v8 offset:6144
  v_mfma_f32_16x16x32_bf16 v[40:43], a[8:11], a[116:119], v[40:43]
  ds_read_b128 a[48:51], v8 offset:7168
  v_mfma_f32_16x16x32_bf16 v[44:47], a[12:15], a[116:119], v[44:47]
  ds_read_b128 a[52:55], v8 offset:8192
  v_mfma_f32_16x16x32_bf16 v[48:51], a[16:19], a[116:119], v[48:51]
  ds_read_b128 a[56:59], v8 offset:9216
  s_waitcnt lgkmcnt(5)
  v_mfma_f32_16x16x32_bf16 v[32:35], a[20:23], a[120:123], v[32:35]
  ds_read_b128 a[0:3], v8 offset:10240
  v_mfma_f32_16x16x32_bf16 v[36:39], a[24:27], a[120:123], v[36:39]
  ds_read_b128 a[4:7], v8 offset:11264
  v_mfma_f32_16x16x32_bf16 v[40:43], a[28:31], a[120:123], v[40:43]
  ds_read_b128 a[8:11], v8 offset:12288
  v_mfma_f32_16x16x32_bf16 v[44:47], a[32:35], a[120:123], v[44:47]
  ds_read_b128 a[12:15], v8 offset:13312
  v_mfma_f32_16x16x32_bf16 v[48:51], a[36:39], a[120:123], v[48:51]
  ds_read_b128 a[16:19], v8 offset:14336
  s_waitcnt lgkmcnt(5)
  v_mfma_f32_16x16x32_bf16 v[32:35], a[40:43], a[124:127], v[32:35]
  ds_read_b128 a[20:23], v8 offset:15360
  v_mfma_f32_16x16x32_bf16 v[36:39], a[44:47], a[124:127], v[36:39]
  ds_read_b128 a[24:27], v8 offset:16384
  v_mfma_f32_16x16x32_bf16 v[40:43], a[48:51], a[124:127], v[40:43]
  ds_read_b128 a[28:31], v8 offset:17408
  v_mfma_f32_16x16x32_bf16 v[44:47], a[52:55], a[124:127], v[44:47]
  ds_read_b128 a[32:35], v8 offset:18432
  v_mfma_f32_16x16x32_bf16 v[48:51], a[56:59], a[124:127], v[48:51]
  ds_read_b128 a[36:39], v8 offset:19456
  s_waitcnt lgkmcnt(5)
  v_mfma_f32_16x16x32_bf16 v[32:35], a[0:3], a[128:131], v[32:35]
  ds_read_b128 a[40:43], v8 offset:20480
  v_mfma_f32_16x16x32_bf16 v[36:39], a[4:7], a[128:131], v[36:39]
  ds_read_b128 a[44:47], v8 offset:21504
  v_mfma_f32_16x16x32_bf16 v[40:43], a[8:11], a[128:131], v[40:43]
  ds_read_b128 a[48:51], v8 offset:22528
  v_mfma_f32_16x16x32_bf16 v[44:47], a[12:15], a[128:131], v[44:47]
  ds_read_b128 a[52:55], v8 offset:23552
  v_mfma_f32_16x16x32_bf16 v[48:51], a[16:19], a[128:131], v[48:51]
  ds_read_b128 a[56:59], v8 offset:24576
  s_waitcnt lgkmcnt(5)
  v_mfma_f32_16x16x32_bf16 v[32:35], a[20:23], a[132:135], v[32:35]
  ds_read_b128 a[0:3], v8 offset:25600
  v_mfma_f32_16x16x32_bf16 v[36:39], a[24:27], a[132:135], v[36:39]
  ds_read_b128 a[4:7], v8 offset:26624
  v_mfma_f32_16x16x32_bf16 v[40:43], a[28:31], a[132:135], v[40:43]
  ds_read_b128 a[8:11], v8 offset:27648
  v_mfma_f32_16x16x32_bf16 v[44:47], a[32:35], a[132:135], v[44:47]
  ds_read_b128 a[12:15], v8 offset:28672
  v_mfma_f32_16x16x32_bf16 v[48:51], a[36:39], a[132:135], v[48:51]
  ds_read_b128 a[16:19], v8 offset:29696
  s_waitcnt lgkmcnt(5)
  v_mfma_f32_16x16x32_bf16 v[32:35], a[40:43], a[136:139], v[32:35]
  ds_read_b128 a[20:23], v8 offset:30720
  v_mfma_f32_16x16x32_bf16 v[36:39], a[44:47], a[136:139], v[36:39]
  ds_read_b128 a[24:27], v8 offset:31744
  v_mfma_f32_16x16x32_bf16 v[40:43], a[48:51], a[136:139], v[40:43]
  ds_read_b128 a[28:31], v8 offset:32768
  v_mfma_f32_16x16x32_bf16 v[44:47], a[52:55], a[136:139], v[44:47]
  ds_read_b128 a[32:35], v8 offset:33792
  v_mfma_f32_16x16x32_bf16 v[48:51], a[56:59], a[136:139], v[48:51]
  ds_read_b128 a[36:39], v8 offset:34816
  s_waitcnt lgkmcnt(5)
  v_mfma_f32_16x16x32_bf16 v[32:35], a[0:3], a[140:143], v[32:35]
  ds_read_b128 a[40:43], v8 offset:35840
  v_mfma_f32_16x16x32_bf16 v[36:39], a[4:7], a[140:143], v[36:39]
  ds_read_b128 a[44:47], v8 offset:36864
  v_mfma_f32_16x16x32_bf16 v[40:43], a[8:11], a[140:143], v[40:43]
  ds_read_b128 a[48:51], v8 offset:37888
  v_mfma_f32_16x16x32_bf16 v[44:47], a[12:15], a[140:143], v[44:47]
  ds_read_b128 a[52:55], v8 offset:38912
  v_mfma_f32_16x16x32_bf16 v[48:51], a[16:19], a[140:143], v[48:51]
  ds_read_b128 a[56:59], v8 offset:39936
  s_waitcnt lgkmcnt(5)
  v_mfma_f32_16x16x32_bf16 v[32:35], a[20:23], a[144:147], v[32:35]
  ds_read_b128 a[0:3], v8 offset:40960
  v_mfma_f32_16x16x32_bf16 v[36:39], a[24:27], a[144:147], v[36:39]
  ds_read_b128 a[4:7], v8 offset:41984
  v_mfma_f32_16x16x32_bf16 v[40:43], a[28:31], a[144:147], v[40:43]
  ds_read_b128 a[8:11], v8 offset:43008
  v_mfma_f32_16x16x32_bf16 v[44:47], a[32:35], a[144:147], v[44:47]
  ds_read_b128 a[12:15], v8 offset:44032
  v_mfma_f32_16x16x32_bf16 v[48:51], a[36:39], a[144:147], v[48:51]
  ds_read_b128 a[16:19], v8 offset:45056
  s_waitcnt lgkmcnt(5)
  v_mfma_f32_16x16x32_bf16 v[32:35], a[40:43], a[148:151], v[32:35]
  ds_read_b128 a[20:23], v8 offset:46080
  v_mfma_f32_16x16x32_bf16 v[36:39], a[44:47], a[148:151], v[36:39]
  ds_read_b128 a[24:27], v8 offset:47104
  v_mfma_f32_16x16x32_bf16 v[40:43], a[48:51], a[148:151], v[40:43]
  ds_read_b128 a[28:31], v8 offset:48128
  v_mfma_f32_16x16x32_bf16 v[44:47], a[52:55], a[148:151], v[44:47]
  ds_read_b128 a[32:35], v8 offset:49152
  v_mfma_f32_16x16x32_bf16 v[48:51], a[56:59], a[148:151], v[48:51]
  ds_read_b128 a[36:39], v8 offset:50176
  s_waitcnt lgkmcnt(5)
  v_mfma_f32_16x16x32_bf16 v[32:35], a[0:3], a[152:155], v[32:35]
  s_lshr_b32 s33, s35, 1
  s_xor_b32 s32, s33, 1
  s_lshl2_add_u32 s32, s33, s32
  s_mul_i32 s32, s32, 10240
  buffer_load_dwordx4 v[180:183], v3, s[16:19], s32 offen offset:0 sc1
  buffer_load_dwordx4 v[184:187], v3, s[16:19], s32 offen offset:1024 sc1
  buffer_load_dwordx2 v[188:189], v4, s[16:19], s32 offen offset:2048 sc1
  s_lshr_b32 s33, s35, 1
  s_xor_b32 s32, s33, 2
  s_lshl2_add_u32 s32, s33, s32
  s_mul_i32 s32, s32, 10240
  buffer_load_dwordx4 v[200:203], v3, s[16:19], s32 offen offset:0 sc1
  buffer_load_dwordx4 v[204:207], v3, s[16:19], s32 offen offset:1024 sc1
  buffer_load_dwordx2 v[208:209], v4, s[16:19], s32 offen offset:2048 sc1
  s_lshr_b32 s33, s35, 1
  s_xor_b32 s32, s33, 3
  s_lshl2_add_u32 s32, s33, s32
  s_mul_i32 s32, s32, 10240
  buffer_load_dwordx4 v[220:223], v3, s[16:19], s32 offen offset:0 sc1
  buffer_load_dwordx4 v[224:227], v3, s[16:19], s32 offen offset:1024 sc1
  buffer_load_dwordx2 v[228:229], v4, s[16:19], s32 offen offset:2048 sc1
  v_mfma_f32_16x16x32_bf16 v[36:39], a[4:7], a[152:155], v[36:39]
  v_mfma_f32_16x16x32_bf16 v[40:43], a[8:11], a[152:155], v[40:43]
  v_mfma_f32_16x16x32_bf16 v[44:47], a[12:15], a[152:155], v[44:47]
  v_mfma_f32_16x16x32_bf16 v[48:51], a[16:19], a[152:155], v[48:51]
  s_waitcnt lgkmcnt(0)
  v_mfma_f32_16x16x32_bf16 v[32:35], a[20:23], a[156:159], v[32:35]
  v_mfma_f32_16x16x32_bf16 v[36:39], a[24:27], a[156:159], v[36:39]
  v_mfma_f32_16x16x32_bf16 v[40:43], a[28:31], a[156:159], v[40:43]
  v_mfma_f32_16x16x32_bf16 v[44:47], a[32:35], a[156:159], v[44:47]
  v_mfma_f32_16x16x32_bf16 v[48:51], a[36:39], a[156:159], v[48:51]
  s_mov_b32 s8, s76
  s_mov_b32 s9, s77
  s_mov_b32 s10, 0x500000
  s_mov_b32 s11, 0x20000
  v_and_b32 v23, 15, v1
  v_mul_u32_u24 v8, 2560, v23
  v_lshrrev_b32 v23, 4, v1
  v_lshl_add_u32 v8, v23, 3, v8
  s_lshl_b32 s32, s50, 2
  s_add_u32 s32, s32, s30
  s_mul_i32 s32, s32, 40960
  s_lshr_b32 s33, s36, 2
  s_mul_i32 s33, s33, 160
  s_add_u32 s34, s32, s33
  v_cvt_pk_bf16_f32 v32, v32, v33
  v_cvt_pk_bf16_f32 v33, v34, v35
  buffer_store_dwordx2 v[32:33], v8, s[8:11], s34 offen offset:1280
  v_cvt_pk_bf16_f32 v36, v36, v37
  v_cvt_pk_bf16_f32 v37, v38, v39
  buffer_store_dwordx2 v[36:37], v8, s[8:11], s34 offen offset:1312
  v_cvt_pk_bf16_f32 v40, v40, v41
  v_cvt_pk_bf16_f32 v41, v42, v43
  buffer_store_dwordx2 v[40:41], v8, s[8:11], s34 offen offset:1344
  v_cvt_pk_bf16_f32 v44, v44, v45
  v_cvt_pk_bf16_f32 v45, v46, v47
  buffer_store_dwordx2 v[44:45], v8, s[8:11], s34 offen offset:1376
  v_cvt_pk_bf16_f32 v48, v48, v49
  v_cvt_pk_bf16_f32 v49, v50, v51
  buffer_store_dwordx2 v[48:49], v8, s[8:11], s34 offen offset:1408
  s_lshl_b32 s32, s38, 3
  s_lshr_b32 s33, s30, 1
  s_lshl_b32 s33, s33, 2
  s_add_u32 s32, s32, s33
  s_add_u32 s32, s32, s37
  s_mul_i32 s32, s32, 40960
  s_lshl_b32 s33, s39, 1
  s_and_b32 s34, s30, 1
  s_add_u32 s33, s33, s34
  s_mul_i32 s33, s33, 160
  s_add_u32 s34, s32, s33
  s_mov_b32 s52, 0x40000
M_xchk:
  s_waitcnt vmcnt(13)
  v_max_u32 v23, v180, v181
  v_max3_u32 v23, v23, v182, v183
  s_waitcnt vmcnt(12)
  v_max3_u32 v23, v23, v184, v185
  v_max3_u32 v23, v23, v186, v187
  s_waitcnt vmcnt(11)
  v_max3_u32 v23, v23, v188, v189
  s_waitcnt vmcnt(10)
  v_max3_u32 v23, v23, v200, v201
  v_max3_u32 v23, v23, v202, v203
  s_waitcnt vmcnt(9)
  v_max3_u32 v23, v23, v204, v205
  v_max3_u32 v23, v23, v206, v207
  s_waitcnt vmcnt(8)
  v_max3_u32 v23, v23, v208, v209
  s_waitcnt vmcnt(7)
  v_max3_u32 v23, v23, v220, v221
  v_max3_u32 v23, v23, v222, v223
  s_waitcnt vmcnt(6)
  v_max3_u32 v23, v23, v224, v225
  v_max3_u32 v23, v23, v226, v227
  s_waitcnt vmcnt(5)
  v_max3_u32 v23, v23, v228, v229
  v_cmp_eq_u32 vcc, -1, v23
  s_nop 0
  s_cbranch_vccnz M_xagain
M_xok:
  s_mov_b32 s32, 0xffff0000
  v_lshlrev_b32 v96, 16, v180
  v_and_b32 v97, s32, v180
  v_pk_add_f32 v[160:161], v[160:161], v[96:97]
  v_lshlrev_b32 v98, 16, v181
  v_and_b32 v99, s32, v181
  v_pk_add_f32 v[162:163], v[162:163], v[98:99]
  v_lshlrev_b32 v100, 16, v182
  v_and_b32 v101, s32, v182
  v_pk_add_f32 v[164:165], v[164:165], v[100:101]
  v_lshlrev_b32 v102, 16, v183
  v_and_b32 v103, s32, v183
  v_pk_add_f32 v[166:167], v[166:167], v[102:103]
  v_lshlrev_b32 v96, 16, v184
  v_and_b32 v97, s32, v184
  v_pk_add_f32 v[168:169], v[168:169], v[96:97]
  v_lshlrev_b32 v98, 16, v185
  v_and_b32 v99, s32, v185
  v_pk_add_f32 v[170:171], v[170:171], v[98:99]
  v_lshlrev_b32 v100, 16, v186
  v_and_b32 v101, s32, v186
  v_pk_add_f32 v[172:173], v[172:173], v[100:101]
  v_lshlrev_b32 v102, 16, v187
  v_and_b32 v103, s32, v187
  v_pk_add_f32 v[174:175], v[174:175], v[102:103]
  v_lshlrev_b32 v96, 16, v188
  v_and_b32 v97, s32, v188
  v_pk_add_f32 v[176:177], v[176:177], v[96:97]
  v_lshlrev_b32 v98, 16, v189
  v_and_b32 v99, s32, v189
  v_pk_add_f32 v[178:179], v[178:179], v[98:99]
  v_lshlrev_b32 v96, 16, v200
  v_and_b32 v97, s32, v200
  v_pk_add_f32 v[160:161], v[160:161], v[96:97]
  v_lshlrev_b32 v98, 16, v201
  v_and_b32 v99, s32, v201
  v_pk_add_f32 v[162:163], v[162:163], v[98:99]
  v_lshlrev_b32 v100, 16, v202
  v_and_b32 v101, s32, v202
  v_pk_add_f32 v[164:165], v[164:165], v[100:101]
  v_lshlrev_b32 v102, 16, v203
  v_and_b32 v103, s32, v203
  v_pk_add_f32 v[166:167], v[166:167], v[102:103]
  v_lshlrev_b32 v96, 16, v204
  v_and_b32 v97, s32, v204
  v_pk_add_f32 v[168:169], v[168:169], v[96:97]
  v_lshlrev_b32 v98, 16, v205
  v_and_b32 v99, s32, v205
  v_pk_add_f32 v[170:171], v[170:171], v[98:99]
  v_lshlrev_b32 v100, 16, v206
  v_and_b32 v101, s32, v206
  v_pk_add_f32 v[172:173], v[172:173], v[100:101]
  v_lshlrev_b32 v102, 16, v207
  v_and_b32 v103, s32, v207
  v_pk_add_f32 v[174:175], v[174:175], v[102:103]
  v_lshlrev_b32 v96, 16, v208
  v_and_b32 v97, s32, v208
  v_pk_add_f32 v[176:177], v[176:177], v[96:97]
  v_lshlrev_b32 v98, 16, v209
  v_and_b32 v99, s32, v209
  v_pk_add_f32 v[178:179], v[178:179], v[98:99]
  v_lshlrev_b32 v96, 16, v220
  v_and_b32 v97, s32, v220
  v_pk_add_f32 v[160:161], v[160:161], v[96:97]
  v_lshlrev_b32 v98, 16, v221
  v_and_b32 v99, s32, v221
  v_pk_add_f32 v[162:163], v[162:163], v[98:99]
  v_lshlrev_b32 v100, 16, v222
  v_and_b32 v101, s32, v222
  v_pk_add_f32 v[164:165], v[164:165], v[100:101]
  v_lshlrev_b32 v102, 16, v223
  v_and_b32 v103, s32, v223
  v_pk_add_f32 v[166:167], v[166:167], v[102:103]
  v_lshlrev_b32 v96, 16, v224
  v_and_b32 v97, s32, v224
  v_pk_add_f32 v[168:169], v[168:169], v[96:97]
  v_lshlrev_b32 v98, 16, v225
  v_and_b32 v99, s32, v225
  v_pk_add_f32 v[170:171], v[170:171], v[98:99]
  v_lshlrev_b32 v100, 16, v226
  v_and_b32 v101, s32, v226
  v_pk_add_f32 v[172:173], v[172:173], v[100:101]
  v_lshlrev_b32 v102, 16, v227
  v_and_b32 v103, s32, v227
  v_pk_add_f32 v[174:175], v[174:175], v[102:103]
  v_lshlrev_b32 v96, 16, v228
  v_and_b32 v97, s32, v228
  v_pk_add_f32 v[176:177], v[176:177], v[96:97]
  v_lshlrev_b32 v98, 16, v229
  v_and_b32 v99, s32, v229
  v_pk_add_f32 v[178:179], v[178:179], v[98:99]
  v_cvt_pk_bf16_f32 v160, v160, v161
  v_cvt_pk_bf16_f32 v161, v162, v163
  buffer_store_dwordx2 v[160:161], v8, s[8:11], s34 offen offset:0
  v_cvt_pk_bf16_f32 v164, v164, v165
  v_cvt_pk_bf16_f32 v165, v166, v167
  buffer_store_dwordx2 v[164:165], v8, s[8:11], s34 offen offset:32
  v_cvt_pk_bf16_f32 v168, v168, v169
  v_cvt_pk_bf16_f32 v169, v170, v171
  buffer_store_dwordx2 v[168:169], v8, s[8:11], s34 offen offset:64
  v_cvt_pk_bf16_f32 v172, v172, v173
  v_cvt_pk_bf16_f32 v173, v174, v175
  buffer_store_dwordx2 v[172:173], v8, s[8:11], s34 offen offset:96
  v_cvt_pk_bf16_f32 v176, v176, v177
  v_cvt_pk_bf16_f32 v177, v178, v179
  buffer_store_dwordx2 v[176:177], v8, s[8:11], s34 offen offset:128
M_exit:
  s_endpgm
M_kvA:
  v_mfma_f32_16x16x32_bf16 v[120:123], a[232:235], a[196:199], v[120:123]
  ds_read_b128 a[128:131], v10 offset:0
  s_mov_b32 m0, s41
  v_mfma_f32_16x16x32_bf16 v[124:127], a[236:239], a[196:199], v[124:127]
  buffer_load_dwordx4 v6, s[8:11], s44 offen offset:0 nt lds
  v_mfma_f32_16x16x32_bf16 v[128:131], a[224:227], a[200:203], v[128:131]
  ds_read_b128 a[132:135], v10 offset:2048
  v_mfma_f32_16x16x32_bf16 v[132:135], a[228:231], a[200:203], v[132:135]
  v_mfma_f32_16x16x32_bf16 v[136:139], a[224:227], a[204:207], v[136:139]
  ds_read_b64_tr_b16 a[160:161], v14 offset:0
  buffer_load_dwordx4 v7, s[8:11], s44 offen offset:1024 nt lds
  v_mfma_f32_16x16x32_bf16 v[140:143], a[228:231], a[204:207], v[140:143]
  v_mfma_f32_16x16x32_bf16 v[144:147], a[232:235], a[200:203], v[144:147]
  ds_read_b64_tr_b16 a[162:163], v14 offset:1024
  v_mfma_f32_16x16x32_bf16 v[148:151], a[236:239], a[200:203], v[148:151]
  v_mfma_f32_16x16x32_bf16 v[152:155], a[232:235], a[204:207], v[152:155]
  ds_read_b64_tr_b16 a[164:165], v15 offset:0
  buffer_load_dwordx4 v8, s[8:11], s44 offen offset:2048 nt lds
  v_mfma_f32_16x16x32_bf16 v[156:159], a[236:239], a[204:207], v[156:159]
  v_mfma_f32_16x16x32_bf16 v[32:35], a[224:227], a[208:211], v[32:35]
  ds_read_b64_tr_b16 a[166:167], v15 offset:1024
  v_mfma_f32_16x16x32_bf16 v[36:39], a[228:231], a[208:211], v[36:39]
  v_mfma_f32_16x16x32_bf16 v[40:43], a[224:227], a[212:215], v[40:43]
  ds_read_b64_tr_b16 a[168:169], v16 offset:0
  buffer_load_dwordx4 v9, s[8:11], s44 offen offset:3072 nt lds
  v_mfma_f32_16x16x32_bf16 v[44:47], a[228:231], a[212:215], v[44:47]
  v_mfma_f32_16x16x32_bf16 v[48:51], a[232:235], a[208:211], v[48:51]
  ds_read_b64_tr_b16 a[170:171], v16 offset:1024
  v_mfma_f32_16x16x32_bf16 v[52:55], a[236:239], a[208:211], v[52:55]
  v_mfma_f32_16x16x32_bf16 v[56:59], a[232:235], a[212:215], v[56:59]
  ds_read_b64_tr_b16 a[172:173], v17 offset:0
  s_mov_b32 m0, s42
  v_mfma_f32_16x16x32_bf16 v[60:63], a[236:239], a[212:215], v[60:63]
  buffer_load_dwordx4 v6, s[12:15], s45 offen offset:0 nt lds
  v_mfma_f32_16x16x32_bf16 v[64:67], a[224:227], a[216:219], v[64:67]
  ds_read_b64_tr_b16 a[174:175], v17 offset:1024
  v_mfma_f32_16x16x32_bf16 v[68:71], a[228:231], a[216:219], v[68:71]
  v_mfma_f32_16x16x32_bf16 v[72:75], a[224:227], a[220:223], v[72:75]
  ds_read_b128 a[136:139], v10 offset:4096
  buffer_load_dwordx4 v7, s[12:15], s45 offen offset:1024 nt lds
  v_mfma_f32_16x16x32_bf16 v[76:79], a[228:231], a[220:223], v[76:79]
  v_mfma_f32_16x16x32_bf16 v[80:83], a[232:235], a[216:219], v[80:83]
  ds_read_b128 a[140:143], v10 offset:6144
  v_mfma_f32_16x16x32_bf16 v[84:87], a[236:239], a[216:219], v[84:87]
  buffer_load_dwordx4 v8, s[12:15], s45 offen offset:2048 nt lds
  v_mfma_f32_16x16x32_bf16 v[88:91], a[232:235], a[220:223], v[88:91]
  v_mfma_f32_16x16x32_bf16 v[92:95], a[236:239], a[220:223], v[92:95]
  ds_read_b128 a[144:147], v10 offset:8192
  v_mfma_f32_16x16x32_bf16 v[160:163], a[192:195], a[240:243], v[160:163]
  buffer_load_dwordx4 v9, s[12:15], s45 offen offset:3072 nt lds
  v_mfma_f32_16x16x32_bf16 v[164:167], a[196:199], a[240:243], v[164:167]
  ds_read_b128 a[148:151], v10 offset:10240
  v_mfma_f32_16x16x32_bf16 v[168:171], a[192:195], a[244:247], v[168:171]
  v_mfma_f32_16x16x32_bf16 v[172:175], a[196:199], a[244:247], v[172:175]
  ds_read_b128 a[152:155], v10 offset:12288
  v_mfma_f32_16x16x32_bf16 v[176:179], a[192:195], a[248:251], v[176:179]
  v_mfma_f32_16x16x32_bf16 v[180:183], a[196:199], a[248:251], v[180:183]
  ds_read_b128 a[156:159], v10 offset:14336
  v_mfma_f32_16x16x32_bf16 v[184:187], a[192:195], a[252:255], v[184:187]
  v_mfma_f32_16x16x32_bf16 v[188:191], a[196:199], a[252:255], v[188:191]
  ds_read_b64_tr_b16 a[176:177], v14 offset:16384
  v_mfma_f32_16x16x32_bf16 v[192:195], a[200:203], a[240:243], v[192:195]
  v_mfma_f32_16x16x32_bf16 v[196:199], a[204:207], a[240:243], v[196:199]
  ds_read_b64_tr_b16 a[178:179], v14 offset:17408
  v_mfma_f32_16x16x32_bf16 v[200:203], a[200:203], a[244:247], v[200:203]
  v_mfma_f32_16x16x32_bf16 v[204:207], a[204:207], a[244:247], v[204:207]
  ds_read_b64_tr_b16 a[180:181], v15 offset:16384
  v_mfma_f32_16x16x32_bf16 v[208:211], a[200:203], a[248:251], v[208:211]
  v_mfma_f32_16x16x32_bf16 v[212:215], a[204:207], a[248:251], v[212:215]
  ds_read_b64_tr_b16 a[182:183], v15 offset:17408
  v_mfma_f32_16x16x32_bf16 v[216:219], a[200:203], a[252:255], v[216:219]
  v_mfma_f32_16x16x32_bf16 v[220:223], a[204:207], a[252:255], v[220:223]
  ds_read_b64_tr_b16 a[184:185], v16 offset:16384
  v_mfma_f32_16x16x32_bf16 v[224:227], a[208:211], a[240:243], v[224:227]
  v_mfma_f32_16x16x32_bf16 v[228:231], a[212:215], a[240:243], v[228:231]
  ds_read_b64_tr_b16 a[186:187], v16 offset:17408
  v_mfma_f32_16x16x32_bf16 v[232:235], a[208:211], a[244:247], v[232:235]
  v_mfma_f32_16x16x32_bf16 v[236:239], a[212:215], a[244:247], v[236:239]
  ds_read_b64_tr_b16 a[188:189], v17 offset:16384
  v_mfma_f32_16x16x32_bf16 v[240:243], a[208:211], a[248:251], v[240:243]
  v_mfma_f32_16x16x32_bf16 v[244:247], a[212:215], a[248:251], v[244:247]
  ds_read_b64_tr_b16 a[190:191], v17 offset:17408
  v_mfma_f32_16x16x32_bf16 v[248:251], a[208:211], a[252:255], v[248:251]
  v_mfma_f32_16x16x32_bf16 v[252:255], a[212:215], a[252:255], v[252:255]
  v_mfma_f32_16x16x32_bf16 a[0:3], a[216:219], a[240:243], a[0:3]
  v_mfma_f32_16x16x32_bf16 a[4:7], a[220:223], a[240:243], a[4:7]
  v_mfma_f32_16x16x32_bf16 a[8:11], a[216:219], a[244:247], a[8:11]
  v_mfma_f32_16x16x32_bf16 a[12:15], a[220:223], a[244:247], a[12:15]
  v_mfma_f32_16x16x32_bf16 a[16:19], a[216:219], a[248:251], a[16:19]
  v_mfma_f32_16x16x32_bf16 a[20:23], a[220:223], a[248:251], a[20:23]
  v_mfma_f32_16x16x32_bf16 a[24:27], a[216:219], a[252:255], a[24:27]
  s_setpc_b64 s[48:49]
M_kvB:
  v_mfma_f32_16x16x32_bf16 v[120:123], a[168:171], a[132:135], v[120:123]
  ds_read_b128 a[192:195], v11 offset:0
  s_mov_b32 m0, s41
  v_mfma_f32_16x16x32_bf16 v[124:127], a[172:175], a[132:135], v[124:127]
  buffer_load_dwordx4 v2, s[4:7], s44 offen offset:0  lds
  v_mfma_f32_16x16x32_bf16 v[128:131], a[160:163], a[136:139], v[128:131]
  ds_read_b128 a[196:199], v11 offset:2048
  v_mfma_f32_16x16x32_bf16 v[132:135], a[164:167], a[136:139], v[132:135]
  v_mfma_f32_16x16x32_bf16 v[136:139], a[160:163], a[140:143], v[136:139]
  ds_read_b64_tr_b16 a[224:225], v14 offset:8192
  v_mfma_f32_16x16x32_bf16 v[140:143], a[164:167], a[140:143], v[140:143]
  v_mfma_f32_16x16x32_bf16 v[144:147], a[168:171], a[136:139], v[144:147]
  ds_read_b64_tr_b16 a[226:227], v14 offset:9216
  v_mfma_f32_16x16x32_bf16 v[148:151], a[172:175], a[136:139], v[148:151]
  buffer_load_dwordx4 v3, s[4:7], s44 offen offset:1024  lds
  v_mfma_f32_16x16x32_bf16 v[152:155], a[168:171], a[140:143], v[152:155]
  ds_read_b64_tr_b16 a[228:229], v15 offset:8192
  v_mfma_f32_16x16x32_bf16 v[156:159], a[172:175], a[140:143], v[156:159]
  v_mfma_f32_16x16x32_bf16 v[32:35], a[160:163], a[144:147], v[32:35]
  ds_read_b64_tr_b16 a[230:231], v15 offset:9216
  v_mfma_f32_16x16x32_bf16 v[36:39], a[164:167], a[144:147], v[36:39]
  v_mfma_f32_16x16x32_bf16 v[40:43], a[160:163], a[148:151], v[40:43]
  ds_read_b64_tr_b16 a[232:233], v16 offset:8192
  v_mfma_f32_16x16x32_bf16 v[44:47], a[164:167], a[148:151], v[44:47]
  v_mfma_f32_16x16x32_bf16 v[48:51], a[168:171], a[144:147], v[48:51]
  ds_read_b64_tr_b16 a[234:235], v16 offset:9216
  buffer_load_dwordx4 v4, s[4:7], s44 offen offset:2048  lds
  v_mfma_f32_16x16x32_bf16 v[52:55], a[172:175], a[144:147], v[52:55]
  v_mfma_f32_16x16x32_bf16 v[56:59], a[168:171], a[148:151], v[56:59]
  ds_read_b64_tr_b16 a[236:237], v17 offset:8192
  v_mfma_f32_16x16x32_bf16 v[60:63], a[172:175], a[148:151], v[60:63]
  v_mfma_f32_16x16x32_bf16 v[64:67], a[160:163], a[152:155], v[64:67]
  ds_read_b64_tr_b16 a[238:239], v17 offset:9216
  v_mfma_f32_16x16x32_bf16 v[68:71], a[164:167], a[152:155], v[68:71]
  v_mfma_f32_16x16x32_bf16 v[72:75], a[160:163], a[156:159], v[72:75]
  ds_read_b128 a[200:203], v11 offset:4096
  buffer_load_dwordx4 v5, s[4:7], s44 offen offset:3072  lds
  v_mfma_f32_16x16x32_bf16 v[76:79], a[164:167], a[156:159], v[76:79]
  v_mfma_f32_16x16x32_bf16 v[80:83], a[168:171], a[152:155], v[80:83]
  ds_read_b128 a[204:207], v11 offset:6144
  v_mfma_f32_16x16x32_bf16 v[84:87], a[172:175], a[152:155], v[84:87]
  v_mfma_f32_16x16x32_bf16 v[88:91], a[168:171], a[156:159], v[88:91]
  v_mfma_f32_16x16x32_bf16 v[92:95], a[172:175], a[156:159], v[92:95]
  ds_read_b128 a[208:211], v11 offset:8192
  v_mfma_f32_16x16x32_bf16 v[160:163], a[128:131], a[176:179], v[160:163]
  v_mfma_f32_16x16x32_bf16 v[164:167], a[132:135], a[176:179], v[164:167]
  ds_read_b128 a[212:215], v11 offset:10240
  s_mov_b32 m0, s42
  v_mfma_f32_16x16x32_bf16 v[168:171], a[128:131], a[180:183], v[168:171]
  buffer_load_dwordx4 v2, s[4:7], s45 offen offset:0  lds
  v_mfma_f32_16x16x32_bf16 v[172:175], a[132:135], a[180:183], v[172:175]
  ds_read_b128 a[216:219], v11 offset:12288
  v_mfma_f32_16x16x32_bf16 v[176:179], a[128:131], a[184:187], v[176:179]
  v_mfma_f32_16x16x32_bf16 v[180:183], a[132:135], a[184:187], v[180:183]
  ds_read_b128 a[220:223], v11 offset:14336
  v_mfma_f32_16x16x32_bf16 v[184:187], a[128:131], a[188:191], v[184:187]
  v_mfma_f32_16x16x32_bf16 v[188:191], a[132:135], a[188:191], v[188:191]
  ds_read_b64_tr_b16 a[240:241], v14 offset:24576
  v_mfma_f32_16x16x32_bf16 v[192:195], a[136:139], a[176:179], v[192:195]
  buffer_load_dwordx4 v3, s[4:7], s45 offen offset:1024  lds
  v_mfma_f32_16x16x32_bf16 v[196:199], a[140:143], a[176:179], v[196:199]
  ds_read_b64_tr_b16 a[242:243], v14 offset:25600
  v_mfma_f32_16x16x32_bf16 v[200:203], a[136:139], a[180:183], v[200:203]
  v_mfma_f32_16x16x32_bf16 v[204:207], a[140:143], a[180:183], v[204:207]
  ds_read_b64_tr_b16 a[244:245], v15 offset:24576
  v_mfma_f32_16x16x32_bf16 v[208:211], a[136:139], a[184:187], v[208:211]
  v_mfma_f32_16x16x32_bf16 v[212:215], a[140:143], a[184:187], v[212:215]
  ds_read_b64_tr_b16 a[246:247], v15 offset:25600
  v_mfma_f32_16x16x32_bf16 v[216:219], a[136:139], a[188:191], v[216:219]
  buffer_load_dwordx4 v4, s[4:7], s45 offen offset:2048  lds
  v_mfma_f32_16x16x32_bf16 v[220:223], a[140:143], a[188:191], v[220:223]
  ds_read_b64_tr_b16 a[248:249], v16 offset:24576
  v_mfma_f32_16x16x32_bf16 v[224:227], a[144:147], a[176:179], v[224:227]
  v_mfma_f32_16x16x32_bf16 v[228:231], a[148:151], a[176:179], v[228:231]
  ds_read_b64_tr_b16 a[250:251], v16 offset:25600
  v_mfma_f32_16x16x32_bf16 v[232:235], a[144:147], a[180:183], v[232:235]
  v_mfma_f32_16x16x32_bf16 v[236:239], a[148:151], a[180:183], v[236:239]
  ds_read_b64_tr_b16 a[252:253], v17 offset:24576
  v_mfma_f32_16x16x32_bf16 v[240:243], a[144:147], a[184:187], v[240:243]
  buffer_load_dwordx4 v5, s[4:7], s45 offen offset:3072  lds
  v_mfma_f32_16x16x32_bf16 v[244:247], a[148:151], a[184:187], v[244:247]
  ds_read_b64_tr_b16 a[254:255], v17 offset:25600
  v_mfma_f32_16x16x32_bf16 v[248:251], a[144:147], a[188:191], v[248:251]
  v_mfma_f32_16x16x32_bf16 v[252:255], a[148:151], a[188:191], v[252:255]
  v_mfma_f32_16x16x32_bf16 a[0:3], a[152:155], a[176:179], a[0:3]
  v_mfma_f32_16x16x32_bf16 a[4:7], a[156:159], a[176:179], a[4:7]
  v_mfma_f32_16x16x32_bf16 a[8:11], a[152:155], a[180:183], a[8:11]
  v_add_u32 v10, s86, v10
  v_add_u32 v11, s86, v11
  v_mfma_f32_16x16x32_bf16 a[12:15], a[156:159], a[180:183], a[12:15]
  v_add_u32 v14, s87, v14
  v_mfma_f32_16x16x32_bf16 a[16:19], a[152:155], a[184:187], a[16:19]
  v_add_u32 v15, s87, v15
  v_mfma_f32_16x16x32_bf16 a[20:23], a[156:159], a[184:187], a[20:23]
  v_add_u32 v16, s87, v16
  v_mfma_f32_16x16x32_bf16 a[24:27], a[152:155], a[188:191], a[24:27]
  v_add_u32 v17, s87, v17
  s_setpc_b64 s[48:49]
M_b0:
  v_mfma_f32_32x32x16_bf16 v[64:79], a[168:171], a[164:167], v[64:79]
  ds_read_b128 a[128:131], v10 offset:0
  ds_read_b64_tr_b16 a[136:137], v14 offset:0
  ds_read_b64_tr_b16 a[138:139], v14 offset:1024
  s_mov_b32 m0, s41
  v_mfma_f32_32x32x16_bf16 v[80:95], a[172:175], a[164:167], v[80:95]
  ds_read_b128 a[132:135], v10 offset:4096
  ds_read_b64_tr_b16 a[140:141], v15 offset:0
  buffer_load_dwordx4 v6, s[8:11], s44 offen offset:0  lds
  v_mfma_f32_32x32x16_bf16 v[32:47], a[184:187], a[176:179], v[32:47]
  ds_read_b64_tr_b16 a[142:143], v15 offset:1024
  ds_read_b128 a[144:147], v11 offset:0
  ds_read_b64_tr_b16 a[152:153], v14 offset:4096
  buffer_load_dwordx4 v7, s[8:11], s44 offen offset:1024  lds
  v_mfma_f32_32x32x16_bf16 v[48:63], a[188:191], a[176:179], v[48:63]
  ds_read_b64_tr_b16 a[154:155], v14 offset:5120
  ds_read_b128 a[148:151], v11 offset:4096
  v_mfma_f32_32x32x16_bf16 v[64:79], a[184:187], a[180:183], v[64:79]
  ds_read_b64_tr_b16 a[156:157], v15 offset:4096
  ds_read_b64_tr_b16 a[158:159], v15 offset:5120
  buffer_load_dwordx4 v8, s[8:11], s44 offen offset:2048  lds
  v_mfma_f32_32x32x16_bf16 v[80:95], a[188:191], a[180:183], v[80:95]
  s_waitcnt lgkmcnt(0)
  buffer_load_dwordx4 v9, s[8:11], s44 offen offset:3072  lds
  v_mfma_f32_32x32x16_bf16 v[32:47], a[136:139], a[128:131], v[32:47]
  ds_read_b128 a[160:163], v12 offset:0
  ds_read_b64_tr_b16 a[168:169], v14 offset:8192
  v_mfma_f32_32x32x16_bf16 v[48:63], a[140:143], a[128:131], v[48:63]
  ds_read_b64_tr_b16 a[170:171], v14 offset:9216
  ds_read_b128 a[164:167], v12 offset:4096
  s_mov_b32 m0, s42
  v_mfma_f32_32x32x16_bf16 v[64:79], a[136:139], a[132:135], v[64:79]
  ds_read_b64_tr_b16 a[172:173], v15 offset:8192
  ds_read_b64_tr_b16 a[174:175], v15 offset:9216
  buffer_load_dwordx4 v2, s[4:7], s45 offen offset:0  lds
  v_add_u32 v10, s86, v10
  v_add_u32 v11, s86, v11
  v_mfma_f32_32x32x16_bf16 v[80:95], a[140:143], a[132:135], v[80:95]
  ds_read_b128 a[176:179], v13 offset:0
  ds_read_b64_tr_b16 a[184:185], v14 offset:12288
  buffer_load_dwordx4 v3, s[4:7], s45 offen offset:1024  lds
  v_mfma_f32_32x32x16_bf16 v[32:47], a[152:155], a[144:147], v[32:47]
  ds_read_b64_tr_b16 a[186:187], v14 offset:13312
  ds_read_b128 a[180:183], v13 offset:4096
  buffer_load_dwordx4 v4, s[4:7], s45 offen offset:2048  lds
  v_mfma_f32_32x32x16_bf16 v[48:63], a[156:159], a[144:147], v[48:63]
  ds_read_b64_tr_b16 a[188:189], v15 offset:12288
  ds_read_b64_tr_b16 a[190:191], v15 offset:13312
  buffer_load_dwordx4 v5, s[4:7], s45 offen offset:3072  lds
  v_mfma_f32_32x32x16_bf16 v[64:79], a[152:155], a[148:151], v[64:79]
  v_add_u32 v12, s86, v12
  v_add_u32 v13, s86, v13
  v_add_u32 v14, s87, v14
  v_add_u32 v15, s87, v15
  s_setpc_b64 s[48:49]
M_b1:
  v_mfma_f32_32x32x16_bf16 v[64:79], a[164:167], a[168:171], v[64:79]
  ds_read_b128 a[128:131], v10 offset:0
  ds_read_b64_tr_b16 a[136:137], v14 offset:0
  ds_read_b64_tr_b16 a[138:139], v14 offset:1024
  s_mov_b32 m0, s41
  v_mfma_f32_32x32x16_bf16 v[80:95], a[164:167], a[172:175], v[80:95]
  ds_read_b128 a[132:135], v10 offset:4096
  ds_read_b64_tr_b16 a[140:141], v15 offset:0
  buffer_load_dwordx4 v6, s[8:11], s44 offen offset:0  lds
  v_mfma_f32_32x32x16_bf16 v[32:47], a[176:179], a[184:187], v[32:47]
  ds_read_b64_tr_b16 a[142:143], v15 offset:1024
  ds_read_b128 a[144:147], v11 offset:0
  ds_read_b64_tr_b16 a[152:153], v14 offset:4096
  buffer_load_dwordx4 v7, s[8:11], s44 offen offset:1024  lds
  v_mfma_f32_32x32x16_bf16 v[48:63], a[176:179], a[188:191], v[48:63]
  ds_read_b64_tr_b16 a[154:155], v14 offset:5120
  ds_read_b128 a[148:151], v11 offset:4096
  v_mfma_f32_32x32x16_bf16 v[64:79], a[180:183], a[184:187], v[64:79]
  ds_read_b64_tr_b16 a[156:157], v15 offset:4096
  ds_read_b64_tr_b16 a[158:159], v15 offset:5120
  buffer_load_dwordx4 v8, s[8:11], s44 offen offset:2048  lds
  v_mfma_f32_32x32x16_bf16 v[80:95], a[180:183], a[188:191], v[80:95]
  s_waitcnt lgkmcnt(0)
  buffer_load_dwordx4 v9, s[8:11], s44 offen offset:3072  lds
  v_mfma_f32_32x32x16_bf16 v[32:47], a[128:131], a[136:139], v[32:47]
  ds_read_b128 a[160:163], v12 offset:0
  ds_read_b64_tr_b16 a[168:169], v14 offset:8192
  v_mfma_f32_32x32x16_bf16 v[48:63], a[128:131], a[140:143], v[48:63]
  ds_read_b64_tr_b16 a[170:171], v14 offset:9216
  ds_read_b128 a[164:167], v12 offset:4096
  s_mov_b32 m0, s42
  v_mfma_f32_32x32x16_bf16 v[64:79], a[132:135], a[136:139], v[64:79]
  ds_read_b64_tr_b16 a[172:173], v15 offset:8192
  ds_read_b64_tr_b16 a[174:175], v15 offset:9216
  buffer_load_dwordx4 v2, s[4:7], s45 offen offset:0  lds
  v_add_u32 v10, s86, v10
  v_add_u32 v11, s86, v11
  v_mfma_f32_32x32x16_bf16 v[80:95], a[132:135], a[140:143], v[80:95]
  ds_read_b128 a[176:179], v13 offset:0
  ds_read_b64_tr_b16 a[184:185], v14 offset:12288
  buffer_load_dwordx4 v3, s[4:7], s45 offen offset:1024  lds
  v_mfma_f32_32x32x16_bf16 v[32:47], a[144:147], a[152:155], v[32:47]
  ds_read_b64_tr_b16 a[186:187], v14 offset:13312
  ds_read_b128 a[180:183], v13 offset:4096
  buffer_load_dwordx4 v4, s[4:7], s45 offen offset:2048  lds
  v_mfma_f32_32x32x16_bf16 v[48:63], a[144:147], a[156:159], v[48:63]
  ds_read_b64_tr_b16 a[188:189], v15 offset:12288
  ds_read_b64_tr_b16 a[190:191], v15 offset:13312
  buffer_load_dwordx4 v5, s[4:7], s45 offen offset:3072  lds
  v_mfma_f32_32x32x16_bf16 v[64:79], a[148:151], a[152:155], v[64:79]
  v_add_u32 v12, s86, v12
  v_add_u32 v13, s86, v13
  v_add_u32 v14, s87, v14
  v_add_u32 v15, s87, v15
  s_setpc_b64 s[48:49]
M_q:
  v_mfma_f32_16x16x32_bf16 v[136:139], a[72:75], a[60:63], v[136:139]
  ds_read_b128 a[8:11], v12 offset:0
  s_mov_b32 m0, s41
  v_mfma_f32_16x16x32_bf16 v[108:111], a[76:79], a[56:59], v[108:111]
  ds_read_b128 a[12:15], v12 offset:2048
  buffer_load_dwordx4 v2, s[4:7], s44 offen offset:0  lds
  v_mfma_f32_16x16x32_bf16 v[140:143], a[76:79], a[60:63], v[140:143]
  ds_read_b64_tr_b16 a[16:17], v14 offset:0
  v_mfma_f32_16x16x32_bf16 v[112:115], a[80:83], a[56:59], v[112:115]
  ds_read_b64_tr_b16 a[18:19], v14 offset:1024
  v_mfma_f32_16x16x32_bf16 v[144:147], a[80:83], a[60:63], v[144:147]
  ds_read_b64_tr_b16 a[20:21], v15 offset:0
  v_mfma_f32_16x16x32_bf16 v[116:119], a[84:87], a[56:59], v[116:119]
  ds_read_b64_tr_b16 a[22:23], v15 offset:1024
  buffer_load_dwordx4 v3, s[4:7], s44 offen offset:1024  lds
  v_mfma_f32_16x16x32_bf16 v[148:151], a[84:87], a[60:63], v[148:151]
  ds_read_b64_tr_b16 a[24:25], v16 offset:0
  v_mfma_f32_16x16x32_bf16 v[120:123], a[88:91], a[56:59], v[120:123]
  ds_read_b64_tr_b16 a[26:27], v16 offset:1024
  v_mfma_f32_16x16x32_bf16 v[152:155], a[88:91], a[60:63], v[152:155]
  ds_read_b64_tr_b16 a[28:29], v17 offset:0
  v_mfma_f32_16x16x32_bf16 v[124:127], a[92:95], a[56:59], v[124:127]
  ds_read_b64_tr_b16 a[30:31], v17 offset:1024
  buffer_load_dwordx4 v4, s[4:7], s44 offen offset:2048  lds
  v_mfma_f32_16x16x32_bf16 v[156:159], a[92:95], a[60:63], v[156:159]
  v_mfma_f32_16x16x32_bf16 v[32:35], a[64:67], a[48:51], v[32:35]
  ds_read_b64_tr_b16 a[32:33], v18 offset:0
  v_mfma_f32_16x16x32_bf16 v[64:67], a[64:67], a[52:55], v[64:67]
  ds_read_b64_tr_b16 a[34:35], v18 offset:1024
  v_mfma_f32_16x16x32_bf16 v[36:39], a[68:71], a[48:51], v[36:39]
  ds_read_b64_tr_b16 a[36:37], v19 offset:0
  buffer_load_dwordx4 v5, s[4:7], s44 offen offset:3072  lds
  v_mfma_f32_16x16x32_bf16 v[68:71], a[68:71], a[52:55], v[68:71]
  ds_read_b64_tr_b16 a[38:39], v19 offset:1024
  v_mfma_f32_16x16x32_bf16 v[40:43], a[72:75], a[48:51], v[40:43]
  ds_read_b64_tr_b16 a[40:41], v20 offset:0
  v_mfma_f32_16x16x32_bf16 v[72:75], a[72:75], a[52:55], v[72:75]
  ds_read_b64_tr_b16 a[42:43], v20 offset:1024
  v_mfma_f32_16x16x32_bf16 v[44:47], a[76:79], a[48:51], v[44:47]
  ds_read_b64_tr_b16 a[44:45], v21 offset:0
  s_mov_b32 m0, s42
  v_mfma_f32_16x16x32_bf16 v[76:79], a[76:79], a[52:55], v[76:79]
  ds_read_b64_tr_b16 a[46:47], v21 offset:1024
  buffer_load_dwordx4 v2, s[4:7], s45 offen offset:0  lds
  v_mfma_f32_16x16x32_bf16 v[48:51], a[80:83], a[48:51], v[48:51]
  ds_read_b128 a[0:3], v10 offset:0
  v_mfma_f32_16x16x32_bf16 v[80:83], a[80:83], a[52:55], v[80:83]
  ds_read_b128 a[4:7], v10 offset:2048
  v_mfma_f32_16x16x32_bf16 v[52:55], a[84:87], a[48:51], v[52:55]
  v_mfma_f32_16x16x32_bf16 v[84:87], a[84:87], a[52:55], v[84:87]
  buffer_load_dwordx4 v3, s[4:7], s45 offen offset:1024  lds
  v_mfma_f32_16x16x32_bf16 v[56:59], a[88:91], a[48:51], v[56:59]
  v_mfma_f32_16x16x32_bf16 v[88:91], a[88:91], a[52:55], v[88:91]
  v_mfma_f32_16x16x32_bf16 v[60:63], a[92:95], a[48:51], v[60:63]
  v_mfma_f32_16x16x32_bf16 v[92:95], a[92:95], a[52:55], v[92:95]
  s_waitcnt lgkmcnt(0)
  buffer_load_dwordx4 v4, s[4:7], s45 offen offset:2048  lds
  v_mfma_f32_16x16x32_bf16 v[96:99], a[16:19], a[8:11], v[96:99]
  ds_read_b128 a[56:59], v13 offset:0
  v_mfma_f32_16x16x32_bf16 v[128:131], a[16:19], a[12:15], v[128:131]
  ds_read_b128 a[60:63], v13 offset:2048
  v_mfma_f32_16x16x32_bf16 v[100:103], a[20:23], a[8:11], v[100:103]
  ds_read_b64_tr_b16 a[64:65], v14 offset:8192
  v_mfma_f32_16x16x32_bf16 v[132:135], a[20:23], a[12:15], v[132:135]
  ds_read_b64_tr_b16 a[66:67], v14 offset:9216
  buffer_load_dwordx4 v5, s[4:7], s45 offen offset:3072  lds
  v_mfma_f32_16x16x32_bf16 v[104:107], a[24:27], a[8:11], v[104:107]
  ds_read_b64_tr_b16 a[68:69], v15 offset:8192
  v_mfma_f32_16x16x32_bf16 v[136:139], a[24:27], a[12:15], v[136:139]
  ds_read_b64_tr_b16 a[70:71], v15 offset:9216
  v_mfma_f32_16x16x32_bf16 v[108:111], a[28:31], a[8:11], v[108:111]
  ds_read_b64_tr_b16 a[72:73], v16 offset:8192
  v_mfma_f32_16x16x32_bf16 v[140:143], a[28:31], a[12:15], v[140:143]
  s_mov_b32 m0, s43
  v_mfma_f32_16x16x32_bf16 v[112:115], a[32:35], a[8:11], v[112:115]
  ds_read_b64_tr_b16 a[74:75], v16 offset:9216
  buffer_load_dwordx4 v6, s[8:11], s46 offen offset:0  lds
  v_mfma_f32_16x16x32_bf16 v[144:147], a[32:35], a[12:15], v[144:147]
  ds_read_b64_tr_b16 a[76:77], v17 offset:8192
  v_mfma_f32_16x16x32_bf16 v[116:119], a[36:39], a[8:11], v[116:119]
  ds_read_b64_tr_b16 a[78:79], v17 offset:9216
  v_mfma_f32_16x16x32_bf16 v[148:151], a[36:39], a[12:15], v[148:151]
  ds_read_b64_tr_b16 a[80:81], v18 offset:8192
  v_mfma_f32_16x16x32_bf16 v[120:123], a[40:43], a[8:11], v[120:123]
  ds_read_b64_tr_b16 a[82:83], v18 offset:9216
  buffer_load_dwordx4 v7, s[8:11], s46 offen offset:1024  lds
  v_mfma_f32_16x16x32_bf16 v[152:155], a[40:43], a[12:15], v[152:155]
  ds_read_b64_tr_b16 a[84:85], v19 offset:8192
  v_mfma_f32_16x16x32_bf16 v[124:127], a[44:47], a[8:11], v[124:127]
  ds_read_b64_tr_b16 a[86:87], v19 offset:9216
  v_mfma_f32_16x16x32_bf16 v[156:159], a[44:47], a[12:15], v[156:159]
  v_mfma_f32_16x16x32_bf16 v[32:35], a[16:19], a[0:3], v[32:35]
  ds_read_b64_tr_b16 a[88:89], v20 offset:8192
  buffer_load_dwordx4 v8, s[8:11], s46 offen offset:2048  lds
  v_mfma_f32_16x16x32_bf16 v[64:67], a[16:19], a[4:7], v[64:67]
  ds_read_b64_tr_b16 a[90:91], v20 offset:9216
  v_mfma_f32_16x16x32_bf16 v[36:39], a[20:23], a[0:3], v[36:39]
  ds_read_b64_tr_b16 a[92:93], v21 offset:8192
  v_mfma_f32_16x16x32_bf16 v[68:71], a[20:23], a[4:7], v[68:71]
  ds_read_b64_tr_b16 a[94:95], v21 offset:9216
  v_mfma_f32_16x16x32_bf16 v[40:43], a[24:27], a[0:3], v[40:43]
  ds_read_b128 a[48:51], v11 offset:0
  buffer_load_dwordx4 v9, s[8:11], s46 offen offset:3072  lds
  v_mfma_f32_16x16x32_bf16 v[72:75], a[24:27], a[4:7], v[72:75]
  ds_read_b128 a[52:55], v11 offset:2048
  v_mfma_f32_16x16x32_bf16 v[44:47], a[28:31], a[0:3], v[44:47]
  v_mfma_f32_16x16x32_bf16 v[76:79], a[28:31], a[4:7], v[76:79]
  v_mfma_f32_16x16x32_bf16 v[48:51], a[32:35], a[0:3], v[48:51]
  v_mfma_f32_16x16x32_bf16 v[80:83], a[32:35], a[4:7], v[80:83]
  v_add_u32 v10, s86, v10
  v_add_u32 v12, s87, v12
  v_mfma_f32_16x16x32_bf16 v[52:55], a[36:39], a[0:3], v[52:55]
  v_add_u32 v14, s83, v14
  v_xor_b32 v11, 64, v10
  v_mfma_f32_16x16x32_bf16 v[84:87], a[36:39], a[4:7], v[84:87]
  v_xor_b32 v13, 64, v12
  v_xor_b32 v15, 32, v14
  v_mfma_f32_16x16x32_bf16 v[56:59], a[40:43], a[0:3], v[56:59]
  v_xor_b32 v16, 64, v14
  v_xor_b32 v17, 96, v14
  v_mfma_f32_16x16x32_bf16 v[88:91], a[40:43], a[4:7], v[88:91]
  v_xor_b32 v18, 128, v14
  v_xor_b32 v19, 160, v14
  v_mfma_f32_16x16x32_bf16 v[60:63], a[44:47], a[0:3], v[60:63]
  v_xor_b32 v20, 192, v14
  v_xor_b32 v21, 224, v14
  s_setpc_b64 s[48:49]
M_poll_1:
  s_mov_b32 s52, 0x40000
M_poll_1_l:
  s_sleep 1
  v_mov_b32 v23, 0
  global_load_dword v29, v23, s[78:79] sc1
  s_waitcnt vmcnt(0)
  v_cmp_gt_u32 vcc, 1, v29
  s_nop 0
  s_cbranch_vccz M_poll_1_r
  s_sub_u32 s52, s52, 1
  s_cbranch_scc0 M_poll_1_l
  s_branch M_poll_1_r
M_poll_4:
  s_mov_b32 s52, 0x40000
M_poll_4_l:
  s_sleep 1
  v_and_b32 v23, 7, v1
  v_lshlrev_b32 v23, 10, v23
  s_andn2_b32 s32, s2, 0x38
  s_lshl_b32 s32, s32, 7
  buffer_load_dword v26, v23, s[20:23], s32 offen sc1
  s_waitcnt vmcnt(0)
  v_cmp_gt_u32 vcc, 1, v26
  s_nop 0
  s_cbranch_vccz M_poll_4_r
  s_sub_u32 s52, s52, 1
  s_cbranch_scc0 M_poll_4_l
  s_branch M_poll_4_r
M_phi:
  s_nop 8
  v_max3_f32 v24, v48, v49, v50
  v_max3_f32 v24, v24, v51, v52
  v_max3_f32 v24, v24, v53, v54
  v_max3_f32 v24, v24, v55, v56
  v_max3_f32 v24, v24, v57, v58
  v_max3_f32 v24, v24, v59, v60
  v_max3_f32 v24, v24, v61, v62
  v_max3_f32 v24, v24, v63, v64
  v_max3_f32 v24, v24, v65, v66
  v_max_f32 v24, v24, v67
  v_mul_f32 v24, s51, v24
  v_pk_fma_f32 v[48:49], v[48:49], s[50:51], v[24:25] op_sel:[0,1,0] op_sel_hi:[1,1,0] neg_lo:[0,0,1] neg_hi:[0,0,1]
  v_pk_fma_f32 v[50:51], v[50:51], s[50:51], v[24:25] op_sel:[0,1,0] op_sel_hi:[1,1,0] neg_lo:[0,0,1] neg_hi:[0,0,1]
  v_pk_fma_f32 v[52:53], v[52:53], s[50:51], v[24:25] op_sel:[0,1,0] op_sel_hi:[1,1,0] neg_lo:[0,0,1] neg_hi:[0,0,1]
  v_pk_fma_f32 v[54:55], v[54:55], s[50:51], v[24:25] op_sel:[0,1,0] op_sel_hi:[1,1,0] neg_lo:[0,0,1] neg_hi:[0,0,1]
  v_pk_fma_f32 v[56:57], v[56:57], s[50:51], v[24:25] op_sel:[0,1,0] op_sel_hi:[1,1,0] neg_lo:[0,0,1] neg_hi:[0,0,1]
  v_pk_fma_f32 v[58:59], v[58:59], s[50:51], v[24:25] op_sel:[0,1,0] op_sel_hi:[1,1,0] neg_lo:[0,0,1] neg_hi:[0,0,1]
  v_pk_fma_f32 v[60:61], v[60:61], s[50:51], v[24:25] op_sel:[0,1,0] op_sel_hi:[1,1,0] neg_lo:[0,0,1] neg_hi:[0,0,1]
  v_pk_fma_f32 v[62:63], v[62:63], s[50:51], v[24:25] op_sel:[0,1,0] op_sel_hi:[1,1,0] neg_lo:[0,0,1] neg_hi:[0,0,1]
  v_pk_fma_f32 v[64:65], v[64:65], s[50:51], v[24:25] op_sel:[0,1,0] op_sel_hi:[1,1,0] neg_lo:[0,0,1] neg_hi:[0,0,1]
  v_pk_fma_f32 v[66:67], v[66:67], s[50:51], v[24:25] op_sel:[0,1,0] op_sel_hi:[1,1,0] neg_lo:[0,0,1] neg_hi:[0,0,1]
  v_exp_f32 v48, v48
  v_exp_f32 v49, v49
  v_exp_f32 v50, v50
  v_exp_f32 v51, v51
  v_exp_f32 v52, v52
  v_exp_f32 v53, v53
  v_exp_f32 v54, v54
  v_exp_f32 v55, v55
  v_exp_f32 v56, v56
  v_exp_f32 v57, v57
  v_exp_f32 v58, v58
  v_exp_f32 v59, v59
  v_exp_f32 v60, v60
  v_exp_f32 v61, v61
  v_exp_f32 v62, v62
  v_exp_f32 v63, v63
  v_exp_f32 v64, v64
  v_exp_f32 v65, v65
  v_exp_f32 v66, v66
  v_exp_f32 v67, v67
  v_pk_add_f32 v[68:69], v[48:49], v[50:51]
  v_pk_add_f32 v[68:69], v[68:69], v[52:53]
  v_pk_add_f32 v[68:69], v[68:69], v[54:55]
  v_pk_add_f32 v[68:69], v[68:69], v[56:57]
  v_pk_add_f32 v[68:69], v[68:69], v[58:59]
  v_pk_add_f32 v[68:69], v[68:69], v[60:61]
  v_pk_add_f32 v[68:69], v[68:69], v[62:63]
  v_pk_add_f32 v[68:69], v[68:69], v[64:65]
  v_pk_add_f32 v[68:69], v[68:69], v[66:67]
  v_add_f32 v24, v68, v69
  v_rcp_f32 v24, v24
  s_nop 0
  v_pk_mul_f32 v[48:49], v[48:49], v[24:25] op_sel:[0,0] op_sel_hi:[1,0]
  v_pk_mul_f32 v[50:51], v[50:51], v[24:25] op_sel:[0,0] op_sel_hi:[1,0]
  v_pk_mul_f32 v[52:53], v[52:53], v[24:25] op_sel:[0,0] op_sel_hi:[1,0]
  v_pk_mul_f32 v[54:55], v[54:55], v[24:25] op_sel:[0,0] op_sel_hi:[1,0]
  v_pk_mul_f32 v[56:57], v[56:57], v[24:25] op_sel:[0,0] op_sel_hi:[1,0]
  v_pk_mul_f32 v[58:59], v[58:59], v[24:25] op_sel:[0,0] op_sel_hi:[1,0]
  v_pk_mul_f32 v[60:61], v[60:61], v[24:25] op_sel:[0,0] op_sel_hi:[1,0]
  v_pk_mul_f32 v[62:63], v[62:63], v[24:25] op_sel:[0,0] op_sel_hi:[1,0]
  v_pk_mul_f32 v[64:65], v[64:65], v[24:25] op_sel:[0,0] op_sel_hi:[1,0]
  v_pk_mul_f32 v[66:67], v[66:67], v[24:25] op_sel:[0,0] op_sel_hi:[1,0]
  v_cvt_pk_bf16_f32 v80, v48, v49
  v_cvt_pk_bf16_f32 v81, v50, v51
  v_cvt_pk_bf16_f32 v82, v52, v53
  v_cvt_pk_bf16_f32 v83, v54, v55
  v_cvt_pk_bf16_f32 v84, v56, v57
  v_cvt_pk_bf16_f32 v85, v58, v59
  v_cvt_pk_bf16_f32 v86, v60, v61
  v_cvt_pk_bf16_f32 v87, v62, v63
  v_cvt_pk_bf16_f32 v88, v64, v65
  v_cvt_pk_bf16_f32 v89, v66, v67
  s_setpc_b64 s[48:49]
M_poll_5:
  s_mov_b32 s52, 0x40000
M_poll_5_l:
  s_sleep 1
  v_min_u32 v23, 29, v1
  v_lshlrev_b32 v23, 10, v23
  s_lshl_b32 s32, s35, 7
  buffer_load_dword v26, v23, s[20:23], s32 offen sc1
  s_waitcnt vmcnt(0)
  v_cmp_gt_u32 vcc, 2, v26
  s_nop 0
  s_cbranch_vccz M_poll_5_r
  s_sub_u32 s52, s52, 1
  s_cbranch_scc0 M_poll_5_l
  s_branch M_poll_5_r
M_ev_6:
  s_sub_i32 s32, s92, s43
  s_lshl_b32 s32, s32, 5
  v_subrev_u32 v23, s32, v3
  v_cmp_gt_i32 s[84:85], 0, v23
  v_cmp_gt_i32 s[86:87], 1, v23
  v_cmp_gt_i32 s[88:89], 2, v23
  v_cmp_gt_i32 s[90:91], 3, v23
  v_cndmask_b32 v48, v48, v4, s[84:85]
  v_cndmask_b32 v49, v49, v4, s[86:87]
  v_cndmask_b32 v50, v50, v4, s[88:89]
  v_cndmask_b32 v51, v51, v4, s[90:91]
  v_cndmask_b32 v60, v60, v4, s[84:85]
  v_cndmask_b32 v61, v61, v4, s[86:87]
  v_cndmask_b32 v62, v62, v4, s[88:89]
  v_cndmask_b32 v63, v63, v4, s[90:91]
  v_cmp_gt_i32 s[84:85], 16, v23
  v_cmp_gt_i32 s[86:87], 17, v23
  v_cmp_gt_i32 s[88:89], 18, v23
  v_cmp_gt_i32 s[90:91], 19, v23
  v_cndmask_b32 v52, v52, v4, s[84:85]
  v_cndmask_b32 v53, v53, v4, s[86:87]
  v_cndmask_b32 v54, v54, v4, s[88:89]
  v_cndmask_b32 v55, v55, v4, s[90:91]
  v_cmp_gt_i32 s[84:85], -16, v23
  v_cmp_gt_i32 s[86:87], -15, v23
  v_cmp_gt_i32 s[88:89], -14, v23
  v_cmp_gt_i32 s[90:91], -13, v23
  v_cndmask_b32 v56, v56, v4, s[84:85]
  v_cndmask_b32 v57, v57, v4, s[86:87]
  v_cndmask_b32 v58, v58, v4, s[88:89]
  v_cndmask_b32 v59, v59, v4, s[90:91]
  s_branch M_ev_6_r
M_ev_7:
  s_sub_i32 s32, s92, s43
  s_lshl_b32 s32, s32, 5
  v_subrev_u32 v23, s32, v3
  v_cmp_gt_i32 s[84:85], 0, v23
  v_cmp_gt_i32 s[86:87], 1, v23
  v_cmp_gt_i32 s[88:89], 2, v23
  v_cmp_gt_i32 s[90:91], 3, v23
  v_cndmask_b32 v112, v112, v4, s[84:85]
  v_cndmask_b32 v113, v113, v4, s[86:87]
  v_cndmask_b32 v114, v114, v4, s[88:89]
  v_cndmask_b32 v115, v115, v4, s[90:91]
  v_cndmask_b32 v124, v124, v4, s[84:85]
  v_cndmask_b32 v125, v125, v4, s[86:87]
  v_cndmask_b32 v126, v126, v4, s[88:89]
  v_cndmask_b32 v127, v127, v4, s[90:91]
  v_cmp_gt_i32 s[84:85], 16, v23
  v_cmp_gt_i32 s[86:87], 17, v23
  v_cmp_gt_i32 s[88:89], 18, v23
  v_cmp_gt_i32 s[90:91], 19, v23
  v_cndmask_b32 v116, v116, v4, s[84:85]
  v_cndmask_b32 v117, v117, v4, s[86:87]
  v_cndmask_b32 v118, v118, v4, s[88:89]
  v_cndmask_b32 v119, v119, v4, s[90:91]
  v_cmp_gt_i32 s[84:85], -16, v23
  v_cmp_gt_i32 s[86:87], -15, v23
  v_cmp_gt_i32 s[88:89], -14, v23
  v_cmp_gt_i32 s[90:91], -13, v23
  v_cndmask_b32 v120, v120, v4, s[84:85]
  v_cndmask_b32 v121, v121, v4, s[86:87]
  v_cndmask_b32 v122, v122, v4, s[88:89]
  v_cndmask_b32 v123, v123, v4, s[90:91]
  s_branch M_ev_7_r
M_sl_8:
  s_call_b64 s[48:49], M_slow0
  s_branch M_sl_8_r
M_ev_9:
  s_cmp_eq_u32 s40, s95
  s_cbranch_scc1 M_ev_9_x
  s_sub_i32 s32, s92, s43
  s_lshl_b32 s32, s32, 5
  v_subrev_u32 v23, s32, v3
  v_cmp_gt_i32 s[84:85], 0, v23
  v_cmp_gt_i32 s[86:87], 1, v23
  v_cmp_gt_i32 s[88:89], 2, v23
  v_cmp_gt_i32 s[90:91], 3, v23
  v_cndmask_b32 v112, v112, v4, s[84:85]
  v_cndmask_b32 v113, v113, v4, s[86:87]
  v_cndmask_b32 v114, v114, v4, s[88:89]
  v_cndmask_b32 v115, v115, v4, s[90:91]
  v_cndmask_b32 v124, v124, v4, s[84:85]
  v_cndmask_b32 v125, v125, v4, s[86:87]
  v_cndmask_b32 v126, v126, v4, s[88:89]
  v_cndmask_b32 v127, v127, v4, s[90:91]
  v_cmp_gt_i32 s[84:85], 16, v23
  v_cmp_gt_i32 s[86:87], 17, v23
  v_cmp_gt_i32 s[88:89], 18, v23
  v_cmp_gt_i32 s[90:91], 19, v23
  v_cndmask_b32 v116, v116, v4, s[84:85]
  v_cndmask_b32 v117, v117, v4, s[86:87]
  v_cndmask_b32 v118, v118, v4, s[88:89]
  v_cndmask_b32 v119, v119, v4, s[90:91]
  v_cmp_gt_i32 s[84:85], -16, v23
  v_cmp_gt_i32 s[86:87], -15, v23
  v_cmp_gt_i32 s[88:89], -14, v23
  v_cmp_gt_i32 s[90:91], -13, v23
  v_cndmask_b32 v120, v120, v4, s[84:85]
  v_cndmask_b32 v121, v121, v4, s[86:87]
  v_cndmask_b32 v122, v122, v4, s[88:89]
  v_cndmask_b32 v123, v123, v4, s[90:91]
  s_branch M_ev_9_r
M_ev_9_x:
  s_xor_b32 s32, s30, 1
  s_lshl_b32 s32, s32, 13
  s_add_u32 s32, s32, 0x20000
  v_add_u32 v23, s32, v22
  ds_read_b128 v[192:195], v23 offset:0
  ds_read_b128 v[196:199], v23 offset:1024
  ds_read_b128 v[200:203], v23 offset:2048
  ds_read_b128 v[204:207], v23 offset:3072
  ds_read_b128 v[208:211], v23 offset:4096
  ds_read_b128 v[212:215], v23 offset:5120
  ds_read_b128 v[216:219], v23 offset:6144
  ds_read_b128 v[220:223], v23 offset:7168
  v_mov_b32 v112, v30
  v_mov_b32 v113, v30
  v_mov_b32 v114, v30
  v_mov_b32 v115, v30
  v_mov_b32 v116, v30
  v_mov_b32 v117, v30
  v_mov_b32 v118, v30
  v_mov_b32 v119, v30
  v_mov_b32 v120, v31
  v_mov_b32 v121, v31
  v_mov_b32 v122, v31
  v_mov_b32 v123, v31
  v_mov_b32 v124, v31
  v_mov_b32 v125, v31
  v_mov_b32 v126, v31
  v_mov_b32 v127, v31
  v_mov_b32 v18, v30
  v_mov_b32 v19, v31
  s_xor_b32 s43, s42, 1
  s_mov_b32 s93, 0
  s_waitcnt lgkmcnt(0)
  s_cmp_lt_u32 s40, 32
  s_cbranch_scc1 M_ev_9_r
  s_sub_i32 s32, s92, s43
  s_lshl_b32 s32, s32, 5
  v_subrev_u32 v23, s32, v3
  v_cmp_gt_i32 s[84:85], 0, v23
  v_cmp_gt_i32 s[86:87], 1, v23
  v_cmp_gt_i32 s[88:89], 2, v23
  v_cmp_gt_i32 s[90:91], 3, v23
  v_cndmask_b32 v112, v112, v4, s[84:85]
  v_cndmask_b32 v113, v113, v4, s[86:87]
  v_cndmask_b32 v114, v114, v4, s[88:89]
  v_cndmask_b32 v115, v115, v4, s[90:91]
  v_cndmask_b32 v124, v124, v4, s[84:85]
  v_cndmask_b32 v125, v125, v4, s[86:87]
  v_cndmask_b32 v126, v126, v4, s[88:89]
  v_cndmask_b32 v127, v127, v4, s[90:91]
  v_cmp_gt_i32 s[84:85], 16, v23
  v_cmp_gt_i32 s[86:87], 17, v23
  v_cmp_gt_i32 s[88:89], 18, v23
  v_cmp_gt_i32 s[90:91], 19, v23
  v_cndmask_b32 v116, v116, v4, s[84:85]
  v_cndmask_b32 v117, v117, v4, s[86:87]
  v_cndmask_b32 v118, v118, v4, s[88:89]
  v_cndmask_b32 v119, v119, v4, s[90:91]
  v_cmp_gt_i32 s[84:85], -16, v23
  v_cmp_gt_i32 s[86:87], -15, v23
  v_cmp_gt_i32 s[88:89], -14, v23
  v_cmp_gt_i32 s[90:91], -13, v23
  v_cndmask_b32 v120, v120, v4, s[84:85]
  v_cndmask_b32 v121, v121, v4, s[86:87]
  v_cndmask_b32 v122, v122, v4, s[88:89]
  v_cndmask_b32 v123, v123, v4, s[90:91]
  s_sub_i32 s32, s92, s42
  s_lshl_b32 s32, s32, 5
  v_subrev_u32 v23, s32, v3
  v_cmp_gt_i32 s[84:85], 0, v23
  v_cmp_gt_i32 s[86:87], 1, v23
  v_cmp_gt_i32 s[88:89], 2, v23
  v_cmp_gt_i32 s[90:91], 3, v23
  v_cndmask_b32 v96, v96, v4, s[84:85]
  v_cndmask_b32 v97, v97, v4, s[86:87]
  v_cndmask_b32 v98, v98, v4, s[88:89]
  v_cndmask_b32 v99, v99, v4, s[90:91]
  v_cndmask_b32 v108, v108, v4, s[84:85]
  v_cndmask_b32 v109, v109, v4, s[86:87]
  v_cndmask_b32 v110, v110, v4, s[88:89]
  v_cndmask_b32 v111, v111, v4, s[90:91]
  v_cmp_gt_i32 s[84:85], 16, v23
  v_cmp_gt_i32 s[86:87], 17, v23
  v_cmp_gt_i32 s[88:89], 18, v23
  v_cmp_gt_i32 s[90:91], 19, v23
  v_cndmask_b32 v100, v100, v4, s[84:85]
  v_cndmask_b32 v101, v101, v4, s[86:87]
  v_cndmask_b32 v102, v102, v4, s[88:89]
  v_cndmask_b32 v103, v103, v4, s[90:91]
  v_cmp_gt_i32 s[84:85], -16, v23
  v_cmp_gt_i32 s[86:87], -15, v23
  v_cmp_gt_i32 s[88:89], -14, v23
  v_cmp_gt_i32 s[90:91], -13, v23
  v_cndmask_b32 v104, v104, v4, s[84:85]
  v_cndmask_b32 v105, v105, v4, s[86:87]
  v_cndmask_b32 v106, v106, v4, s[88:89]
  v_cndmask_b32 v107, v107, v4, s[90:91]
  s_branch M_ev_9_r
M_sl_10:
  s_call_b64 s[48:49], M_slow1
  s_branch M_sl_10_r
M_ev_11:
  s_sub_i32 s32, s92, s43
  s_lshl_b32 s32, s32, 5
  v_subrev_u32 v23, s32, v3
  v_cmp_gt_i32 s[84:85], 0, v23
  v_cmp_gt_i32 s[86:87], 1, v23
  v_cmp_gt_i32 s[88:89], 2, v23
  v_cmp_gt_i32 s[90:91], 3, v23
  v_cndmask_b32 v112, v112, v4, s[84:85]
  v_cndmask_b32 v113, v113, v4, s[86:87]
  v_cndmask_b32 v114, v114, v4, s[88:89]
  v_cndmask_b32 v115, v115, v4, s[90:91]
  v_cndmask_b32 v124, v124, v4, s[84:85]
  v_cndmask_b32 v125, v125, v4, s[86:87]
  v_cndmask_b32 v126, v126, v4, s[88:89]
  v_cndmask_b32 v127, v127, v4, s[90:91]
  v_cmp_gt_i32 s[84:85], 16, v23
  v_cmp_gt_i32 s[86:87], 17, v23
  v_cmp_gt_i32 s[88:89], 18, v23
  v_cmp_gt_i32 s[90:91], 19, v23
  v_cndmask_b32 v116, v116, v4, s[84:85]
  v_cndmask_b32 v117, v117, v4, s[86:87]
  v_cndmask_b32 v118, v118, v4, s[88:89]
  v_cndmask_b32 v119, v119, v4, s[90:91]
  v_cmp_gt_i32 s[84:85], -16, v23
  v_cmp_gt_i32 s[86:87], -15, v23
  v_cmp_gt_i32 s[88:89], -14, v23
  v_cmp_gt_i32 s[90:91], -13, v23
  v_cndmask_b32 v120, v120, v4, s[84:85]
  v_cndmask_b32 v121, v121, v4, s[86:87]
  v_cndmask_b32 v122, v122, v4, s[88:89]
  v_cndmask_b32 v123, v123, v4, s[90:91]
  s_cmp_lt_u32 s40, 32
  s_cbranch_scc1 M_ev_11_r
  s_sub_i32 s32, s92, s42
  s_lshl_b32 s32, s32, 5
  v_subrev_u32 v23, s32, v3
  v_cmp_gt_i32 s[84:85], 0, v23
  v_cmp_gt_i32 s[86:87], 1, v23
  v_cmp_gt_i32 s[88:89], 2, v23
  v_cmp_gt_i32 s[90:91], 3, v23
  v_cndmask_b32 v96, v96, v4, s[84:85]
  v_cndmask_b32 v97, v97, v4, s[86:87]
  v_cndmask_b32 v98, v98, v4, s[88:89]
  v_cndmask_b32 v99, v99, v4, s[90:91]
  v_cndmask_b32 v108, v108, v4, s[84:85]
  v_cndmask_b32 v109, v109, v4, s[86:87]
  v_cndmask_b32 v110, v110, v4, s[88:89]
  v_cndmask_b32 v111, v111, v4, s[90:91]
  v_cmp_gt_i32 s[84:85], 16, v23
  v_cmp_gt_i32 s[86:87], 17, v23
  v_cmp_gt_i32 s[88:89], 18, v23
  v_cmp_gt_i32 s[90:91], 19, v23
  v_cndmask_b32 v100, v100, v4, s[84:85]
  v_cndmask_b32 v101, v101, v4, s[86:87]
  v_cndmask_b32 v102, v102, v4, s[88:89]
  v_cndmask_b32 v103, v103, v4, s[90:91]
  v_cmp_gt_i32 s[84:85], -16, v23
  v_cmp_gt_i32 s[86:87], -15, v23
  v_cmp_gt_i32 s[88:89], -14, v23
  v_cmp_gt_i32 s[90:91], -13, v23
  v_cndmask_b32 v104, v104, v4, s[84:85]
  v_cndmask_b32 v105, v105, v4, s[86:87]
  v_cndmask_b32 v106, v106, v4, s[88:89]
  v_cndmask_b32 v107, v107, v4, s[90:91]
  s_branch M_ev_11_r
M_sl_12:
  s_call_b64 s[48:49], M_slow0
  s_branch M_sl_12_r
M_ev_13:
  s_sub_i32 s32, s92, s43
  s_lshl_b32 s32, s32, 5
  v_subrev_u32 v23, s32, v3
  v_cmp_gt_i32 s[84:85], 0, v23
  v_cmp_gt_i32 s[86:87], 1, v23
  v_cmp_gt_i32 s[88:89], 2, v23
  v_cmp_gt_i32 s[90:91], 3, v23
  v_cndmask_b32 v112, v112, v4, s[84:85]
  v_cndmask_b32 v113, v113, v4, s[86:87]
  v_cndmask_b32 v114, v114, v4, s[88:89]
  v_cndmask_b32 v115, v115, v4, s[90:91]
  v_cndmask_b32 v124, v124, v4, s[84:85]
  v_cndmask_b32 v125, v125, v4, s[86:87]
  v_cndmask_b32 v126, v126, v4, s[88:89]
  v_cndmask_b32 v127, v127, v4, s[90:91]
  v_cmp_gt_i32 s[84:85], 16, v23
  v_cmp_gt_i32 s[86:87], 17, v23
  v_cmp_gt_i32 s[88:89], 18, v23
  v_cmp_gt_i32 s[90:91], 19, v23
  v_cndmask_b32 v116, v116, v4, s[84:85]
  v_cndmask_b32 v117, v117, v4, s[86:87]
  v_cndmask_b32 v118, v118, v4, s[88:89]
  v_cndmask_b32 v119, v119, v4, s[90:91]
  v_cmp_gt_i32 s[84:85], -16, v23
  v_cmp_gt_i32 s[86:87], -15, v23
  v_cmp_gt_i32 s[88:89], -14, v23
  v_cmp_gt_i32 s[90:91], -13, v23
  v_cndmask_b32 v120, v120, v4, s[84:85]
  v_cndmask_b32 v121, v121, v4, s[86:87]
  v_cndmask_b32 v122, v122, v4, s[88:89]
  v_cndmask_b32 v123, v123, v4, s[90:91]
  s_sub_i32 s32, s92, s42
  s_lshl_b32 s32, s32, 5
  v_subrev_u32 v23, s32, v3
  v_cmp_gt_i32 s[84:85], 0, v23
  v_cmp_gt_i32 s[86:87], 1, v23
  v_cmp_gt_i32 s[88:89], 2, v23
  v_cmp_gt_i32 s[90:91], 3, v23
  v_cndmask_b32 v96, v96, v4, s[84:85]
  v_cndmask_b32 v97, v97, v4, s[86:87]
  v_cndmask_b32 v98, v98, v4, s[88:89]
  v_cndmask_b32 v99, v99, v4, s[90:91]
  v_cndmask_b32 v108, v108, v4, s[84:85]
  v_cndmask_b32 v109, v109, v4, s[86:87]
  v_cndmask_b32 v110, v110, v4, s[88:89]
  v_cndmask_b32 v111, v111, v4, s[90:91]
  v_cmp_gt_i32 s[84:85], 16, v23
  v_cmp_gt_i32 s[86:87], 17, v23
  v_cmp_gt_i32 s[88:89], 18, v23
  v_cmp_gt_i32 s[90:91], 19, v23
  v_cndmask_b32 v100, v100, v4, s[84:85]
  v_cndmask_b32 v101, v101, v4, s[86:87]
  v_cndmask_b32 v102, v102, v4, s[88:89]
  v_cndmask_b32 v103, v103, v4, s[90:91]
  v_cmp_gt_i32 s[84:85], -16, v23
  v_cmp_gt_i32 s[86:87], -15, v23
  v_cmp_gt_i32 s[88:89], -14, v23
  v_cmp_gt_i32 s[90:91], -13, v23
  v_cndmask_b32 v104, v104, v4, s[84:85]
  v_cndmask_b32 v105, v105, v4, s[86:87]
  v_cndmask_b32 v106, v106, v4, s[88:89]
  v_cndmask_b32 v107, v107, v4, s[90:91]
  s_branch M_ev_13_r
M_sl_14:
  s_call_b64 s[48:49], M_slow1
  s_branch M_sl_14_r
M_ev_15:
  s_sub_i32 s32, s92, s43
  s_lshl_b32 s32, s32, 5
  v_subrev_u32 v23, s32, v3
  v_cmp_gt_i32 s[84:85], 0, v23
  v_cmp_gt_i32 s[86:87], 1, v23
  v_cmp_gt_i32 s[88:89], 2, v23
  v_cmp_gt_i32 s[90:91], 3, v23
  v_cndmask_b32 v112, v112, v4, s[84:85]
  v_cndmask_b32 v113, v113, v4, s[86:87]
  v_cndmask_b32 v114, v114, v4, s[88:89]
  v_cndmask_b32 v115, v115, v4, s[90:91]
  v_cndmask_b32 v124, v124, v4, s[84:85]
  v_cndmask_b32 v125, v125, v4, s[86:87]
  v_cndmask_b32 v126, v126, v4, s[88:89]
  v_cndmask_b32 v127, v127, v4, s[90:91]
  v_cmp_gt_i32 s[84:85], 16, v23
  v_cmp_gt_i32 s[86:87], 17, v23
  v_cmp_gt_i32 s[88:89], 18, v23
  v_cmp_gt_i32 s[90:91], 19, v23
  v_cndmask_b32 v116, v116, v4, s[84:85]
  v_cndmask_b32 v117, v117, v4, s[86:87]
  v_cndmask_b32 v118, v118, v4, s[88:89]
  v_cndmask_b32 v119, v119, v4, s[90:91]
  v_cmp_gt_i32 s[84:85], -16, v23
  v_cmp_gt_i32 s[86:87], -15, v23
  v_cmp_gt_i32 s[88:89], -14, v23
  v_cmp_gt_i32 s[90:91], -13, v23
  v_cndmask_b32 v120, v120, v4, s[84:85]
  v_cndmask_b32 v121, v121, v4, s[86:87]
  v_cndmask_b32 v122, v122, v4, s[88:89]
  v_cndmask_b32 v123, v123, v4, s[90:91]
  s_sub_i32 s32, s92, s42
  s_lshl_b32 s32, s32, 5
  v_subrev_u32 v23, s32, v3
  v_cmp_gt_i32 s[84:85], 0, v23
  v_cmp_gt_i32 s[86:87], 1, v23
  v_cmp_gt_i32 s[88:89], 2, v23
  v_cmp_gt_i32 s[90:91], 3, v23
  v_cndmask_b32 v96, v96, v4, s[84:85]
  v_cndmask_b32 v97, v97, v4, s[86:87]
  v_cndmask_b32 v98, v98, v4, s[88:89]
  v_cndmask_b32 v99, v99, v4, s[90:91]
  v_cndmask_b32 v108, v108, v4, s[84:85]
  v_cndmask_b32 v109, v109, v4, s[86:87]
  v_cndmask_b32 v110, v110, v4, s[88:89]
  v_cndmask_b32 v111, v111, v4, s[90:91]
  v_cmp_gt_i32 s[84:85], 16, v23
  v_cmp_gt_i32 s[86:87], 17, v23
  v_cmp_gt_i32 s[88:89], 18, v23
  v_cmp_gt_i32 s[90:91], 19, v23
  v_cndmask_b32 v100, v100, v4, s[84:85]
  v_cndmask_b32 v101, v101, v4, s[86:87]
  v_cndmask_b32 v102, v102, v4, s[88:89]
  v_cndmask_b32 v103, v103, v4, s[90:91]
  v_cmp_gt_i32 s[84:85], -16, v23
  v_cmp_gt_i32 s[86:87], -15, v23
  v_cmp_gt_i32 s[88:89], -14, v23
  v_cmp_gt_i32 s[90:91], -13, v23
  v_cndmask_b32 v104, v104, v4, s[84:85]
  v_cndmask_b32 v105, v105, v4, s[86:87]
  v_cndmask_b32 v106, v106, v4, s[88:89]
  v_cndmask_b32 v107, v107, v4, s[90:91]
  s_branch M_ev_15_r
M_poll_17:
  s_mov_b32 s52, 0x40000
M_poll_17_l:
  s_sleep 1
  v_and_b32 v23, 7, v1
  v_lshlrev_b32 v23, 10, v23
  s_andn2_b32 s32, s2, 0x38
  s_lshl_b32 s32, s32, 7
  buffer_load_dword v5, v23, s[20:23], s32 offen sc1
  s_waitcnt vmcnt(0)
  v_cmp_gt_u32 vcc, 3, v5
  s_nop 0
  s_cbranch_vccz M_poll_17_r
  s_sub_u32 s52, s52, 1
  s_cbranch_scc0 M_poll_17_l
  s_branch M_poll_17_r
M_poll_19:
  s_mov_b32 s52, 0x40000
M_poll_19_l:
  s_sleep 1
  buffer_load_dword v26, v20, s[20:23], 0 offen sc1
  s_waitcnt vmcnt(0)
  v_cmp_gt_u32 vcc, v21, v26
  s_nop 0
  s_cbranch_vccz M_poll_19_r
  s_sub_u32 s52, s52, 1
  s_cbranch_scc0 M_poll_19_l
  s_branch M_poll_19_r
M_sl_20:
  s_call_b64 s[48:49], M_slow1
  s_branch M_sl_20_r
M_p3:
  v_mfma_f32_16x16x32_bf16 v[160:163], a[16:19], a[0:3], v[160:163]
  ds_read_b128 a[52:55], v8 offset:10240
  v_mfma_f32_16x16x32_bf16 v[180:183], a[16:19], a[4:7], v[180:183]
  ds_read_b128 a[36:39], v4 offset:8192
  s_add_u32 m0, s43, s31
  v_mfma_f32_16x16x32_bf16 v[200:203], a[16:19], a[8:11], v[200:203]
  ds_read_b128 a[40:43], v5 offset:8192
  v_mfma_f32_16x16x32_bf16 v[220:223], a[16:19], a[12:15], v[220:223]
  buffer_load_dwordx4 v2, s[24:27], s40 offen offset:0 sc1 lds
  v_mfma_f32_16x16x32_bf16 v[164:167], a[20:23], a[0:3], v[164:167]
  ds_read_b128 a[44:47], v6 offset:8192
  v_mfma_f32_16x16x32_bf16 v[184:187], a[20:23], a[4:7], v[184:187]
  ds_read_b128 a[48:51], v7 offset:8192
  v_mfma_f32_16x16x32_bf16 v[204:207], a[20:23], a[8:11], v[204:207]
  v_mfma_f32_16x16x32_bf16 v[224:227], a[20:23], a[12:15], v[224:227]
  ds_read_b128 a[56:59], v8 offset:11264
  buffer_load_dwordx4 v2, s[24:27], s40 offen offset:1024 sc1 lds
  v_mfma_f32_16x16x32_bf16 v[168:171], a[24:27], a[0:3], v[168:171]
  ds_read_b128 a[60:63], v8 offset:12288
  v_mfma_f32_16x16x32_bf16 v[188:191], a[24:27], a[4:7], v[188:191]
  v_mfma_f32_16x16x32_bf16 v[208:211], a[24:27], a[8:11], v[208:211]
  ds_read_b128 a[64:67], v8 offset:13312
  v_mfma_f32_16x16x32_bf16 v[228:231], a[24:27], a[12:15], v[228:231]
  ds_read_b128 a[68:71], v8 offset:14336
  buffer_load_dwordx4 v2, s[24:27], s40 offen offset:2048 sc1 lds
  v_mfma_f32_16x16x32_bf16 v[172:175], a[28:31], a[0:3], v[172:175]
  v_mfma_f32_16x16x32_bf16 v[192:195], a[28:31], a[4:7], v[192:195]
  s_add_u32 s44, s44, 1
  s_and_b32 s44, s44, 3
  v_mfma_f32_16x16x32_bf16 v[212:215], a[28:31], a[8:11], v[212:215]
  s_mov_b32 s46, 36864
  s_cselect_b32 s46, s46, 0xfffe5000
  v_mfma_f32_16x16x32_bf16 v[232:235], a[28:31], a[12:15], v[232:235]
  buffer_load_dwordx4 v2, s[24:27], s40 offen offset:3072 sc1 lds
  v_add_u32 v8, s46, v8
  v_add_u32 v4, s46, v4
  v_mfma_f32_16x16x32_bf16 v[176:179], a[32:35], a[0:3], v[176:179]
  v_add_u32 v5, s46, v5
  v_mfma_f32_16x16x32_bf16 v[196:199], a[32:35], a[4:7], v[196:199]
  v_add_u32 v6, s46, v6
  v_mfma_f32_16x16x32_bf16 v[216:219], a[32:35], a[8:11], v[216:219]
  v_add_u32 v7, s46, v7
  v_mfma_f32_16x16x32_bf16 v[236:239], a[32:35], a[12:15], v[236:239]
  s_waitcnt vmcnt(13) lgkmcnt(0)
  s_barrier
  v_mfma_f32_16x16x32_bf16 v[160:163], a[52:55], a[36:39], v[160:163]
  ds_read_b128 a[16:19], v8 offset:0
  s_add_u32 m0, s43, s45
  v_mfma_f32_16x16x32_bf16 v[180:183], a[52:55], a[40:43], v[180:183]
  ds_read_b128 a[0:3], v4 offset:0
  buffer_load_dwordx4 v3, s[12:15], s41 offen offset:0 sc1 lds
  v_mfma_f32_16x16x32_bf16 v[200:203], a[52:55], a[44:47], v[200:203]
  ds_read_b128 a[4:7], v5 offset:0
  v_mfma_f32_16x16x32_bf16 v[220:223], a[52:55], a[48:51], v[220:223]
  v_mfma_f32_16x16x32_bf16 v[164:167], a[56:59], a[36:39], v[164:167]
  ds_read_b128 a[8:11], v6 offset:0
  v_mfma_f32_16x16x32_bf16 v[184:187], a[56:59], a[40:43], v[184:187]
  ds_read_b128 a[12:15], v7 offset:0
  buffer_load_dwordx4 v3, s[12:15], s41 offen offset:1024 sc1 lds
  v_mfma_f32_16x16x32_bf16 v[204:207], a[56:59], a[44:47], v[204:207]
  v_mfma_f32_16x16x32_bf16 v[224:227], a[56:59], a[48:51], v[224:227]
  ds_read_b128 a[20:23], v8 offset:1024
  v_mfma_f32_16x16x32_bf16 v[168:171], a[60:63], a[36:39], v[168:171]
  ds_read_b128 a[24:27], v8 offset:2048
  v_mfma_f32_16x16x32_bf16 v[188:191], a[60:63], a[40:43], v[188:191]
  buffer_load_dwordx4 v3, s[12:15], s41 offen offset:2048 sc1 lds
  v_mfma_f32_16x16x32_bf16 v[208:211], a[60:63], a[44:47], v[208:211]
  ds_read_b128 a[28:31], v8 offset:3072
  s_add_u32 s86, s86, 1
  v_mfma_f32_16x16x32_bf16 v[228:231], a[60:63], a[48:51], v[228:231]
  ds_read_b128 a[32:35], v8 offset:4096
  s_and_b32 s86, s86, 15
  v_mfma_f32_16x16x32_bf16 v[172:175], a[64:67], a[36:39], v[172:175]
  s_add_u32 s43, s43, 36864
  v_mfma_f32_16x16x32_bf16 v[192:195], a[64:67], a[40:43], v[192:195]
  buffer_load_dwordx4 v3, s[12:15], s41 offen offset:3072 sc1 lds
  s_cmp_eq_u32 s43, 147456
  v_mfma_f32_16x16x32_bf16 v[212:215], a[64:67], a[44:47], v[212:215]
  s_cselect_b32 s43, 0, s43
  v_mfma_f32_16x16x32_bf16 v[232:235], a[64:67], a[48:51], v[232:235]
  v_mfma_f32_16x16x32_bf16 v[176:179], a[68:71], a[36:39], v[176:179]
  s_add_u32 m0, m0, 0x1000
  v_mfma_f32_16x16x32_bf16 v[196:199], a[68:71], a[40:43], v[196:199]
  buffer_load_dwordx4 v3, s[12:15], s42 offen offset:0 sc1 lds
  v_mfma_f32_16x16x32_bf16 v[216:219], a[68:71], a[44:47], v[216:219]
  s_mul_i32 s40, s86, s47
  s_mul_i32 s41, s86, s92
  s_add_u32 s41, s41, s87
  s_add_u32 s42, s41, 0x1000
  v_mfma_f32_16x16x32_bf16 v[236:239], a[68:71], a[48:51], v[236:239]
  s_sub_u32 s95, s95, 1
  s_waitcnt lgkmcnt(0)
  s_cbranch_scc0 M_p3
  s_setpc_b64 s[48:49]
M_poll_23:
  s_mov_b32 s52, 0x40000
M_poll_23_l:
  s_sleep 1
  buffer_load_dword v26, v20, s[20:23], 0 offen sc1
  s_waitcnt vmcnt(0)
  v_cmp_gt_u32 vcc, v21, v26
  s_nop 0
  s_cbranch_vccz M_poll_23_r
  s_sub_u32 s52, s52, 1
  s_cbranch_scc0 M_poll_23_l
  s_branch M_poll_23_r
M_poll_25:
  s_mov_b32 s52, 0x40000
M_poll_25_l:
  s_sleep 1
  buffer_load_dword v26, v20, s[20:23], 0 offen sc1
  s_waitcnt vmcnt(0)
  v_cmp_gt_u32 vcc, v21, v26
  s_nop 0
  s_cbranch_vccz M_poll_25_r
  s_sub_u32 s52, s52, 1
  s_cbranch_scc0 M_poll_25_l
  s_branch M_poll_25_r
M_xagain:
  s_lshr_b32 s33, s35, 1
  s_xor_b32 s32, s33, 1
  s_lshl2_add_u32 s32, s33, s32
  s_mul_i32 s32, s32, 10240
  buffer_load_dwordx4 v[180:183], v3, s[16:19], s32 offen offset:0 sc1
  buffer_load_dwordx4 v[184:187], v3, s[16:19], s32 offen offset:1024 sc1
  buffer_load_dwordx2 v[188:189], v4, s[16:19], s32 offen offset:2048 sc1
  s_lshr_b32 s33, s35, 1
  s_xor_b32 s32, s33, 2
  s_lshl2_add_u32 s32, s33, s32
  s_mul_i32 s32, s32, 10240
  buffer_load_dwordx4 v[200:203], v3, s[16:19], s32 offen offset:0 sc1
  buffer_load_dwordx4 v[204:207], v3, s[16:19], s32 offen offset:1024 sc1
  buffer_load_dwordx2 v[208:209], v4, s[16:19], s32 offen offset:2048 sc1
  s_lshr_b32 s33, s35, 1
  s_xor_b32 s32, s33, 3
  s_lshl2_add_u32 s32, s33, s32
  s_mul_i32 s32, s32, 10240
  buffer_load_dwordx4 v[220:223], v3, s[16:19], s32 offen offset:0 sc1
  buffer_load_dwordx4 v[224:227], v3, s[16:19], s32 offen offset:1024 sc1
  buffer_load_dwordx2 v[228:229], v4, s[16:19], s32 offen offset:2048 sc1
  s_waitcnt vmcnt(0)
  s_sub_u32 s52, s52, 1
  s_cbranch_scc0 M_xchk
  s_branch M_xok
M_slow0:
  s_nop 15
  v_max3_f32 v234, v32, v33, v34
  v_max3_f32 v234, v234, v35, v36
  v_max3_f32 v234, v234, v37, v38
  v_max_f32 v234, v234, v39
  v_mov_b32 v235, v234
  s_nop 1
  v_permlane32_swap_b32 v234, v235
  v_max_f32 v234, v234, v235
  v_mov_b32 v235, v234
  s_nop 1
  v_permlane16_swap_b32 v234, v235
  v_max_f32 v234, v234, v235
  v_add_f32 v234, 0x42200000, v234
  v_max_f32 v234, 0, v234
  v_exp_f32 v235, -v234
  v_sub_f32 v32, v32, v234
  v_sub_f32 v64, v64, v234
  v_sub_f32 v96, v96, v234
  v_sub_f32 v33, v33, v234
  v_sub_f32 v65, v65, v234
  v_sub_f32 v97, v97, v234
  v_sub_f32 v34, v34, v234
  v_sub_f32 v66, v66, v234
  v_sub_f32 v98, v98, v234
  v_sub_f32 v35, v35, v234
  v_sub_f32 v67, v67, v234
  v_sub_f32 v99, v99, v234
  v_sub_f32 v36, v36, v234
  v_sub_f32 v68, v68, v234
  v_sub_f32 v100, v100, v234
  v_sub_f32 v37, v37, v234
  v_sub_f32 v69, v69, v234
  v_sub_f32 v101, v101, v234
  v_sub_f32 v38, v38, v234
  v_sub_f32 v70, v70, v234
  v_sub_f32 v102, v102, v234
  v_sub_f32 v39, v39, v234
  v_sub_f32 v71, v71, v234
  v_sub_f32 v103, v103, v234
  v_sub_f32 v16, v16, v234
  v_mul_f32 v8, v8, v235
  v_accvgpr_read_b32 v224, a0
  v_accvgpr_read_b32 v225, a1
  v_accvgpr_read_b32 v226, a2
  v_accvgpr_read_b32 v227, a3
  v_accvgpr_read_b32 v228, a4
  v_accvgpr_read_b32 v229, a5
  v_accvgpr_read_b32 v230, a6
  v_accvgpr_read_b32 v231, a7
  v_mul_f32 v224, v224, v235
  v_mul_f32 v225, v225, v235
  v_mul_f32 v226, v226, v235
  v_mul_f32 v227, v227, v235
  v_mul_f32 v228, v228, v235
  v_mul_f32 v229, v229, v235
  v_mul_f32 v230, v230, v235
  v_mul_f32 v231, v231, v235
  v_accvgpr_write_b32 a0, v224
  v_accvgpr_write_b32 a1, v225
  v_accvgpr_write_b32 a2, v226
  v_accvgpr_write_b32 a3, v227
  v_accvgpr_write_b32 a4, v228
  v_accvgpr_write_b32 a5, v229
  v_accvgpr_write_b32 a6, v230
  v_accvgpr_write_b32 a7, v231
  v_accvgpr_read_b32 v224, a8
  v_accvgpr_read_b32 v225, a9
  v_accvgpr_read_b32 v226, a10
  v_accvgpr_read_b32 v227, a11
  v_accvgpr_read_b32 v228, a12
  v_accvgpr_read_b32 v229, a13
  v_accvgpr_read_b32 v230, a14
  v_accvgpr_read_b32 v231, a15
  v_mul_f32 v224, v224, v235
  v_mul_f32 v225, v225, v235
  v_mul_f32 v226, v226, v235
  v_mul_f32 v227, v227, v235
  v_mul_f32 v228, v228, v235
  v_mul_f32 v229, v229, v235
  v_mul_f32 v230, v230, v235
  v_mul_f32 v231, v231, v235
  v_accvgpr_write_b32 a8, v224
  v_accvgpr_write_b32 a9, v225
  v_accvgpr_write_b32 a10, v226
  v_accvgpr_write_b32 a11, v227
  v_accvgpr_write_b32 a12, v228
  v_accvgpr_write_b32 a13, v229
  v_accvgpr_write_b32 a14, v230
  v_accvgpr_write_b32 a15, v231
  v_accvgpr_read_b32 v224, a16
  v_accvgpr_read_b32 v225, a17
  v_accvgpr_read_b32 v226, a18
  v_accvgpr_read_b32 v227, a19
  v_accvgpr_read_b32 v228, a20
  v_accvgpr_read_b32 v229, a21
  v_accvgpr_read_b32 v230, a22
  v_accvgpr_read_b32 v231, a23
  v_mul_f32 v224, v224, v235
  v_mul_f32 v225, v225, v235
  v_mul_f32 v226, v226, v235
  v_mul_f32 v227, v227, v235
  v_mul_f32 v228, v228, v235
  v_mul_f32 v229, v229, v235
  v_mul_f32 v230, v230, v235
  v_mul_f32 v231, v231, v235
  v_accvgpr_write_b32 a16, v224
  v_accvgpr_write_b32 a17, v225
  v_accvgpr_write_b32 a18, v226
  v_accvgpr_write_b32 a19, v227
  v_accvgpr_write_b32 a20, v228
  v_accvgpr_write_b32 a21, v229
  v_accvgpr_write_b32 a22, v230
  v_accvgpr_write_b32 a23, v231
  v_accvgpr_read_b32 v224, a24
  v_accvgpr_read_b32 v225, a25
  v_accvgpr_read_b32 v226, a26
  v_accvgpr_read_b32 v227, a27
  v_accvgpr_read_b32 v228, a28
  v_accvgpr_read_b32 v229, a29
  v_accvgpr_read_b32 v230, a30
  v_accvgpr_read_b32 v231, a31
  v_mul_f32 v224, v224, v235
  v_mul_f32 v225, v225, v235
  v_mul_f32 v226, v226, v235
  v_mul_f32 v227, v227, v235
  v_mul_f32 v228, v228, v235
  v_mul_f32 v229, v229, v235
  v_mul_f32 v230, v230, v235
  v_mul_f32 v231, v231, v235
  v_accvgpr_write_b32 a24, v224
  v_accvgpr_write_b32 a25, v225
  v_accvgpr_write_b32 a26, v226
  v_accvgpr_write_b32 a27, v227
  v_accvgpr_write_b32 a28, v228
  v_accvgpr_write_b32 a29, v229
  v_accvgpr_write_b32 a30, v230
  v_accvgpr_write_b32 a31, v231
  v_max3_f32 v234, v40, v41, v42
  v_max3_f32 v234, v234, v43, v44
  v_max3_f32 v234, v234, v45, v46
  v_max_f32 v234, v234, v47
  v_mov_b32 v235, v234
  s_nop 1
  v_permlane32_swap_b32 v234, v235
  v_max_f32 v234, v234, v235
  v_mov_b32 v235, v234
  s_nop 1
  v_permlane16_swap_b32 v234, v235
  v_max_f32 v234, v234, v235
  v_add_f32 v234, 0x42200000, v234
  v_max_f32 v234, 0, v234
  v_exp_f32 v235, -v234
  v_sub_f32 v40, v40, v234
  v_sub_f32 v72, v72, v234
  v_sub_f32 v104, v104, v234
  v_sub_f32 v41, v41, v234
  v_sub_f32 v73, v73, v234
  v_sub_f32 v105, v105, v234
  v_sub_f32 v42, v42, v234
  v_sub_f32 v74, v74, v234
  v_sub_f32 v106, v106, v234
  v_sub_f32 v43, v43, v234
  v_sub_f32 v75, v75, v234
  v_sub_f32 v107, v107, v234
  v_sub_f32 v44, v44, v234
  v_sub_f32 v76, v76, v234
  v_sub_f32 v108, v108, v234
  v_sub_f32 v45, v45, v234
  v_sub_f32 v77, v77, v234
  v_sub_f32 v109, v109, v234
  v_sub_f32 v46, v46, v234
  v_sub_f32 v78, v78, v234
  v_sub_f32 v110, v110, v234
  v_sub_f32 v47, v47, v234
  v_sub_f32 v79, v79, v234
  v_sub_f32 v111, v111, v234
  v_sub_f32 v17, v17, v234
  v_mul_f32 v9, v9, v235
  v_accvgpr_read_b32 v224, a32
  v_accvgpr_read_b32 v225, a33
  v_accvgpr_read_b32 v226, a34
  v_accvgpr_read_b32 v227, a35
  v_accvgpr_read_b32 v228, a36
  v_accvgpr_read_b32 v229, a37
  v_accvgpr_read_b32 v230, a38
  v_accvgpr_read_b32 v231, a39
  v_mul_f32 v224, v224, v235
  v_mul_f32 v225, v225, v235
  v_mul_f32 v226, v226, v235
  v_mul_f32 v227, v227, v235
  v_mul_f32 v228, v228, v235
  v_mul_f32 v229, v229, v235
  v_mul_f32 v230, v230, v235
  v_mul_f32 v231, v231, v235
  v_accvgpr_write_b32 a32, v224
  v_accvgpr_write_b32 a33, v225
  v_accvgpr_write_b32 a34, v226
  v_accvgpr_write_b32 a35, v227
  v_accvgpr_write_b32 a36, v228
  v_accvgpr_write_b32 a37, v229
  v_accvgpr_write_b32 a38, v230
  v_accvgpr_write_b32 a39, v231
  v_accvgpr_read_b32 v224, a40
  v_accvgpr_read_b32 v225, a41
  v_accvgpr_read_b32 v226, a42
  v_accvgpr_read_b32 v227, a43
  v_accvgpr_read_b32 v228, a44
  v_accvgpr_read_b32 v229, a45
  v_accvgpr_read_b32 v230, a46
  v_accvgpr_read_b32 v231, a47
  v_mul_f32 v224, v224, v235
  v_mul_f32 v225, v225, v235
  v_mul_f32 v226, v226, v235
  v_mul_f32 v227, v227, v235
  v_mul_f32 v228, v228, v235
  v_mul_f32 v229, v229, v235
  v_mul_f32 v230, v230, v235
  v_mul_f32 v231, v231, v235
  v_accvgpr_write_b32 a40, v224
  v_accvgpr_write_b32 a41, v225
  v_accvgpr_write_b32 a42, v226
  v_accvgpr_write_b32 a43, v227
  v_accvgpr_write_b32 a44, v228
  v_accvgpr_write_b32 a45, v229
  v_accvgpr_write_b32 a46, v230
  v_accvgpr_write_b32 a47, v231
  v_accvgpr_read_b32 v224, a48
  v_accvgpr_read_b32 v225, a49
  v_accvgpr_read_b32 v226, a50
  v_accvgpr_read_b32 v227, a51
  v_accvgpr_read_b32 v228, a52
  v_accvgpr_read_b32 v229, a53
  v_accvgpr_read_b32 v230, a54
  v_accvgpr_read_b32 v231, a55
  v_mul_f32 v224, v224, v235
  v_mul_f32 v225, v225, v235
  v_mul_f32 v226, v226, v235
  v_mul_f32 v227, v227, v235
  v_mul_f32 v228, v228, v235
  v_mul_f32 v229, v229, v235
  v_mul_f32 v230, v230, v235
  v_mul_f32 v231, v231, v235
  v_accvgpr_write_b32 a48, v224
  v_accvgpr_write_b32 a49, v225
  v_accvgpr_write_b32 a50, v226
  v_accvgpr_write_b32 a51, v227
  v_accvgpr_write_b32 a52, v228
  v_accvgpr_write_b32 a53, v229
  v_accvgpr_write_b32 a54, v230
  v_accvgpr_write_b32 a55, v231
  v_accvgpr_read_b32 v224, a56
  v_accvgpr_read_b32 v225, a57
  v_accvgpr_read_b32 v226, a58
  v_accvgpr_read_b32 v227, a59
  v_accvgpr_read_b32 v228, a60
  v_accvgpr_read_b32 v229, a61
  v_accvgpr_read_b32 v230, a62
  v_accvgpr_read_b32 v231, a63
  v_mul_f32 v224, v224, v235
  v_mul_f32 v225, v225, v235
  v_mul_f32 v226, v226, v235
  v_mul_f32 v227, v227, v235
  v_mul_f32 v228, v228, v235
  v_mul_f32 v229, v229, v235
  v_mul_f32 v230, v230, v235
  v_mul_f32 v231, v231, v235
  v_accvgpr_write_b32 a56, v224
  v_accvgpr_write_b32 a57, v225
  v_accvgpr_write_b32 a58, v226
  v_accvgpr_write_b32 a59, v227
  v_accvgpr_write_b32 a60, v228
  v_accvgpr_write_b32 a61, v229
  v_accvgpr_write_b32 a62, v230
  v_accvgpr_write_b32 a63, v231
  v_max3_f32 v234, v48, v49, v50
  v_max3_f32 v234, v234, v51, v52
  v_max3_f32 v234, v234, v53, v54
  v_max_f32 v234, v234, v55
  v_mov_b32 v235, v234
  s_nop 1
  v_permlane32_swap_b32 v234, v235
  v_max_f32 v234, v234, v235
  v_mov_b32 v235, v234
  s_nop 1
  v_permlane16_swap_b32 v234, v235
  v_max_f32 v234, v234, v235
  v_add_f32 v234, 0x42200000, v234
  v_max_f32 v234, 0, v234
  v_exp_f32 v235, -v234
  v_mul_f32 v236, s93, v234
  v_sub_f32 v48, v48, v234
  v_sub_f32 v80, v80, v236
  v_sub_f32 v112, v112, v236
  v_sub_f32 v49, v49, v234
  v_sub_f32 v81, v81, v236
  v_sub_f32 v113, v113, v236
  v_sub_f32 v50, v50, v234
  v_sub_f32 v82, v82, v236
  v_sub_f32 v114, v114, v236
  v_sub_f32 v51, v51, v234
  v_sub_f32 v83, v83, v236
  v_sub_f32 v115, v115, v236
  v_sub_f32 v52, v52, v234
  v_sub_f32 v84, v84, v236
  v_sub_f32 v116, v116, v236
  v_sub_f32 v53, v53, v234
  v_sub_f32 v85, v85, v236
  v_sub_f32 v117, v117, v236
  v_sub_f32 v54, v54, v234
  v_sub_f32 v86, v86, v236
  v_sub_f32 v118, v118, v236
  v_sub_f32 v55, v55, v234
  v_sub_f32 v87, v87, v236
  v_sub_f32 v119, v119, v236
  v_sub_f32 v18, v18, v236
  v_mul_f32 v10, v10, v235
  v_accvgpr_read_b32 v224, a64
  v_accvgpr_read_b32 v225, a65
  v_accvgpr_read_b32 v226, a66
  v_accvgpr_read_b32 v227, a67
  v_accvgpr_read_b32 v228, a68
  v_accvgpr_read_b32 v229, a69
  v_accvgpr_read_b32 v230, a70
  v_accvgpr_read_b32 v231, a71
  v_mul_f32 v224, v224, v235
  v_mul_f32 v225, v225, v235
  v_mul_f32 v226, v226, v235
  v_mul_f32 v227, v227, v235
  v_mul_f32 v228, v228, v235
  v_mul_f32 v229, v229, v235
  v_mul_f32 v230, v230, v235
  v_mul_f32 v231, v231, v235
  v_accvgpr_write_b32 a64, v224
  v_accvgpr_write_b32 a65, v225
  v_accvgpr_write_b32 a66, v226
  v_accvgpr_write_b32 a67, v227
  v_accvgpr_write_b32 a68, v228
  v_accvgpr_write_b32 a69, v229
  v_accvgpr_write_b32 a70, v230
  v_accvgpr_write_b32 a71, v231
  v_accvgpr_read_b32 v224, a72
  v_accvgpr_read_b32 v225, a73
  v_accvgpr_read_b32 v226, a74
  v_accvgpr_read_b32 v227, a75
  v_accvgpr_read_b32 v228, a76
  v_accvgpr_read_b32 v229, a77
  v_accvgpr_read_b32 v230, a78
  v_accvgpr_read_b32 v231, a79
  v_mul_f32 v224, v224, v235
  v_mul_f32 v225, v225, v235
  v_mul_f32 v226, v226, v235
  v_mul_f32 v227, v227, v235
  v_mul_f32 v228, v228, v235
  v_mul_f32 v229, v229, v235
  v_mul_f32 v230, v230, v235
  v_mul_f32 v231, v231, v235
  v_accvgpr_write_b32 a72, v224
  v_accvgpr_write_b32 a73, v225
  v_accvgpr_write_b32 a74, v226
  v_accvgpr_write_b32 a75, v227
  v_accvgpr_write_b32 a76, v228
  v_accvgpr_write_b32 a77, v229
  v_accvgpr_write_b32 a78, v230
  v_accvgpr_write_b32 a79, v231
  v_accvgpr_read_b32 v224, a80
  v_accvgpr_read_b32 v225, a81
  v_accvgpr_read_b32 v226, a82
  v_accvgpr_read_b32 v227, a83
  v_accvgpr_read_b32 v228, a84
  v_accvgpr_read_b32 v229, a85
  v_accvgpr_read_b32 v230, a86
  v_accvgpr_read_b32 v231, a87
  v_mul_f32 v224, v224, v235
  v_mul_f32 v225, v225, v235
  v_mul_f32 v226, v226, v235
  v_mul_f32 v227, v227, v235
  v_mul_f32 v228, v228, v235
  v_mul_f32 v229, v229, v235
  v_mul_f32 v230, v230, v235
  v_mul_f32 v231, v231, v235
  v_accvgpr_write_b32 a80, v224
  v_accvgpr_write_b32 a81, v225
  v_accvgpr_write_b32 a82, v226
  v_accvgpr_write_b32 a83, v227
  v_accvgpr_write_b32 a84, v228
  v_accvgpr_write_b32 a85, v229
  v_accvgpr_write_b32 a86, v230
  v_accvgpr_write_b32 a87, v231
  v_accvgpr_read_b32 v224, a88
  v_accvgpr_read_b32 v225, a89
  v_accvgpr_read_b32 v226, a90
  v_accvgpr_read_b32 v227, a91
  v_accvgpr_read_b32 v228, a92
  v_accvgpr_read_b32 v229, a93
  v_accvgpr_read_b32 v230, a94
  v_accvgpr_read_b32 v231, a95
  v_mul_f32 v224, v224, v235
  v_mul_f32 v225, v225, v235
  v_mul_f32 v226, v226, v235
  v_mul_f32 v227, v227, v235
  v_mul_f32 v228, v228, v235
  v_mul_f32 v229, v229, v235
  v_mul_f32 v230, v230, v235
  v_mul_f32 v231, v231, v235
  v_accvgpr_write_b32 a88, v224
  v_accvgpr_write_b32 a89, v225
  v_accvgpr_write_b32 a90, v226
  v_accvgpr_write_b32 a91, v227
  v_accvgpr_write_b32 a92, v228
  v_accvgpr_write_b32 a93, v229
  v_accvgpr_write_b32 a94, v230
  v_accvgpr_write_b32 a95, v231
  v_max3_f32 v234, v56, v57, v58
  v_max3_f32 v234, v234, v59, v60
  v_max3_f32 v234, v234, v61, v62
  v_max_f32 v234, v234, v63
  v_mov_b32 v235, v234
  s_nop 1
  v_permlane32_swap_b32 v234, v235
  v_max_f32 v234, v234, v235
  v_mov_b32 v235, v234
  s_nop 1
  v_permlane16_swap_b32 v234, v235
  v_max_f32 v234, v234, v235
  v_add_f32 v234, 0x42200000, v234
  v_max_f32 v234, 0, v234
  v_exp_f32 v235, -v234
  v_mul_f32 v236, s93, v234
  v_sub_f32 v56, v56, v234
  v_sub_f32 v88, v88, v236
  v_sub_f32 v120, v120, v236
  v_sub_f32 v57, v57, v234
  v_sub_f32 v89, v89, v236
  v_sub_f32 v121, v121, v236
  v_sub_f32 v58, v58, v234
  v_sub_f32 v90, v90, v236
  v_sub_f32 v122, v122, v236
  v_sub_f32 v59, v59, v234
  v_sub_f32 v91, v91, v236
  v_sub_f32 v123, v123, v236
  v_sub_f32 v60, v60, v234
  v_sub_f32 v92, v92, v236
  v_sub_f32 v124, v124, v236
  v_sub_f32 v61, v61, v234
  v_sub_f32 v93, v93, v236
  v_sub_f32 v125, v125, v236
  v_sub_f32 v62, v62, v234
  v_sub_f32 v94, v94, v236
  v_sub_f32 v126, v126, v236
  v_sub_f32 v63, v63, v234
  v_sub_f32 v95, v95, v236
  v_sub_f32 v127, v127, v236
  v_sub_f32 v19, v19, v236
  v_mul_f32 v11, v11, v235
  v_accvgpr_read_b32 v224, a96
  v_accvgpr_read_b32 v225, a97
  v_accvgpr_read_b32 v226, a98
  v_accvgpr_read_b32 v227, a99
  v_accvgpr_read_b32 v228, a100
  v_accvgpr_read_b32 v229, a101
  v_accvgpr_read_b32 v230, a102
  v_accvgpr_read_b32 v231, a103
  v_mul_f32 v224, v224, v235
  v_mul_f32 v225, v225, v235
  v_mul_f32 v226, v226, v235
  v_mul_f32 v227, v227, v235
  v_mul_f32 v228, v228, v235
  v_mul_f32 v229, v229, v235
  v_mul_f32 v230, v230, v235
  v_mul_f32 v231, v231, v235
  v_accvgpr_write_b32 a96, v224
  v_accvgpr_write_b32 a97, v225
  v_accvgpr_write_b32 a98, v226
  v_accvgpr_write_b32 a99, v227
  v_accvgpr_write_b32 a100, v228
  v_accvgpr_write_b32 a101, v229
  v_accvgpr_write_b32 a102, v230
  v_accvgpr_write_b32 a103, v231
  v_accvgpr_read_b32 v224, a104
  v_accvgpr_read_b32 v225, a105
  v_accvgpr_read_b32 v226, a106
  v_accvgpr_read_b32 v227, a107
  v_accvgpr_read_b32 v228, a108
  v_accvgpr_read_b32 v229, a109
  v_accvgpr_read_b32 v230, a110
  v_accvgpr_read_b32 v231, a111
  v_mul_f32 v224, v224, v235
  v_mul_f32 v225, v225, v235
  v_mul_f32 v226, v226, v235
  v_mul_f32 v227, v227, v235
  v_mul_f32 v228, v228, v235
  v_mul_f32 v229, v229, v235
  v_mul_f32 v230, v230, v235
  v_mul_f32 v231, v231, v235
  v_accvgpr_write_b32 a104, v224
  v_accvgpr_write_b32 a105, v225
  v_accvgpr_write_b32 a106, v226
  v_accvgpr_write_b32 a107, v227
  v_accvgpr_write_b32 a108, v228
  v_accvgpr_write_b32 a109, v229
  v_accvgpr_write_b32 a110, v230
  v_accvgpr_write_b32 a111, v231
  v_accvgpr_read_b32 v224, a112
  v_accvgpr_read_b32 v225, a113
  v_accvgpr_read_b32 v226, a114
  v_accvgpr_read_b32 v227, a115
  v_accvgpr_read_b32 v228, a116
  v_accvgpr_read_b32 v229, a117
  v_accvgpr_read_b32 v230, a118
  v_accvgpr_read_b32 v231, a119
  v_mul_f32 v224, v224, v235
  v_mul_f32 v225, v225, v235
  v_mul_f32 v226, v226, v235
  v_mul_f32 v227, v227, v235
  v_mul_f32 v228, v228, v235
  v_mul_f32 v229, v229, v235
  v_mul_f32 v230, v230, v235
  v_mul_f32 v231, v231, v235
  v_accvgpr_write_b32 a112, v224
  v_accvgpr_write_b32 a113, v225
  v_accvgpr_write_b32 a114, v226
  v_accvgpr_write_b32 a115, v227
  v_accvgpr_write_b32 a116, v228
  v_accvgpr_write_b32 a117, v229
  v_accvgpr_write_b32 a118, v230
  v_accvgpr_write_b32 a119, v231
  v_accvgpr_read_b32 v224, a120
  v_accvgpr_read_b32 v225, a121
  v_accvgpr_read_b32 v226, a122
  v_accvgpr_read_b32 v227, a123
  v_accvgpr_read_b32 v228, a124
  v_accvgpr_read_b32 v229, a125
  v_accvgpr_read_b32 v230, a126
  v_accvgpr_read_b32 v231, a127
  v_mul_f32 v224, v224, v235
  v_mul_f32 v225, v225, v235
  v_mul_f32 v226, v226, v235
  v_mul_f32 v227, v227, v235
  v_mul_f32 v228, v228, v235
  v_mul_f32 v229, v229, v235
  v_mul_f32 v230, v230, v235
  v_mul_f32 v231, v231, v235
  v_accvgpr_write_b32 a120, v224
  v_accvgpr_write_b32 a121, v225
  v_accvgpr_write_b32 a122, v226
  v_accvgpr_write_b32 a123, v227
  v_accvgpr_write_b32 a124, v228
  v_accvgpr_write_b32 a125, v229
  v_accvgpr_write_b32 a126, v230
  v_accvgpr_write_b32 a127, v231
  v_exp_f32 v224, v32
  v_exp_f32 v225, v33
  v_exp_f32 v226, v40
  v_cvt_pk_bf16_f32 v128, v224, v225
  v_exp_f32 v227, v41
  v_exp_f32 v228, v48
  v_cvt_pk_bf16_f32 v132, v226, v227
  v_exp_f32 v229, v49
  v_exp_f32 v230, v56
  v_cvt_pk_bf16_f32 v136, v228, v229
  v_exp_f32 v231, v57
  v_exp_f32 v224, v34
  v_cvt_pk_bf16_f32 v140, v230, v231
  v_exp_f32 v225, v35
  v_exp_f32 v226, v42
  v_cvt_pk_bf16_f32 v129, v224, v225
  v_exp_f32 v227, v43
  v_exp_f32 v228, v50
  v_cvt_pk_bf16_f32 v133, v226, v227
  v_exp_f32 v229, v51
  v_exp_f32 v230, v58
  v_cvt_pk_bf16_f32 v137, v228, v229
  v_exp_f32 v231, v59
  v_exp_f32 v224, v36
  v_cvt_pk_bf16_f32 v141, v230, v231
  v_exp_f32 v225, v37
  v_exp_f32 v226, v44
  v_cvt_pk_bf16_f32 v130, v224, v225
  v_exp_f32 v227, v45
  v_exp_f32 v228, v52
  v_cvt_pk_bf16_f32 v134, v226, v227
  v_exp_f32 v229, v53
  v_exp_f32 v230, v60
  v_cvt_pk_bf16_f32 v138, v228, v229
  v_exp_f32 v231, v61
  v_exp_f32 v224, v38
  v_cvt_pk_bf16_f32 v142, v230, v231
  v_exp_f32 v225, v39
  v_exp_f32 v226, v46
  v_cvt_pk_bf16_f32 v131, v224, v225
  v_exp_f32 v227, v47
  v_exp_f32 v228, v54
  v_cvt_pk_bf16_f32 v135, v226, v227
  v_exp_f32 v229, v55
  v_exp_f32 v230, v62
  v_cvt_pk_bf16_f32 v139, v228, v229
  v_exp_f32 v231, v63
  s_nop 0
  v_cvt_pk_bf16_f32 v143, v230, v231
  v_mfma_f32_16x16x32_bf16 v[144:147], v[12:15], v[128:131], 0
  v_mfma_f32_16x16x32_bf16 v[148:151], v[12:15], v[132:135], 0
  v_mfma_f32_16x16x32_bf16 v[152:155], v[12:15], v[136:139], 0
  v_mfma_f32_16x16x32_bf16 v[156:159], v[12:15], v[140:143], 0
  v_exp_f32 v224, v64
  v_exp_f32 v225, v65
  v_exp_f32 v226, v72
  v_exp_f32 v227, v73
  s_nop 3
  s_setpc_b64 s[48:49]
M_slow1:
  s_nop 15
  v_max3_f32 v234, v64, v65, v66
  v_max3_f32 v234, v234, v67, v68
  v_max3_f32 v234, v234, v69, v70
  v_max_f32 v234, v234, v71
  v_mov_b32 v235, v234
  s_nop 1
  v_permlane32_swap_b32 v234, v235
  v_max_f32 v234, v234, v235
  v_mov_b32 v235, v234
  s_nop 1
  v_permlane16_swap_b32 v234, v235
  v_max_f32 v234, v234, v235
  v_add_f32 v234, 0x42200000, v234
  v_max_f32 v234, 0, v234
  v_exp_f32 v235, -v234
  v_sub_f32 v64, v64, v234
  v_sub_f32 v32, v32, v234
  v_sub_f32 v96, v96, v234
  v_sub_f32 v65, v65, v234
  v_sub_f32 v33, v33, v234
  v_sub_f32 v97, v97, v234
  v_sub_f32 v66, v66, v234
  v_sub_f32 v34, v34, v234
  v_sub_f32 v98, v98, v234
  v_sub_f32 v67, v67, v234
  v_sub_f32 v35, v35, v234
  v_sub_f32 v99, v99, v234
  v_sub_f32 v68, v68, v234
  v_sub_f32 v36, v36, v234
  v_sub_f32 v100, v100, v234
  v_sub_f32 v69, v69, v234
  v_sub_f32 v37, v37, v234
  v_sub_f32 v101, v101, v234
  v_sub_f32 v70, v70, v234
  v_sub_f32 v38, v38, v234
  v_sub_f32 v102, v102, v234
  v_sub_f32 v71, v71, v234
  v_sub_f32 v39, v39, v234
  v_sub_f32 v103, v103, v234
  v_sub_f32 v16, v16, v234
  v_mul_f32 v8, v8, v235
  v_accvgpr_read_b32 v224, a0
  v_accvgpr_read_b32 v225, a1
  v_accvgpr_read_b32 v226, a2
  v_accvgpr_read_b32 v227, a3
  v_accvgpr_read_b32 v228, a4
  v_accvgpr_read_b32 v229, a5
  v_accvgpr_read_b32 v230, a6
  v_accvgpr_read_b32 v231, a7
  v_mul_f32 v224, v224, v235
  v_mul_f32 v225, v225, v235
  v_mul_f32 v226, v226, v235
  v_mul_f32 v227, v227, v235
  v_mul_f32 v228, v228, v235
  v_mul_f32 v229, v229, v235
  v_mul_f32 v230, v230, v235
  v_mul_f32 v231, v231, v235
  v_accvgpr_write_b32 a0, v224
  v_accvgpr_write_b32 a1, v225
  v_accvgpr_write_b32 a2, v226
  v_accvgpr_write_b32 a3, v227
  v_accvgpr_write_b32 a4, v228
  v_accvgpr_write_b32 a5, v229
  v_accvgpr_write_b32 a6, v230
  v_accvgpr_write_b32 a7, v231
  v_accvgpr_read_b32 v224, a8
  v_accvgpr_read_b32 v225, a9
  v_accvgpr_read_b32 v226, a10
  v_accvgpr_read_b32 v227, a11
  v_accvgpr_read_b32 v228, a12
  v_accvgpr_read_b32 v229, a13
  v_accvgpr_read_b32 v230, a14
  v_accvgpr_read_b32 v231, a15
  v_mul_f32 v224, v224, v235
  v_mul_f32 v225, v225, v235
  v_mul_f32 v226, v226, v235
  v_mul_f32 v227, v227, v235
  v_mul_f32 v228, v228, v235
  v_mul_f32 v229, v229, v235
  v_mul_f32 v230, v230, v235
  v_mul_f32 v231, v231, v235
  v_accvgpr_write_b32 a8, v224
  v_accvgpr_write_b32 a9, v225
  v_accvgpr_write_b32 a10, v226
  v_accvgpr_write_b32 a11, v227
  v_accvgpr_write_b32 a12, v228
  v_accvgpr_write_b32 a13, v229
  v_accvgpr_write_b32 a14, v230
  v_accvgpr_write_b32 a15, v231
  v_accvgpr_read_b32 v224, a16
  v_accvgpr_read_b32 v225, a17
  v_accvgpr_read_b32 v226, a18
  v_accvgpr_read_b32 v227, a19
  v_accvgpr_read_b32 v228, a20
  v_accvgpr_read_b32 v229, a21
  v_accvgpr_read_b32 v230, a22
  v_accvgpr_read_b32 v231, a23
  v_mul_f32 v224, v224, v235
  v_mul_f32 v225, v225, v235
  v_mul_f32 v226, v226, v235
  v_mul_f32 v227, v227, v235
  v_mul_f32 v228, v228, v235
  v_mul_f32 v229, v229, v235
  v_mul_f32 v230, v230, v235
  v_mul_f32 v231, v231, v235
  v_accvgpr_write_b32 a16, v224
  v_accvgpr_write_b32 a17, v225
  v_accvgpr_write_b32 a18, v226
  v_accvgpr_write_b32 a19, v227
  v_accvgpr_write_b32 a20, v228
  v_accvgpr_write_b32 a21, v229
  v_accvgpr_write_b32 a22, v230
  v_accvgpr_write_b32 a23, v231
  v_accvgpr_read_b32 v224, a24
  v_accvgpr_read_b32 v225, a25
  v_accvgpr_read_b32 v226, a26
  v_accvgpr_read_b32 v227, a27
  v_accvgpr_read_b32 v228, a28
  v_accvgpr_read_b32 v229, a29
  v_accvgpr_read_b32 v230, a30
  v_accvgpr_read_b32 v231, a31
  v_mul_f32 v224, v224, v235
  v_mul_f32 v225, v225, v235
  v_mul_f32 v226, v226, v235
  v_mul_f32 v227, v227, v235
  v_mul_f32 v228, v228, v235
  v_mul_f32 v229, v229, v235
  v_mul_f32 v230, v230, v235
  v_mul_f32 v231, v231, v235
  v_accvgpr_write_b32 a24, v224
  v_accvgpr_write_b32 a25, v225
  v_accvgpr_write_b32 a26, v226
  v_accvgpr_write_b32 a27, v227
  v_accvgpr_write_b32 a28, v228
  v_accvgpr_write_b32 a29, v229
  v_accvgpr_write_b32 a30, v230
  v_accvgpr_write_b32 a31, v231
  v_max3_f32 v234, v72, v73, v74
  v_max3_f32 v234, v234, v75, v76
  v_max3_f32 v234, v234, v77, v78
  v_max_f32 v234, v234, v79
  v_mov_b32 v235, v234
  s_nop 1
  v_permlane32_swap_b32 v234, v235
  v_max_f32 v234, v234, v235
  v_mov_b32 v235, v234
  s_nop 1
  v_permlane16_swap_b32 v234, v235
  v_max_f32 v234, v234, v235
  v_add_f32 v234, 0x42200000, v234
  v_max_f32 v234, 0, v234
  v_exp_f32 v235, -v234
  v_sub_f32 v72, v72, v234
  v_sub_f32 v40, v40, v234
  v_sub_f32 v104, v104, v234
  v_sub_f32 v73, v73, v234
  v_sub_f32 v41, v41, v234
  v_sub_f32 v105, v105, v234
  v_sub_f32 v74, v74, v234
  v_sub_f32 v42, v42, v234
  v_sub_f32 v106, v106, v234
  v_sub_f32 v75, v75, v234
  v_sub_f32 v43, v43, v234
  v_sub_f32 v107, v107, v234
  v_sub_f32 v76, v76, v234
  v_sub_f32 v44, v44, v234
  v_sub_f32 v108, v108, v234
  v_sub_f32 v77, v77, v234
  v_sub_f32 v45, v45, v234
  v_sub_f32 v109, v109, v234
  v_sub_f32 v78, v78, v234
  v_sub_f32 v46, v46, v234
  v_sub_f32 v110, v110, v234
  v_sub_f32 v79, v79, v234
  v_sub_f32 v47, v47, v234
  v_sub_f32 v111, v111, v234
  v_sub_f32 v17, v17, v234
  v_mul_f32 v9, v9, v235
  v_accvgpr_read_b32 v224, a32
  v_accvgpr_read_b32 v225, a33
  v_accvgpr_read_b32 v226, a34
  v_accvgpr_read_b32 v227, a35
  v_accvgpr_read_b32 v228, a36
  v_accvgpr_read_b32 v229, a37
  v_accvgpr_read_b32 v230, a38
  v_accvgpr_read_b32 v231, a39
  v_mul_f32 v224, v224, v235
  v_mul_f32 v225, v225, v235
  v_mul_f32 v226, v226, v235
  v_mul_f32 v227, v227, v235
  v_mul_f32 v228, v228, v235
  v_mul_f32 v229, v229, v235
  v_mul_f32 v230, v230, v235
  v_mul_f32 v231, v231, v235
  v_accvgpr_write_b32 a32, v224
  v_accvgpr_write_b32 a33, v225
  v_accvgpr_write_b32 a34, v226
  v_accvgpr_write_b32 a35, v227
  v_accvgpr_write_b32 a36, v228
  v_accvgpr_write_b32 a37, v229
  v_accvgpr_write_b32 a38, v230
  v_accvgpr_write_b32 a39, v231
  v_accvgpr_read_b32 v224, a40
  v_accvgpr_read_b32 v225, a41
  v_accvgpr_read_b32 v226, a42
  v_accvgpr_read_b32 v227, a43
  v_accvgpr_read_b32 v228, a44
  v_accvgpr_read_b32 v229, a45
  v_accvgpr_read_b32 v230, a46
  v_accvgpr_read_b32 v231, a47
  v_mul_f32 v224, v224, v235
  v_mul_f32 v225, v225, v235
  v_mul_f32 v226, v226, v235
  v_mul_f32 v227, v227, v235
  v_mul_f32 v228, v228, v235
  v_mul_f32 v229, v229, v235
  v_mul_f32 v230, v230, v235
  v_mul_f32 v231, v231, v235
  v_accvgpr_write_b32 a40, v224
  v_accvgpr_write_b32 a41, v225
  v_accvgpr_write_b32 a42, v226
  v_accvgpr_write_b32 a43, v227
  v_accvgpr_write_b32 a44, v228
  v_accvgpr_write_b32 a45, v229
  v_accvgpr_write_b32 a46, v230
  v_accvgpr_write_b32 a47, v231
  v_accvgpr_read_b32 v224, a48
  v_accvgpr_read_b32 v225, a49
  v_accvgpr_read_b32 v226, a50
  v_accvgpr_read_b32 v227, a51
  v_accvgpr_read_b32 v228, a52
  v_accvgpr_read_b32 v229, a53
  v_accvgpr_read_b32 v230, a54
  v_accvgpr_read_b32 v231, a55
  v_mul_f32 v224, v224, v235
  v_mul_f32 v225, v225, v235
  v_mul_f32 v226, v226, v235
  v_mul_f32 v227, v227, v235
  v_mul_f32 v228, v228, v235
  v_mul_f32 v229, v229, v235
  v_mul_f32 v230, v230, v235
  v_mul_f32 v231, v231, v235
  v_accvgpr_write_b32 a48, v224
  v_accvgpr_write_b32 a49, v225
  v_accvgpr_write_b32 a50, v226
  v_accvgpr_write_b32 a51, v227
  v_accvgpr_write_b32 a52, v228
  v_accvgpr_write_b32 a53, v229
  v_accvgpr_write_b32 a54, v230
  v_accvgpr_write_b32 a55, v231
  v_accvgpr_read_b32 v224, a56
  v_accvgpr_read_b32 v225, a57
  v_accvgpr_read_b32 v226, a58
  v_accvgpr_read_b32 v227, a59
  v_accvgpr_read_b32 v228, a60
  v_accvgpr_read_b32 v229, a61
  v_accvgpr_read_b32 v230, a62
  v_accvgpr_read_b32 v231, a63
  v_mul_f32 v224, v224, v235
  v_mul_f32 v225, v225, v235
  v_mul_f32 v226, v226, v235
  v_mul_f32 v227, v227, v235
  v_mul_f32 v228, v228, v235
  v_mul_f32 v229, v229, v235
  v_mul_f32 v230, v230, v235
  v_mul_f32 v231, v231, v235
  v_accvgpr_write_b32 a56, v224
  v_accvgpr_write_b32 a57, v225
  v_accvgpr_write_b32 a58, v226
  v_accvgpr_write_b32 a59, v227
  v_accvgpr_write_b32 a60, v228
  v_accvgpr_write_b32 a61, v229
  v_accvgpr_write_b32 a62, v230
  v_accvgpr_write_b32 a63, v231
  v_max3_f32 v234, v80, v81, v82
  v_max3_f32 v234, v234, v83, v84
  v_max3_f32 v234, v234, v85, v86
  v_max_f32 v234, v234, v87
  v_mov_b32 v235, v234
  s_nop 1
  v_permlane32_swap_b32 v234, v235
  v_max_f32 v234, v234, v235
  v_mov_b32 v235, v234
  s_nop 1
  v_permlane16_swap_b32 v234, v235
  v_max_f32 v234, v234, v235
  v_add_f32 v234, 0x42200000, v234
  v_max_f32 v234, 0, v234
  v_exp_f32 v235, -v234
  v_mul_f32 v236, s93, v234
  v_sub_f32 v80, v80, v234
  v_sub_f32 v48, v48, v236
  v_sub_f32 v112, v112, v236
  v_sub_f32 v81, v81, v234
  v_sub_f32 v49, v49, v236
  v_sub_f32 v113, v113, v236
  v_sub_f32 v82, v82, v234
  v_sub_f32 v50, v50, v236
  v_sub_f32 v114, v114, v236
  v_sub_f32 v83, v83, v234
  v_sub_f32 v51, v51, v236
  v_sub_f32 v115, v115, v236
  v_sub_f32 v84, v84, v234
  v_sub_f32 v52, v52, v236
  v_sub_f32 v116, v116, v236
  v_sub_f32 v85, v85, v234
  v_sub_f32 v53, v53, v236
  v_sub_f32 v117, v117, v236
  v_sub_f32 v86, v86, v234
  v_sub_f32 v54, v54, v236
  v_sub_f32 v118, v118, v236
  v_sub_f32 v87, v87, v234
  v_sub_f32 v55, v55, v236
  v_sub_f32 v119, v119, v236
  v_sub_f32 v18, v18, v236
  v_mul_f32 v10, v10, v235
  v_accvgpr_read_b32 v224, a64
  v_accvgpr_read_b32 v225, a65
  v_accvgpr_read_b32 v226, a66
  v_accvgpr_read_b32 v227, a67
  v_accvgpr_read_b32 v228, a68
  v_accvgpr_read_b32 v229, a69
  v_accvgpr_read_b32 v230, a70
  v_accvgpr_read_b32 v231, a71
  v_mul_f32 v224, v224, v235
  v_mul_f32 v225, v225, v235
  v_mul_f32 v226, v226, v235
  v_mul_f32 v227, v227, v235
  v_mul_f32 v228, v228, v235
  v_mul_f32 v229, v229, v235
  v_mul_f32 v230, v230, v235
  v_mul_f32 v231, v231, v235
  v_accvgpr_write_b32 a64, v224
  v_accvgpr_write_b32 a65, v225
  v_accvgpr_write_b32 a66, v226
  v_accvgpr_write_b32 a67, v227
  v_accvgpr_write_b32 a68, v228
  v_accvgpr_write_b32 a69, v229
  v_accvgpr_write_b32 a70, v230
  v_accvgpr_write_b32 a71, v231
  v_accvgpr_read_b32 v224, a72
  v_accvgpr_read_b32 v225, a73
  v_accvgpr_read_b32 v226, a74
  v_accvgpr_read_b32 v227, a75
  v_accvgpr_read_b32 v228, a76
  v_accvgpr_read_b32 v229, a77
  v_accvgpr_read_b32 v230, a78
  v_accvgpr_read_b32 v231, a79
  v_mul_f32 v224, v224, v235
  v_mul_f32 v225, v225, v235
  v_mul_f32 v226, v226, v235
  v_mul_f32 v227, v227, v235
  v_mul_f32 v228, v228, v235
  v_mul_f32 v229, v229, v235
  v_mul_f32 v230, v230, v235
  v_mul_f32 v231, v231, v235
  v_accvgpr_write_b32 a72, v224
  v_accvgpr_write_b32 a73, v225
  v_accvgpr_write_b32 a74, v226
  v_accvgpr_write_b32 a75, v227
  v_accvgpr_write_b32 a76, v228
  v_accvgpr_write_b32 a77, v229
  v_accvgpr_write_b32 a78, v230
  v_accvgpr_write_b32 a79, v231
  v_accvgpr_read_b32 v224, a80
  v_accvgpr_read_b32 v225, a81
  v_accvgpr_read_b32 v226, a82
  v_accvgpr_read_b32 v227, a83
  v_accvgpr_read_b32 v228, a84
  v_accvgpr_read_b32 v229, a85
  v_accvgpr_read_b32 v230, a86
  v_accvgpr_read_b32 v231, a87
  v_mul_f32 v224, v224, v235
  v_mul_f32 v225, v225, v235
  v_mul_f32 v226, v226, v235
  v_mul_f32 v227, v227, v235
  v_mul_f32 v228, v228, v235
  v_mul_f32 v229, v229, v235
  v_mul_f32 v230, v230, v235
  v_mul_f32 v231, v231, v235
  v_accvgpr_write_b32 a80, v224
  v_accvgpr_write_b32 a81, v225
  v_accvgpr_write_b32 a82, v226
  v_accvgpr_write_b32 a83, v227
  v_accvgpr_write_b32 a84, v228
  v_accvgpr_write_b32 a85, v229
  v_accvgpr_write_b32 a86, v230
  v_accvgpr_write_b32 a87, v231
  v_accvgpr_read_b32 v224, a88
  v_accvgpr_read_b32 v225, a89
  v_accvgpr_read_b32 v226, a90
  v_accvgpr_read_b32 v227, a91
  v_accvgpr_read_b32 v228, a92
  v_accvgpr_read_b32 v229, a93
  v_accvgpr_read_b32 v230, a94
  v_accvgpr_read_b32 v231, a95
  v_mul_f32 v224, v224, v235
  v_mul_f32 v225, v225, v235
  v_mul_f32 v226, v226, v235
  v_mul_f32 v227, v227, v235
  v_mul_f32 v228, v228, v235
  v_mul_f32 v229, v229, v235
  v_mul_f32 v230, v230, v235
  v_mul_f32 v231, v231, v235
  v_accvgpr_write_b32 a88, v224
  v_accvgpr_write_b32 a89, v225
  v_accvgpr_write_b32 a90, v226
  v_accvgpr_write_b32 a91, v227
  v_accvgpr_write_b32 a92, v228
  v_accvgpr_write_b32 a93, v229
  v_accvgpr_write_b32 a94, v230
  v_accvgpr_write_b32 a95, v231
  v_max3_f32 v234, v88, v89, v90
  v_max3_f32 v234, v234, v91, v92
  v_max3_f32 v234, v234, v93, v94
  v_max_f32 v234, v234, v95
  v_mov_b32 v235, v234
  s_nop 1
  v_permlane32_swap_b32 v234, v235
  v_max_f32 v234, v234, v235
  v_mov_b32 v235, v234
  s_nop 1
  v_permlane16_swap_b32 v234, v235
  v_max_f32 v234, v234, v235
  v_add_f32 v234, 0x42200000, v234
  v_max_f32 v234, 0, v234
  v_exp_f32 v235, -v234
  v_mul_f32 v236, s93, v234
  v_sub_f32 v88, v88, v234
  v_sub_f32 v56, v56, v236
  v_sub_f32 v120, v120, v236
  v_sub_f32 v89, v89, v234
  v_sub_f32 v57, v57, v236
  v_sub_f32 v121, v121, v236
  v_sub_f32 v90, v90, v234
  v_sub_f32 v58, v58, v236
  v_sub_f32 v122, v122, v236
  v_sub_f32 v91, v91, v234
  v_sub_f32 v59, v59, v236
  v_sub_f32 v123, v123, v236
  v_sub_f32 v92, v92, v234
  v_sub_f32 v60, v60, v236
  v_sub_f32 v124, v124, v236
  v_sub_f32 v93, v93, v234
  v_sub_f32 v61, v61, v236
  v_sub_f32 v125, v125, v236
  v_sub_f32 v94, v94, v234
  v_sub_f32 v62, v62, v236
  v_sub_f32 v126, v126, v236
  v_sub_f32 v95, v95, v234
  v_sub_f32 v63, v63, v236
  v_sub_f32 v127, v127, v236
  v_sub_f32 v19, v19, v236
  v_mul_f32 v11, v11, v235
  v_accvgpr_read_b32 v224, a96
  v_accvgpr_read_b32 v225, a97
  v_accvgpr_read_b32 v226, a98
  v_accvgpr_read_b32 v227, a99
  v_accvgpr_read_b32 v228, a100
  v_accvgpr_read_b32 v229, a101
  v_accvgpr_read_b32 v230, a102
  v_accvgpr_read_b32 v231, a103
  v_mul_f32 v224, v224, v235
  v_mul_f32 v225, v225, v235
  v_mul_f32 v226, v226, v235
  v_mul_f32 v227, v227, v235
  v_mul_f32 v228, v228, v235
  v_mul_f32 v229, v229, v235
  v_mul_f32 v230, v230, v235
  v_mul_f32 v231, v231, v235
  v_accvgpr_write_b32 a96, v224
  v_accvgpr_write_b32 a97, v225
  v_accvgpr_write_b32 a98, v226
  v_accvgpr_write_b32 a99, v227
  v_accvgpr_write_b32 a100, v228
  v_accvgpr_write_b32 a101, v229
  v_accvgpr_write_b32 a102, v230
  v_accvgpr_write_b32 a103, v231
  v_accvgpr_read_b32 v224, a104
  v_accvgpr_read_b32 v225, a105
  v_accvgpr_read_b32 v226, a106
  v_accvgpr_read_b32 v227, a107
  v_accvgpr_read_b32 v228, a108
  v_accvgpr_read_b32 v229, a109
  v_accvgpr_read_b32 v230, a110
  v_accvgpr_read_b32 v231, a111
  v_mul_f32 v224, v224, v235
  v_mul_f32 v225, v225, v235
  v_mul_f32 v226, v226, v235
  v_mul_f32 v227, v227, v235
  v_mul_f32 v228, v228, v235
  v_mul_f32 v229, v229, v235
  v_mul_f32 v230, v230, v235
  v_mul_f32 v231, v231, v235
  v_accvgpr_write_b32 a104, v224
  v_accvgpr_write_b32 a105, v225
  v_accvgpr_write_b32 a106, v226
  v_accvgpr_write_b32 a107, v227
  v_accvgpr_write_b32 a108, v228
  v_accvgpr_write_b32 a109, v229
  v_accvgpr_write_b32 a110, v230
  v_accvgpr_write_b32 a111, v231
  v_accvgpr_read_b32 v224, a112
  v_accvgpr_read_b32 v225, a113
  v_accvgpr_read_b32 v226, a114
  v_accvgpr_read_b32 v227, a115
  v_accvgpr_read_b32 v228, a116
  v_accvgpr_read_b32 v229, a117
  v_accvgpr_read_b32 v230, a118
  v_accvgpr_read_b32 v231, a119
  v_mul_f32 v224, v224, v235
  v_mul_f32 v225, v225, v235
  v_mul_f32 v226, v226, v235
  v_mul_f32 v227, v227, v235
  v_mul_f32 v228, v228, v235
  v_mul_f32 v229, v229, v235
  v_mul_f32 v230, v230, v235
  v_mul_f32 v231, v231, v235
  v_accvgpr_write_b32 a112, v224
  v_accvgpr_write_b32 a113, v225
  v_accvgpr_write_b32 a114, v226
  v_accvgpr_write_b32 a115, v227
  v_accvgpr_write_b32 a116, v228
  v_accvgpr_write_b32 a117, v229
  v_accvgpr_write_b32 a118, v230
  v_accvgpr_write_b32 a119, v231
  v_accvgpr_read_b32 v224, a120
  v_accvgpr_read_b32 v225, a121
  v_accvgpr_read_b32 v226, a122
  v_accvgpr_read_b32 v227, a123
  v_accvgpr_read_b32 v228, a124
  v_accvgpr_read_b32 v229, a125
  v_accvgpr_read_b32 v230, a126
  v_accvgpr_read_b32 v231, a127
  v_mul_f32 v224, v224, v235
  v_mul_f32 v225, v225, v235
  v_mul_f32 v226, v226, v235
  v_mul_f32 v227, v227, v235
  v_mul_f32 v228, v228, v235
  v_mul_f32 v229, v229, v235
  v_mul_f32 v230, v230, v235
  v_mul_f32 v231, v231, v235
  v_accvgpr_write_b32 a120, v224
  v_accvgpr_write_b32 a121, v225
  v_accvgpr_write_b32 a122, v226
  v_accvgpr_write_b32 a123, v227
  v_accvgpr_write_b32 a124, v228
  v_accvgpr_write_b32 a125, v229
  v_accvgpr_write_b32 a126, v230
  v_accvgpr_write_b32 a127, v231
  v_exp_f32 v224, v64
  v_exp_f32 v225, v65
  v_exp_f32 v226, v72
  v_cvt_pk_bf16_f32 v144, v224, v225
  v_exp_f32 v227, v73
  v_exp_f32 v228, v80
  v_cvt_pk_bf16_f32 v148, v226, v227
  v_exp_f32 v229, v81
  v_exp_f32 v230, v88
  v_cvt_pk_bf16_f32 v152, v228, v229
  v_exp_f32 v231, v89
  v_exp_f32 v224, v66
  v_cvt_pk_bf16_f32 v156, v230, v231
  v_exp_f32 v225, v67
  v_exp_f32 v226, v74
  v_cvt_pk_bf16_f32 v145, v224, v225
  v_exp_f32 v227, v75
  v_exp_f32 v228, v82
  v_cvt_pk_bf16_f32 v149, v226, v227
  v_exp_f32 v229, v83
  v_exp_f32 v230, v90
  v_cvt_pk_bf16_f32 v153, v228, v229
  v_exp_f32 v231, v91
  v_exp_f32 v224, v68
  v_cvt_pk_bf16_f32 v157, v230, v231
  v_exp_f32 v225, v69
  v_exp_f32 v226, v76
  v_cvt_pk_bf16_f32 v146, v224, v225
  v_exp_f32 v227, v77
  v_exp_f32 v228, v84
  v_cvt_pk_bf16_f32 v150, v226, v227
  v_exp_f32 v229, v85
  v_exp_f32 v230, v92
  v_cvt_pk_bf16_f32 v154, v228, v229
  v_exp_f32 v231, v93
  v_exp_f32 v224, v70
  v_cvt_pk_bf16_f32 v158, v230, v231
  v_exp_f32 v225, v71
  v_exp_f32 v226, v78
  v_cvt_pk_bf16_f32 v147, v224, v225
  v_exp_f32 v227, v79
  v_exp_f32 v228, v86
  v_cvt_pk_bf16_f32 v151, v226, v227
  v_exp_f32 v229, v87
  v_exp_f32 v230, v94
  v_cvt_pk_bf16_f32 v155, v228, v229
  v_exp_f32 v231, v95
  s_nop 0
  v_cvt_pk_bf16_f32 v159, v230, v231
  v_mfma_f32_16x16x32_bf16 v[128:131], v[12:15], v[144:147], 0
  v_mfma_f32_16x16x32_bf16 v[132:135], v[12:15], v[148:151], 0
  v_mfma_f32_16x16x32_bf16 v[136:139], v[12:15], v[152:155], 0
  v_mfma_f32_16x16x32_bf16 v[140:143], v[12:15], v[156:159], 0
  v_exp_f32 v224, v32
  v_exp_f32 v225, v33
  v_exp_f32 v226, v40
  v_exp_f32 v227, v41
  s_nop 3
  s_setpc_b64 s[48:49]
M_codeend:
.section .rodata,"a"
.p2align 6
.amdhsa_kernel main_kernel
  .amdhsa_next_free_vgpr 512
  .amdhsa_next_free_sgpr 102
  .amdhsa_accum_offset 256
  .amdhsa_group_segment_fixed_size 0
  .amdhsa_kernarg_size 104
  .amdhsa_user_sgpr_count 2
  .amdhsa_user_sgpr_kernarg_segment_ptr 1
  .amdhsa_system_sgpr_workgroup_id_x 1
.end_amdhsa_kernel
```
